```python
import torch

def _softmax(x, axis=-1):
    return torch.softmax(x, dim=axis)
def _gelu(x):
    return torch.nn.functional.gelu(x, approximate="tanh")
def _silu(x):
    return torch.nn.functional.silu(x)
def _sigmoid(x):
    return torch.sigmoid(x)
def _layernorm(x, axis=-1, eps=1e-5):
    m = x.mean(dim=axis, keepdim=True)
    v = x.var(dim=axis, keepdim=True, unbiased=False)
    return (x - m) / torch.sqrt(v + eps)
def _scatter_add(tgt, idx, src, axis=0):
    return tgt.clone().index_add_(axis, idx, src)
def _segment_sum(src, seg, n):
    out = torch.zeros((n,) + src.shape[1:], dtype=src.dtype)
    return out.index_add_(0, seg, src)
def _pad(x, pw):
    flat = tuple(v for pair in reversed(pw) for v in pair)
    return torch.nn.functional.pad(x, flat)

kernel_name = 'recurrent_scan__sliding_local_dilated__swiglu_ffn__prompt'

def setup_inputs():

    _w = (lambda a: (lambda t: t.to(torch.bfloat16) if t.is_floating_point() else t)(torch.as_tensor(a)))
    def _A_setup():
        B, S, D = 1, 2048, 512
        return {
            "x": _w((lambda *s: torch.randn(*s, dtype=torch.bfloat16) * 0.05)(B, S, D)),
            "wqkv": _w((lambda *s: torch.randn(*s, dtype=torch.bfloat16) * 0.05)(D, 3 * D)),
            "wo": _w((lambda *s: torch.randn(*s, dtype=torch.bfloat16) * 0.05)(D, D)),
        }
    _A_in = _A_setup()

    def _B_setup():
        B, S, D, F = 1, 2048, 512, 1792
        return {
            "x": _w((lambda *s: torch.randn(*s, dtype=torch.bfloat16) * 0.05)(B, S, D)),
            "w_gate": _w((lambda *s: torch.randn(*s, dtype=torch.bfloat16) * 0.05)(D, F)),
            "w_up": _w((lambda *s: torch.randn(*s, dtype=torch.bfloat16) * 0.05)(D, F)),
            "w_down": _w((lambda *s: torch.randn(*s, dtype=torch.bfloat16) * 0.05)(F, D)),
        }
    _B_in = _B_setup()

    return {
        "A_x": _A_in["x"],
        "A_wqkv": _A_in["wqkv"],
        "A_wo": _A_in["wo"],
        "B_x": _B_in["x"],
        "B_w_gate": _B_in["w_gate"],
        "B_w_up": _B_in["w_up"],
        "B_w_down": _B_in["w_down"],
    }

def reference(A_x, A_wqkv, A_wo, B_x, B_w_gate, B_w_up, B_w_down):
    def _A_ref(x, wqkv, wo):
        B, S, D = x.shape
        H = 32; Dh = D // H
        W, dil = 8, 2
        qkv = (lambda x, *d: x.permute(*d))((x @ wqkv).reshape(B, S, 3, H, Dh), 2, 0, 3, 1, 4)
        q, k, v = qkv[0], qkv[1], qkv[2]
        scale = Dh ** -0.5
        pos = torch.arange(S)
        off = torch.arange(W) * dil
        idx = pos[:, None] - off[None, :]
        mask = idx >= 0
        idx_c = torch.where(mask, idx, 0).reshape(-1)
        kg = k[:, :, idx_c, :].reshape(B, H, S, W, Dh)
        vg = v[:, :, idx_c, :].reshape(B, H, S, W, Dh)
        logits = torch.einsum("bhsd,bhswd->bhsw", q, kg) * scale
        logits = torch.where(mask[None, None, :, :], logits, -1e9)
        attn = _softmax(logits, axis=-1)
        o = torch.einsum("bhsw,bhswd->bhsd", attn, vg)
        return (lambda x, *d: x.permute(*d))(o, 0, 2, 1, 3).reshape(B, S, D) @ wo

    def _B_ref(x, w_gate, w_up, w_down):
        g = _silu(x @ w_gate)
        u = x @ w_up
        return (g * u) @ w_down

    x = A_x
    xn = _layernorm(x, axis=-1)
    s = _A_ref(xn, A_wqkv, A_wo)
    g = _silu(_B_ref(xn, B_w_gate, B_w_up, B_w_down))
    return x + s * g
```

```asm
; @launch grid=(256,1,1) block=(512,1,1) lds=163840
.amdgcn_target "amdgcn-amd-amdhsa--gfx950"
.text
.globl recurrent_scan__sliding_local_dilated__swiglu_ffn__prompt_kernel
.p2align 8
.type recurrent_scan__sliding_local_dilated__swiglu_ffn__prompt_kernel,@function
recurrent_scan__sliding_local_dilated__swiglu_ffn__prompt_kernel:
  s_cmp_ge_u32 s2, 256
  s_cbranch_scc1 L_exit
  s_load_dwordx2 s[20:21], s[0:1], 0
  s_load_dwordx16 s[4:19], s[0:1], 0
  s_load_dwordx4 s[36:39], s[0:1], 64
  v_readfirstlane_b32 s44, v0
  v_lshrrev_b32 v3, 4, v0
  v_lshrrev_b32 v190, 3, v0
  s_bfe_u32 s66, s2, 0x10002
  s_bfe_u32 s67, s2, 0x30003
  s_lshl3_add_u32 s46, s66, s67
  v_bitop3_b32 v4, v3, v0, 7 bitop3:0x28
  s_lshl_b32 s53, s44, 4
  s_lshl_b32 s50, s46, 17
  v_lshlrev_b32 v4, 4, v4
  s_and_b32 s66, s2, 3
  s_lshr_b32 s67, s2, 6
  s_lshl2_add_u32 s66, s66, s67
  s_lshl_b32 s66, s66, 13
  s_add_u32 s63, s66, s50
  v_lshlrev_b32 v2, 4, v0
  v_lshl_add_u32 v18, v190, 10, v4
  s_mov_b32 s22, 0x200000
  s_mov_b32 s23, 0x20000
  s_getpc_b64 s[66:67]
  s_lshr_b32 s68, s2, 3
  s_lshl_b32 s68, s68, 4
  v_lshrrev_b32 v5, 5, v0
  v_add_lshl_u32 v4, v5, s68, 7
  global_load_dword v177, v4, s[66:67]
  s_add_u32 s51, s50, 0x10000
  s_add_u32 m0, s53, 8192
  s_waitcnt lgkmcnt(0)
  buffer_load_dwordx4 v18, s[20:23], s50 offen lds
  s_add_u32 m0, s53, 16384
  s_nop 0
  buffer_load_dwordx4 v18, s[20:23], s51 offen lds
  v_and_b32 v3, 4, v3
  s_lshr_b32 s44, s44, 6
  v_and_or_b32 v3, v190, 2, v3
  s_and_b32 s66, s2, 3
  s_lshr_b32 s67, s2, 7
  s_lshl1_add_u32 s47, s66, s67
  v_bitop3_b32 v3, v3, v0, 7 bitop3:0x28
  s_and_b32 s45, s44, 3
  s_lshl_b32 s52, s45, 10
  v_lshlrev_b32 v3, 4, v3
  v_and_b32 v191, 31, v190
  s_mov_b32 s27, 0x20000
  s_mov_b32 s31, 0x20000
  s_movk_i32 s68, 3584
  s_lshr_b32 s54, s44, 2
  s_bitcmp1_b32 s2, 6
  s_cbranch_scc1 L_pB
  s_movk_i32 s55, 3072
  s_lshl_b32 s66, s47, 7
  s_xor_b32 s59, s66, 256
  s_add_u32 s59, s59, 2560
  s_lshl_b32 s67, 1024, s54
  s_add_u32 s57, s66, s67
  s_cmp_eq_u32 s54, 0
  s_cselect_b32 s56, s55, s68
  s_cselect_b32 s58, s66, s59
  s_cselect_b64 s[28:29], s[6:7], s[12:13]
  s_mov_b64 s[24:25], s[6:7]
  s_branch L_pJ
L_pB:
  s_mov_b32 s55, s68
  s_mov_b32 s56, s68
  s_mul_i32 s66, s47, 320
  s_bitcmp1_b32 s47, 0
  s_cselect_b32 s57, 64, 0
  s_cselect_b32 s59, 0, 256
  s_add_u32 s57, s57, s66
  s_add_u32 s59, s59, s66
  s_add_u32 s58, s57, 128
  s_cmp_eq_u32 s54, 0
  s_cselect_b64 s[24:25], s[12:13], s[14:15]
  s_cselect_b64 s[28:29], s[12:13], s[14:15]
L_pJ:
  v_mad_u32_u24 v20, v191, s55, v3
  v_mad_u32_u24 v21, v191, s56, v3
  s_lshl_b32 s26, s55, 9
  s_lshl_b32 s30, s56, 9
  s_lshl_b32 s66, s54, 13
  s_add_u32 s66, s66, s52
  s_add_u32 m0, s66, 61440
  s_nop 0
  buffer_load_dwordx4 v20, s[24:27], s57 offen lds
  s_lshl_b32 s67, s55, 5
  s_add_u32 s67, s67, s57
  s_add_u32 m0, s66, 65536
  s_nop 0
  buffer_load_dwordx4 v20, s[24:27], s67 offen lds
  buffer_load_dwordx4 v[184:187], v2, s[20:23], s63 offen
  v_add_u32 v20, s57, v20
  v_add_u32 v21, s58, v21
  v_and_b32 v1, 63, v0
  s_bitcmp1_b32 s2, 6
  s_cbranch_scc1 L_B
  s_cmp_eq_u32 s54, 0
  s_cbranch_scc0 L_A1
  s_branch L_A0
L_B:
  s_cmp_eq_u32 s54, 0
  s_cbranch_scc0 L_B1
  s_branch L_B0
L_exit:
  s_endpgm
.p2align 12
L_A0:
  s_setprio 1
  s_mov_b32 s48, 0
  s_mov_b32 s49, 0
  v_lshlrev_b32 v2, 4, v1
  s_cmp_eq_u32 s45, 0
  s_cselect_b64 s[6:7], s[6:7], s[12:13]
  s_cmp_eq_u32 s45, 2
  s_cselect_b64 s[6:7], s[14:15], s[6:7]
  s_or_b32 s67, s2, 0
  s_cmp_eq_u32 s45, 0
  s_cselect_b32 s66, 6, 7
  s_mul_i32 s67, s67, 2
  s_add_u32 s67, s67, 256
  s_mul_i32 s67, s67, s66
  s_mul_i32 s66, s66, 2
  s_sub_u32 s66, s66, 1
  s_cmp_eq_u32 s45, 3
  s_cselect_b32 s66, 0, s66
  v_min_u32 v208, s66, v1
  v_add_lshl_u32 v208, v208, s67, 7
  v_and_b32 v11, 15, v1
  v_lshrrev_b32 v4, 4, v1
  v_bfe_u32 v190, v1, 1, 3
  v_xor_b32 v190, v190, v4
  v_lshlrev_b32 v190, 4, v190
  v_lshl_add_u32 v23, v11, 7, v190
  v_xor_b32_e64 v24, 64, v23
  v_bfe_u32 v190, v1, 3, 2
  v_xor_b32 v190, s45, v190
  v_lshlrev_b32 v190, 5, v190
  v_lshl_add_u32 v190, v4, 10, v190
  v_bfe_u32 v191, v1, 2, 2
  s_add_u32 m0, s52, 77824
  s_mov_b32 s48, 0
  buffer_load_dwordx4 v21, s[28:31], s48 offen lds
  v_lshl_add_u32 v190, v191, 7, v190
  v_and_b32 v3, 3, v1
  v_lshl_add_u32 v190, v3, 3, v190
  v_add_u32 v25, 61440, v190
  v_add_u32 v26, 122880, v190
  v_mov_b32 v34, 0x3f803f80
  v_mov_b32 v35, 0x3f803f80
  v_mov_b32 v36, 0x3f803f80
  v_mov_b32 v37, 0x3f803f80
  v_mov_b32 v126, 0
  v_mov_b32 v127, 0
  v_mov_b32 v128, 0
  v_mov_b32 v129, 0
  v_mov_b32 v138, 0
  v_mov_b32 v139, 0
  v_mov_b32 v140, 0
  v_mov_b32 v141, 0
  v_mov_b32 v142, 0
  v_mov_b32 v143, 0
  v_mov_b32 v144, 0
  v_mov_b32 v145, 0
  v_bfe_i32 v32, v1, 0, 1
  v_and_b32 v32, 0xaaaaaaaa, v32
  s_add_u32 m0, s52, 81920
  s_mov_b32 s48, 98304
  buffer_load_dwordx4 v21, s[28:31], s48 offen lds
  v_or_b32 v32, 0x44444444, v32
  s_add_u32 s40, s38, 0
  s_addc_u32 s41, s39, 0
  s_mov_b64 s[12:13], s[18:19]
  s_mov_b32 s42, 0x970000
  s_mov_b32 s43, 0x20000
  s_mov_b32 s38, 0x100
  s_mov_b32 s39, 0x20000
  s_mov_b32 s10, 0x80000
  s_mov_b32 s11, 0x20000
  s_mov_b32 s18, 0x1c0000
  s_mov_b32 s19, 0x20000
  s_mov_b32 s14, 0x200000
  s_mov_b32 s15, 0x20000
  s_and_b32 s66, s2, 7
  s_bfe_u32 s67, s2, 0x20003
  s_lshl2_add_u32 s66, s66, s67
  s_lshr_b32 s60, s2, 5
  s_and_b32 s67, s66, 30
  s_add_u32 s61, s66, s67
  s_lshl3_add_u32 s66, s66, s60
  s_lshl_b32 s66, s66, 9
  s_add_u32 s64, s66, 9437184
  s_lshl_b32 s66, s45, 28
  global_load_dword v177, v208, s[6:7]
  v_lshl_add_u32 v3, v1, 2, s66
  v_mov_b32 v188, 0
  v_mov_b32_e64 v189, 0
  buffer_store_dword v188, v3, s[40:43], s64 offen sc1
  ds_write_b32 v188, v188 offset:5888
  v_mov_b32 v6, 1
  s_mov_b64 exec, 0
  s_branch L_P0wA
L_A0r:
  s_mov_b64 exec, -1
  s_waitcnt vmcnt(4)
  v_lshlrev_b32 v200, 16, v184
  v_and_b32 v201, 0xffff0000, v184
  v_lshlrev_b32_e64 v202, 16, v185
  v_and_b32 v203, 0xffff0000, v185
  v_lshlrev_b32_e64 v204, 16, v186
  v_and_b32 v205, 0xffff0000, v186
  v_lshlrev_b32_e64 v206, 16, v187
  v_and_b32 v207, 0xffff0000, v187
  v_pk_add_f32 v[184:185], v[200:201], v[202:203]
  v_pk_add_f32 v[186:187], v[204:205], v[206:207]
  v_pk_add_f32 v[184:185], v[184:185], v[186:187]
  v_add_f32_e64 v188, v184, v185
  s_add_u32 s63, s63, s53
  s_lshr_b32 s63, s63, 6
  v_add_f32_dpp v188, v188, v188 row_ror:8 row_mask:0xf bank_mask:0xf
  s_nop 1
  v_add_f32_dpp v188, v188, v188 row_ror:4 row_mask:0xf bank_mask:0xf
  s_add_u32 m0, s53, 26496
  s_nop 0
  buffer_load_dwordx4 v18, s[20:23], s50 offen offset:128 lds
  v_add_f32_dpp v188, v188, v188 row_ror:2 row_mask:0xf bank_mask:0xf
  s_nop 1
  v_add_f32_dpp v188, v188, v188 row_ror:1 row_mask:0xf bank_mask:0xf
  v_mov_b32 v191, v188
  s_nop 1
  v_permlane16_swap_b32 v188, v191
  v_add_f32 v188, v188, v191
  v_mov_b32 v191, v188
  s_nop 1
  v_permlane32_swap_b32 v188, v191
  v_add_f32_e64 v188, v188, v191
  v_mul_f32 v188, 0x3b000000, v188
  v_pk_add_f32 v[200:201], v[200:201], v[188:189] op_sel_hi:[1,0] neg_lo:[0,1] neg_hi:[0,1]
  v_pk_add_f32 v[202:203], v[202:203], v[188:189] op_sel_hi:[1,0] neg_lo:[0,1] neg_hi:[0,1]
  v_pk_add_f32 v[204:205], v[204:205], v[188:189] op_sel_hi:[1,0] neg_lo:[0,1] neg_hi:[0,1]
  v_pk_add_f32 v[206:207], v[206:207], v[188:189] op_sel_hi:[1,0] neg_lo:[0,1] neg_hi:[0,1]
  v_pk_mul_f32 v[184:185], v[200:201], v[200:201]
  v_pk_fma_f32 v[184:185], v[202:203], v[202:203], v[184:185]
  v_pk_fma_f32 v[184:185], v[204:205], v[204:205], v[184:185]
  v_pk_fma_f32 v[184:185], v[206:207], v[206:207], v[184:185]
  v_add_f32_e64 v189, v184, v185
  s_add_u32 s63, s63, 9568256
  v_lshlrev_b32_e64 v190, 24, v1
  v_add_f32_dpp v189, v189, v189 row_ror:8 row_mask:0xf bank_mask:0xf
  s_nop 1
  v_add_f32_dpp v189, v189, v189 row_ror:4 row_mask:0xf bank_mask:0xf
  s_nop 1
  v_add_f32_dpp v189, v189, v189 row_ror:2 row_mask:0xf bank_mask:0xf
  s_add_u32 m0, s53, 34688
  s_nop 0
  buffer_load_dwordx4 v18, s[20:23], s51 offen offset:128 lds
  v_add_f32_dpp v189, v189, v189 row_ror:1 row_mask:0xf bank_mask:0xf
  v_mov_b32 v191, v189
  s_nop 1
  v_permlane16_swap_b32 v189, v191
  v_add_f32 v189, v189, v191
  v_mov_b32 v191, v189
  s_nop 1
  v_permlane32_swap_b32 v189, v191
  v_add_f32_e64 v189, v189, v191
  v_mul_f32 v189, 0x3b000000, v189
  v_cvt_pk_bf16_f32 v184, v188, v188
  v_and_b32 v184, 0xffff0000, v184
  v_cvt_pk_bf16_f32 v189, v189, v189
  v_and_b32 v189, 0xffff0000, v189
  v_add_f32 v189, 0x3727c5ac, v189
  v_cvt_pk_bf16_f32 v189, v189, v189
  v_and_b32 v189, 0xffff0000, v189
  v_sqrt_f32 v189, v189
  s_nop 0
  v_cvt_pk_bf16_f32 v189, v189, v189
  v_and_b32 v189, 0xffff0000, v189
  v_rcp_f32 v185, v189
  v_mul_f32 v187, v189, v189
  v_mul_f32 v186, 0xbfb8aa3b, v185
  buffer_store_dwordx4 v[184:187], v190, s[40:43], s63 offen sc1
  s_waitcnt lgkmcnt(0)
  s_barrier
  ds_read_b64_tr_b16 v[232:233], v25 offset:0
  ds_read_b64_tr_b16 v[234:235], v25 offset:512
  ds_read_b64_tr_b16 v[236:237], v25 offset:4096
  ds_read_b64_tr_b16 v[238:239], v25 offset:4608
  ds_read_b128 v[170:173], v23 offset:14336
  ds_read_b128 v[228:231], v24 offset:14336
  ds_read_b128 v[166:169], v23 offset:12288
  ds_read_b128 v[224:227], v24 offset:12288
  ds_read_b128 v[162:165], v23 offset:10240
  ds_read_b128 v[220:223], v24 offset:10240
  ds_read_b128 v[158:161], v23 offset:8192
  ds_read_b128 v[216:219], v24 offset:8192
  ds_read_b128 v[154:157], v23 offset:6144
  ds_read_b128 v[200:203], v24 offset:6144
  ds_read_b64_tr_b16 v[240:241], v25 offset:8192
  ds_read_b64_tr_b16 v[242:243], v25 offset:8704
  ds_read_b64_tr_b16 v[244:245], v25 offset:12288
  ds_read_b64_tr_b16 v[246:247], v25 offset:12800
  s_waitcnt lgkmcnt(13)
  v_mfma_f32_16x16x32_bf16 v[70:73], v[232:235], v[170:173], 0
  s_waitcnt lgkmcnt(12)
  v_mfma_f32_16x16x32_bf16 v[70:73], v[236:239], v[228:231], v[70:73]
  s_waitcnt lgkmcnt(10)
  v_mfma_f32_16x16x32_bf16 v[66:69], v[236:239], v[224:227], 0
  v_mfma_f32_16x16x32_bf16 v[66:69], v[232:235], v[166:169], v[66:69]
  s_waitcnt lgkmcnt(9)
  v_mfma_f32_16x16x32_bf16 v[62:65], v[232:235], v[162:165], 0
  s_waitcnt lgkmcnt(8)
  v_mfma_f32_16x16x32_bf16 v[62:65], v[236:239], v[220:223], v[62:65]
  s_waitcnt lgkmcnt(6)
  v_mfma_f32_16x16x32_bf16 v[58:61], v[236:239], v[216:219], 0
  s_add_u32 m0, s52, 102400
  s_mov_b32 s48, 196608
  buffer_load_dwordx4 v20, s[24:27], s48 offen lds
  v_mfma_f32_16x16x32_bf16 v[58:61], v[232:235], v[158:161], v[58:61]
  s_waitcnt lgkmcnt(5)
  v_mfma_f32_16x16x32_bf16 v[54:57], v[232:235], v[154:157], 0
  s_waitcnt lgkmcnt(4)
  v_mfma_f32_16x16x32_bf16 v[54:57], v[236:239], v[200:203], v[54:57]
  s_waitcnt lgkmcnt(2)
  v_mfma_f32_16x16x32_bf16 v[74:77], v[154:157], v[240:243], 0
  s_add_u32 m0, s52, 106496
  s_mov_b32 s48, 294912
  buffer_load_dwordx4 v20, s[24:27], s48 offen lds
  s_waitcnt lgkmcnt(0)
  v_mfma_f32_16x16x32_bf16 v[74:77], v[200:203], v[244:247], v[74:77]
  v_mfma_f32_16x16x32_bf16 v[78:81], v[216:219], v[244:247], 0
  v_mfma_f32_16x16x32_bf16 v[78:81], v[158:161], v[240:243], v[78:81]
  v_mfma_f32_16x16x32_bf16 v[82:85], v[162:165], v[240:243], 0
  v_mfma_f32_16x16x32_bf16 v[82:85], v[220:223], v[244:247], v[82:85]
  s_add_u32 m0, s52, 118784
  s_mov_b32 s48, 196608
  buffer_load_dwordx4 v21, s[28:31], s48 offen lds
  v_mfma_f32_16x16x32_bf16 v[86:89], v[224:227], v[244:247], 0
  v_mfma_f32_16x16x32_bf16 v[86:89], v[166:169], v[240:243], v[86:89]
  v_mfma_f32_16x16x32_bf16 v[90:93], v[170:173], v[240:243], 0
  v_mfma_f32_16x16x32_bf16 v[90:93], v[228:231], v[244:247], v[90:93]
  s_waitcnt vmcnt(8)
  s_barrier
  ds_read_b64_tr_b16 v[232:233], v25 offset:16384
  ds_read_b64_tr_b16 v[234:235], v25 offset:16896
  s_add_u32 m0, s52, 122880
  s_mov_b32 s48, 294912
  buffer_load_dwordx4 v21, s[28:31], s48 offen lds
  ds_read_b64_tr_b16 v[236:237], v25 offset:20480
  ds_read_b64_tr_b16 v[238:239], v25 offset:20992
  ds_read_b64_tr_b16 v[240:241], v25 offset:24576
  ds_read_b64_tr_b16 v[242:243], v25 offset:25088
  ds_read_b64_tr_b16 v[244:245], v25 offset:28672
  s_add_u32 m0, s53, 44800
  ds_read_b64_tr_b16 v[246:247], v25 offset:29184
  buffer_load_dwordx4 v18, s[20:23], s50 offen offset:256 lds
  ds_read_b64_tr_b16 v[248:249], v25 offset:32768
  ds_read_b64_tr_b16 v[250:251], v25 offset:33280
  ds_read_b64_tr_b16 v[252:253], v25 offset:36864
  ds_read_b64_tr_b16 v[254:255], v25 offset:37376
  s_waitcnt lgkmcnt(10)
  v_mfma_f32_16x16x32_bf16 v[50:53], v[232:235], v[170:173], 0
  s_waitcnt lgkmcnt(8)
  v_mfma_f32_16x16x32_bf16 v[50:53], v[236:239], v[228:231], v[50:53]
  v_mfma_f32_16x16x32_bf16 v[46:49], v[236:239], v[224:227], 0
  v_mfma_f32_16x16x32_bf16 v[46:49], v[232:235], v[166:169], v[46:49]
  v_mfma_f32_16x16x32_bf16 v[42:45], v[232:235], v[162:165], 0
  v_mfma_f32_16x16x32_bf16 v[42:45], v[236:239], v[220:223], v[42:45]
  v_mfma_f32_16x16x32_bf16 v[38:41], v[236:239], v[216:219], 0
  v_mfma_f32_16x16x32_bf16 v[38:41], v[232:235], v[158:161], v[38:41]
  v_smfmac_f32_16x16x64_bf16 v[126:129], v[34:37], v[232:239], v32
  s_waitcnt lgkmcnt(6)
  v_mfma_f32_16x16x32_bf16 v[94:97], v[240:243], v[158:161], 0
  s_waitcnt lgkmcnt(4)
  v_mfma_f32_16x16x32_bf16 v[94:97], v[244:247], v[216:219], v[94:97]
  v_mfma_f32_16x16x32_bf16 v[98:101], v[244:247], v[220:223], 0
  v_mfma_f32_16x16x32_bf16 v[98:101], v[240:243], v[162:165], v[98:101]
  v_mfma_f32_16x16x32_bf16 v[102:105], v[240:243], v[166:169], 0
  v_mfma_f32_16x16x32_bf16 v[102:105], v[244:247], v[224:227], v[102:105]
  v_mfma_f32_16x16x32_bf16 v[106:109], v[244:247], v[228:231], 0
  v_mfma_f32_16x16x32_bf16 v[106:109], v[240:243], v[170:173], v[106:109]
  v_smfmac_f32_16x16x64_bf16 v[138:141], v[34:37], v[240:247], v32
  s_waitcnt lgkmcnt(2)
  v_mfma_f32_16x16x32_bf16 v[122:125], v[248:251], v[170:173], 0
  s_waitcnt lgkmcnt(0)
  v_mfma_f32_16x16x32_bf16 v[122:125], v[252:255], v[228:231], v[122:125]
  v_mfma_f32_16x16x32_bf16 v[118:121], v[252:255], v[224:227], 0
  v_mfma_f32_16x16x32_bf16 v[118:121], v[248:251], v[166:169], v[118:121]
  v_mfma_f32_16x16x32_bf16 v[114:117], v[248:251], v[162:165], 0
  v_mfma_f32_16x16x32_bf16 v[114:117], v[252:255], v[220:223], v[114:117]
  v_mfma_f32_16x16x32_bf16 v[110:113], v[252:255], v[216:219], 0
  v_mfma_f32_16x16x32_bf16 v[110:113], v[248:251], v[158:161], v[110:113]
  v_smfmac_f32_16x16x64_bf16 v[142:145], v[34:37], v[248:255], v32
  s_waitcnt vmcnt(3)
  s_barrier
  ds_read_b64_tr_b16 v[232:233], v25 offset:40960
  ds_read_b64_tr_b16 v[234:235], v25 offset:41472
  s_add_u32 m0, s53, 52992
  ds_read_b64_tr_b16 v[236:237], v25 offset:45056
  buffer_load_dwordx4 v18, s[20:23], s51 offen offset:256 lds
  ds_read_b64_tr_b16 v[238:239], v25 offset:45568
  ds_read_b128 v[170:173], v23 offset:32768
  ds_read_b128 v[228:231], v24 offset:32768
  s_add_u32 m0, s52, 143360
  s_mov_b32 s48, 393216
  buffer_load_dwordx4 v20, s[24:27], s48 offen lds
  ds_read_b128 v[166:169], v23 offset:30720
  ds_read_b128 v[224:227], v24 offset:30720
  ds_read_b128 v[162:165], v23 offset:28672
  ds_read_b128 v[220:223], v24 offset:28672
  s_add_u32 m0, s52, 147456
  s_mov_b32 s48, 491520
  buffer_load_dwordx4 v20, s[24:27], s48 offen lds
  ds_read_b128 v[158:161], v23 offset:26624
  ds_read_b128 v[216:219], v24 offset:26624
  ds_read_b128 v[154:157], v23 offset:24576
  ds_read_b128 v[200:203], v24 offset:24576
  s_add_u32 m0, s52, 159744
  s_mov_b32 s48, 393216
  buffer_load_dwordx4 v21, s[28:31], s48 offen lds
  ds_read_b64_tr_b16 v[240:241], v25 offset:49152
  ds_read_b64_tr_b16 v[242:243], v25 offset:49664
  ds_read_b64_tr_b16 v[244:245], v25 offset:53248
  ds_read_b64_tr_b16 v[246:247], v25 offset:53760
  s_waitcnt lgkmcnt(13)
  v_mfma_f32_16x16x32_bf16 v[70:73], v[232:235], v[170:173], v[70:73]
  s_waitcnt lgkmcnt(12)
  v_mfma_f32_16x16x32_bf16 v[70:73], v[236:239], v[228:231], v[70:73]
  s_waitcnt lgkmcnt(10)
  v_mfma_f32_16x16x32_bf16 v[66:69], v[236:239], v[224:227], v[66:69]
  v_mfma_f32_16x16x32_bf16 v[66:69], v[232:235], v[166:169], v[66:69]
  s_waitcnt lgkmcnt(9)
  v_mfma_f32_16x16x32_bf16 v[62:65], v[232:235], v[162:165], v[62:65]
  s_waitcnt lgkmcnt(8)
  v_mfma_f32_16x16x32_bf16 v[62:65], v[236:239], v[220:223], v[62:65]
  s_waitcnt lgkmcnt(6)
  v_mfma_f32_16x16x32_bf16 v[58:61], v[236:239], v[216:219], v[58:61]
  v_mfma_f32_16x16x32_bf16 v[58:61], v[232:235], v[158:161], v[58:61]
  s_waitcnt lgkmcnt(5)
  v_mfma_f32_16x16x32_bf16 v[54:57], v[232:235], v[154:157], v[54:57]
  s_waitcnt lgkmcnt(4)
  v_mfma_f32_16x16x32_bf16 v[54:57], v[236:239], v[200:203], v[54:57]
  s_waitcnt lgkmcnt(2)
  v_mfma_f32_16x16x32_bf16 v[74:77], v[154:157], v[240:243], v[74:77]
  s_waitcnt lgkmcnt(0)
  v_mfma_f32_16x16x32_bf16 v[74:77], v[200:203], v[244:247], v[74:77]
  v_mfma_f32_16x16x32_bf16 v[78:81], v[216:219], v[244:247], v[78:81]
  v_mfma_f32_16x16x32_bf16 v[78:81], v[158:161], v[240:243], v[78:81]
  v_mfma_f32_16x16x32_bf16 v[82:85], v[162:165], v[240:243], v[82:85]
  v_mfma_f32_16x16x32_bf16 v[82:85], v[220:223], v[244:247], v[82:85]
  v_mfma_f32_16x16x32_bf16 v[86:89], v[224:227], v[244:247], v[86:89]
  v_mfma_f32_16x16x32_bf16 v[86:89], v[166:169], v[240:243], v[86:89]
  v_mfma_f32_16x16x32_bf16 v[90:93], v[170:173], v[240:243], v[90:93]
  v_mfma_f32_16x16x32_bf16 v[90:93], v[228:231], v[244:247], v[90:93]
  s_or_b32 s67, s2, 0
  s_cmp_eq_u32 s45, 0
  s_cselect_b32 s66, 6, 7
  s_mul_i32 s67, s67, 2
  s_add_u32 s67, s67, 1536
  s_mul_i32 s67, s67, s66
  s_mul_i32 s66, s66, 2
  s_sub_u32 s66, s66, 1
  s_cmp_eq_u32 s45, 3
  s_cselect_b32 s66, 0, s66
  v_min_u32 v210, s66, v1
  v_add_lshl_u32 v210, v210, s67, 7
  s_or_b32 s67, s2, 128
  s_sub_u32 s69, s45, 1
  s_cselect_b64 s[0:1], s[8:9], s[16:17]
  s_cselect_b32 s68, 16, 56
  s_cselect_b32 s69, 0, s69
  s_mul_i32 s69, s69, 19
  v_min_u32 v211, 18, v1
  v_add_u32 v211, s69, v211
  s_sub_u32 s69, s68, 1
  v_min_u32 v211, s69, v211
  s_mul_i32 s68, s68, s67
  v_and_b32 v3, 7, v211
  v_cmp_eq_u32 vcc, 3, v3
  v_add_lshl_u32 v211, v211, s68, 7
  v_xor_b32 v3, 128, v211
  v_cndmask_b32 v211, v211, v3, vcc
  s_lshl_b32 s66, s46, 13
  s_lshl2_add_u32 s66, s47, s66
  s_add_u32 s66, s66, 9437440
  v_lshl_add_u32 v33, v11, 9, s66
  v_lshrrev_b32 v3, 4, v1
  v_lshl_add_u32 v33, v3, 28, v33
  s_mul_i32 s66, s46, 589824
  s_add_u32 s66, s66, s52
  s_lshl_b32 s67, s47, 12
  s_add_u32 s57, s66, s67
  s_xor_b32 s67, s67, 8192
  s_add_u32 s55, s66, s67
  s_add_u32 s55, s55, 114688
  s_add_u32 s56, s55, 147456
  s_add_u32 s58, s57, 147456
  s_mul_i32 s69, s45, 20
  s_add_u32 s68, s69, 32
  s_lshl3_add_u32 s65, s45, s64
  s_lshr_b32 s67, 255, s60
  s_and_b32 s67, s67, s61
  s_bitcmp1_b32 s67, 0
  s_cselect_b32 s66, 10, 0
  s_cselect_b32 s5, -10, 10
  s_add_u32 s69, s69, s66
  s_add_u32 s68, s68, s66
  s_lshl_b32 s5, s5, 2
  s_mul_i32 s66, s61, 144
  s_add_u32 s66, s66, s68
  s_lshl_b32 s66, s66, 10
  v_and_b32 v3, 0x300, v2
  v_add3_u32 v9, v3, v2, s66
  v_lshrrev_b32 v4, 3, v1
  v_and_b32 v3, 6, v4
  v_bitop3_b32 v3, v3, v1, 7 bitop3:0x28
  v_lshlrev_b32 v3, 4, v3
  v_and_b32 v5, 4, v4
  v_add_u32_e64 v4, v4, v5
  s_lshl_b32 s60, s60, 7
  s_lshl_b32 s69, s69, 14
  s_add_u32 s69, s69, s60
  s_lshl_b32 s68, s68, 11
  s_add_u32 s68, s68, 9601024
  s_cmp_eq_u32 s60, 384
  s_cselect_b32 s69, s68, s69
  s_cselect_b32 s64, 9, 12
  s_cselect_b32 s67, 7, 10
  v_lshl_add_u32 v3, v4, s67, v3
  v_add_u32 v7, s69, v3
  v_lshrrev_b32 v3, 4, v0
  v_lshlrev_b32 v4, 3, v11
  v_lshl_add_u32 v3, v3, 10, v4
  s_lshl_b32 s66, s61, 15
  s_add_u32 s66, s66, s60
  v_add_u32 v8, s66, v3
  v_lshrrev_b32 v3, 5, v1
  v_lshl_add_u32 v3, v3, 13, s53
  v_bfe_u32 v4, v1, 2, 3
  v_lshl_add_u32 v3, v4, 7, v3
  v_bfe_u32 v4, v1, 3, 2
  v_lshl_add_u32 v3, v4, 5, v3
  v_and_b32_e64 v4, 3, v1
  v_lshl_add_u32 v12, v4, 3, v3
  v_xor_b32 v13, 32, v12
  v_xor_b32 v14, 64, v12
  v_xor_b32 v15, 96, v12
  v_add_u32 v212, 81920, v12
  v_add_u32 v213, 81920, v13
  v_add_u32 v214, 81920, v14
  v_add_u32 v215, 81920, v15
  v_add_u32 v196, 147456, v12
  v_add_u32 v197, 147456, v13
  v_add_u32 v198, 147456, v14
  v_add_u32 v199, 147456, v15
  s_lshl_b32 s66, s45, 6
  v_lshlrev_b32 v30, 4, v11
  v_lshl_add_u32 v5, v11, 2, s66
  v_and_b32 v31, 0x30, v1
  v_add_u32_e64 v3, s66, v31
  s_lshl_b32 s66, s45, 9
  v_lshl_add_u32 v10, v1, 3, s66
  v_lshrrev_b32 v182, 3, v1
  v_and_b32_e64 v182, 6, v182
  s_movk_i32 s66, 0x9c
  v_lshrrev_b32 v182, v182, s66
  v_lshrrev_b32_e64 v183, 2, v1
  v_bitop3_b32 v16, v182, v183, 3 bitop3:0x28
  v_lshrrev_b32 v183, 4, v0
  v_lshlrev_b32 v182, 2, v16
  v_sub_u32 v182, v182, v183
  s_add_u32 s66, s45, 64
  v_add_u32_e64 v182, s66, v182
  v_lshl_add_u32 v11, v182, 10, v8
  s_waitcnt vmcnt(5)
  s_barrier
  ds_read_b64_tr_b16 v[232:233], v25 offset:57344
  ds_read_b64_tr_b16 v[234:235], v25 offset:57856
  s_add_u32 m0, s52, 61440
  s_mov_b32 s48, 491520
  buffer_load_dwordx4 v21, s[28:31], s48 offen lds
  ds_read_b64_tr_b16 v[236:237], v26 offset:0
  ds_read_b64_tr_b16 v[238:239], v26 offset:512
  ds_read_b64_tr_b16 v[240:241], v26 offset:4096
  s_add_u32 m0, s53, 7808
  ds_read_b64_tr_b16 v[242:243], v26 offset:4608
  buffer_load_dwordx4 v18, s[20:23], s50 offen offset:384 lds
  ds_read_b64_tr_b16 v[244:245], v26 offset:8192
  ds_read_b64_tr_b16 v[246:247], v26 offset:8704
  s_add_u32 m0, s53, 16000
  ds_read_b64_tr_b16 v[248:249], v26 offset:12288
  buffer_load_dwordx4 v18, s[20:23], s51 offen offset:384 lds
  ds_read_b64_tr_b16 v[250:251], v26 offset:12800
  ds_read_b64_tr_b16 v[252:253], v26 offset:16384
  ds_read_b64_tr_b16 v[254:255], v26 offset:16896
  s_waitcnt lgkmcnt(10)
  v_mfma_f32_16x16x32_bf16 v[50:53], v[232:235], v[170:173], v[50:53]
  s_waitcnt lgkmcnt(8)
  v_mfma_f32_16x16x32_bf16 v[50:53], v[236:239], v[228:231], v[50:53]
  v_mfma_f32_16x16x32_bf16 v[46:49], v[236:239], v[224:227], v[46:49]
  v_mfma_f32_16x16x32_bf16 v[46:49], v[232:235], v[166:169], v[46:49]
  v_mfma_f32_16x16x32_bf16 v[42:45], v[232:235], v[162:165], v[42:45]
  v_mfma_f32_16x16x32_bf16 v[42:45], v[236:239], v[220:223], v[42:45]
  v_mfma_f32_16x16x32_bf16 v[38:41], v[236:239], v[216:219], v[38:41]
  v_mfma_f32_16x16x32_bf16 v[38:41], v[232:235], v[158:161], v[38:41]
  v_smfmac_f32_16x16x64_bf16 v[126:129], v[34:37], v[232:239], v32
  s_waitcnt lgkmcnt(6)
  v_mfma_f32_16x16x32_bf16 v[94:97], v[240:243], v[158:161], v[94:97]
  s_waitcnt lgkmcnt(4)
  v_mfma_f32_16x16x32_bf16 v[94:97], v[244:247], v[216:219], v[94:97]
  v_mfma_f32_16x16x32_bf16 v[98:101], v[244:247], v[220:223], v[98:101]
  v_mfma_f32_16x16x32_bf16 v[98:101], v[240:243], v[162:165], v[98:101]
  v_mfma_f32_16x16x32_bf16 v[102:105], v[240:243], v[166:169], v[102:105]
  v_mfma_f32_16x16x32_bf16 v[102:105], v[244:247], v[224:227], v[102:105]
  v_mfma_f32_16x16x32_bf16 v[106:109], v[244:247], v[228:231], v[106:109]
  v_mfma_f32_16x16x32_bf16 v[106:109], v[240:243], v[170:173], v[106:109]
  v_smfmac_f32_16x16x64_bf16 v[138:141], v[34:37], v[240:247], v32
  s_waitcnt lgkmcnt(2)
  v_mfma_f32_16x16x32_bf16 v[122:125], v[248:251], v[170:173], v[122:125]
  s_waitcnt lgkmcnt(0)
  v_mfma_f32_16x16x32_bf16 v[122:125], v[252:255], v[228:231], v[122:125]
  v_mfma_f32_16x16x32_bf16 v[118:121], v[252:255], v[224:227], v[118:121]
  v_mfma_f32_16x16x32_bf16 v[118:121], v[248:251], v[166:169], v[118:121]
  v_mfma_f32_16x16x32_bf16 v[114:117], v[248:251], v[162:165], v[114:117]
  v_mfma_f32_16x16x32_bf16 v[114:117], v[252:255], v[220:223], v[114:117]
  v_mfma_f32_16x16x32_bf16 v[110:113], v[252:255], v[216:219], v[110:113]
  v_mfma_f32_16x16x32_bf16 v[110:113], v[248:251], v[158:161], v[110:113]
  v_smfmac_f32_16x16x64_bf16 v[142:145], v[34:37], v[248:255], v32
  s_waitcnt vmcnt(4)
  s_barrier
  ds_read_b64_tr_b16 v[232:233], v26 offset:20480
  ds_read_b64_tr_b16 v[234:235], v26 offset:20992
  s_add_u32 m0, s52, 81920
  s_mov_b32 s48, 589824
  buffer_load_dwordx4 v20, s[24:27], s48 offen lds
  ds_read_b64_tr_b16 v[236:237], v26 offset:24576
  ds_read_b64_tr_b16 v[238:239], v26 offset:25088
  ds_read_b128 v[170:173], v23 offset:51200
  ds_read_b128 v[228:231], v24 offset:51200
  s_add_u32 m0, s52, 86016
  s_mov_b32 s48, 688128
  buffer_load_dwordx4 v20, s[24:27], s48 offen lds
  ds_read_b128 v[166:169], v23 offset:49152
  ds_read_b128 v[224:227], v24 offset:49152
  ds_read_b128 v[162:165], v23 offset:47104
  ds_read_b128 v[220:223], v24 offset:47104
  s_add_u32 m0, s52, 98304
  s_mov_b32 s48, 589824
  buffer_load_dwordx4 v21, s[28:31], s48 offen lds
  ds_read_b128 v[158:161], v23 offset:45056
  ds_read_b128 v[216:219], v24 offset:45056
  ds_read_b128 v[154:157], v23 offset:43008
  ds_read_b128 v[200:203], v24 offset:43008
  s_add_u32 m0, s52, 102400
  s_mov_b32 s48, 688128
  buffer_load_dwordx4 v21, s[28:31], s48 offen lds
  ds_read_b64_tr_b16 v[240:241], v26 offset:28672
  ds_read_b64_tr_b16 v[242:243], v26 offset:29184
  ds_read_b64_tr_b16 v[244:245], v26 offset:32768
  ds_read_b64_tr_b16 v[246:247], v26 offset:33280
  s_waitcnt lgkmcnt(13)
  v_mfma_f32_16x16x32_bf16 v[70:73], v[232:235], v[170:173], v[70:73]
  s_waitcnt lgkmcnt(12)
  v_mfma_f32_16x16x32_bf16 v[70:73], v[236:239], v[228:231], v[70:73]
  s_waitcnt lgkmcnt(10)
  v_mfma_f32_16x16x32_bf16 v[66:69], v[236:239], v[224:227], v[66:69]
  v_mfma_f32_16x16x32_bf16 v[66:69], v[232:235], v[166:169], v[66:69]
  s_waitcnt lgkmcnt(9)
  v_mfma_f32_16x16x32_bf16 v[62:65], v[232:235], v[162:165], v[62:65]
  s_waitcnt lgkmcnt(8)
  v_mfma_f32_16x16x32_bf16 v[62:65], v[236:239], v[220:223], v[62:65]
  s_waitcnt lgkmcnt(6)
  v_mfma_f32_16x16x32_bf16 v[58:61], v[236:239], v[216:219], v[58:61]
  v_mfma_f32_16x16x32_bf16 v[58:61], v[232:235], v[158:161], v[58:61]
  s_waitcnt lgkmcnt(5)
  v_mfma_f32_16x16x32_bf16 v[54:57], v[232:235], v[154:157], v[54:57]
  s_waitcnt lgkmcnt(4)
  v_mfma_f32_16x16x32_bf16 v[54:57], v[236:239], v[200:203], v[54:57]
  s_waitcnt lgkmcnt(2)
  v_mfma_f32_16x16x32_bf16 v[74:77], v[154:157], v[240:243], v[74:77]
  s_waitcnt lgkmcnt(0)
  v_mfma_f32_16x16x32_bf16 v[74:77], v[200:203], v[244:247], v[74:77]
  v_mfma_f32_16x16x32_bf16 v[78:81], v[216:219], v[244:247], v[78:81]
  v_mfma_f32_16x16x32_bf16 v[78:81], v[158:161], v[240:243], v[78:81]
  v_mfma_f32_16x16x32_bf16 v[82:85], v[162:165], v[240:243], v[82:85]
  v_mfma_f32_16x16x32_bf16 v[82:85], v[220:223], v[244:247], v[82:85]
  v_mfma_f32_16x16x32_bf16 v[86:89], v[224:227], v[244:247], v[86:89]
  v_mfma_f32_16x16x32_bf16 v[86:89], v[166:169], v[240:243], v[86:89]
  v_mfma_f32_16x16x32_bf16 v[90:93], v[170:173], v[240:243], v[90:93]
  v_mfma_f32_16x16x32_bf16 v[90:93], v[228:231], v[244:247], v[90:93]
  s_waitcnt vmcnt(6)
  s_barrier
  ds_read_b64_tr_b16 v[232:233], v26 offset:36864
  ds_read_b64_tr_b16 v[234:235], v26 offset:37376
  s_add_u32 m0, s53, 26112
  ds_read_b64_tr_b16 v[236:237], v25 offset:0
  buffer_load_dwordx4 v18, s[20:23], s50 offen offset:512 lds
  ds_read_b64_tr_b16 v[238:239], v25 offset:512
  s_add_u32 m0, s53, 34304
  ds_read_b64_tr_b16 v[240:241], v25 offset:4096
  buffer_load_dwordx4 v18, s[20:23], s51 offen offset:512 lds
  ds_read_b64_tr_b16 v[242:243], v25 offset:4608
  ds_read_b64_tr_b16 v[244:245], v25 offset:8192
  s_add_u32 m0, s52, 122880
  s_mov_b32 s48, 786432
  buffer_load_dwordx4 v20, s[24:27], s48 offen lds
  ds_read_b64_tr_b16 v[246:247], v25 offset:8704
  ds_read_b64_tr_b16 v[248:249], v25 offset:12288
  global_load_dword v177, v210, s[6:7]
  ds_read_b64_tr_b16 v[250:251], v25 offset:12800
  ds_read_b64_tr_b16 v[252:253], v25 offset:16384
  ds_read_b64_tr_b16 v[254:255], v25 offset:16896
  s_waitcnt lgkmcnt(10)
  v_mfma_f32_16x16x32_bf16 v[50:53], v[232:235], v[170:173], v[50:53]
  s_waitcnt lgkmcnt(8)
  v_mfma_f32_16x16x32_bf16 v[50:53], v[236:239], v[228:231], v[50:53]
  v_mfma_f32_16x16x32_bf16 v[46:49], v[236:239], v[224:227], v[46:49]
  v_mfma_f32_16x16x32_bf16 v[46:49], v[232:235], v[166:169], v[46:49]
  v_mfma_f32_16x16x32_bf16 v[42:45], v[232:235], v[162:165], v[42:45]
  v_mfma_f32_16x16x32_bf16 v[42:45], v[236:239], v[220:223], v[42:45]
  v_mfma_f32_16x16x32_bf16 v[38:41], v[236:239], v[216:219], v[38:41]
  v_mfma_f32_16x16x32_bf16 v[38:41], v[232:235], v[158:161], v[38:41]
  v_smfmac_f32_16x16x64_bf16 v[126:129], v[34:37], v[232:239], v32
  s_waitcnt lgkmcnt(6)
  v_mfma_f32_16x16x32_bf16 v[94:97], v[240:243], v[158:161], v[94:97]
  s_waitcnt lgkmcnt(4)
  v_mfma_f32_16x16x32_bf16 v[94:97], v[244:247], v[216:219], v[94:97]
  v_mfma_f32_16x16x32_bf16 v[98:101], v[244:247], v[220:223], v[98:101]
L_A0w0:
  s_cbranch_execz L_A0w1
  s_nop 0
  v_mfma_f32_16x16x32_bf16 v[98:101], v[240:243], v[162:165], v[98:101]
  v_mfma_f32_16x16x32_bf16 v[102:105], v[240:243], v[166:169], v[102:105]
  v_mfma_f32_16x16x32_bf16 v[102:105], v[244:247], v[224:227], v[102:105]
  v_mfma_f32_16x16x32_bf16 v[106:109], v[244:247], v[228:231], v[106:109]
  v_mfma_f32_16x16x32_bf16 v[106:109], v[240:243], v[170:173], v[106:109]
  v_smfmac_f32_16x16x64_bf16 v[138:141], v[34:37], v[240:247], v32
  s_waitcnt lgkmcnt(2)
  v_mfma_f32_16x16x32_bf16 v[122:125], v[248:251], v[170:173], v[122:125]
  s_waitcnt lgkmcnt(0)
  v_mfma_f32_16x16x32_bf16 v[122:125], v[252:255], v[228:231], v[122:125]
  v_mfma_f32_16x16x32_bf16 v[118:121], v[252:255], v[224:227], v[118:121]
  v_mfma_f32_16x16x32_bf16 v[118:121], v[248:251], v[166:169], v[118:121]
  v_mfma_f32_16x16x32_bf16 v[114:117], v[248:251], v[162:165], v[114:117]
  v_mfma_f32_16x16x32_bf16 v[114:117], v[252:255], v[220:223], v[114:117]
  v_mfma_f32_16x16x32_bf16 v[110:113], v[252:255], v[216:219], v[110:113]
  v_mfma_f32_16x16x32_bf16 v[110:113], v[248:251], v[158:161], v[110:113]
  v_smfmac_f32_16x16x64_bf16 v[142:145], v[34:37], v[248:255], v32
  s_waitcnt vmcnt(6)
  s_barrier
  ds_read_b64_tr_b16 v[232:233], v25 offset:20480
  ds_read_b64_tr_b16 v[234:235], v25 offset:20992
  s_add_u32 m0, s52, 126976
  s_mov_b32 s48, 884736
  buffer_load_dwordx4 v20, s[24:27], s48 offen lds
  ds_read_b64_tr_b16 v[236:237], v25 offset:24576
  ds_read_b64_tr_b16 v[238:239], v25 offset:25088
  ds_read_b128 v[170:173], v23 offset:14336
  ds_read_b128 v[228:231], v24 offset:14336
  s_add_u32 m0, s52, 139264
  s_mov_b32 s48, 786432
  buffer_load_dwordx4 v21, s[28:31], s48 offen lds
  ds_read_b128 v[166:169], v23 offset:12288
  ds_read_b128 v[224:227], v24 offset:12288
  ds_read_b128 v[162:165], v23 offset:10240
  ds_read_b128 v[220:223], v24 offset:10240
  s_add_u32 m0, s52, 143360
  s_mov_b32 s48, 884736
  buffer_load_dwordx4 v21, s[28:31], s48 offen lds
  ds_read_b128 v[158:161], v23 offset:8192
  ds_read_b128 v[216:219], v24 offset:8192
  ds_read_b128 v[154:157], v23 offset:6144
  ds_read_b128 v[200:203], v24 offset:6144
  s_add_u32 m0, s53, 44416
  ds_read_b64_tr_b16 v[240:241], v25 offset:28672
  buffer_load_dwordx4 v18, s[20:23], s50 offen offset:640 lds
  ds_read_b64_tr_b16 v[242:243], v25 offset:29184
  ds_read_b64_tr_b16 v[244:245], v25 offset:32768
  ds_read_b64_tr_b16 v[246:247], v25 offset:33280
  s_waitcnt lgkmcnt(13)
  v_mfma_f32_16x16x32_bf16 v[70:73], v[232:235], v[170:173], v[70:73]
  s_waitcnt lgkmcnt(12)
  v_mfma_f32_16x16x32_bf16 v[70:73], v[236:239], v[228:231], v[70:73]
  s_waitcnt lgkmcnt(10)
  v_mfma_f32_16x16x32_bf16 v[66:69], v[236:239], v[224:227], v[66:69]
  v_mfma_f32_16x16x32_bf16 v[66:69], v[232:235], v[166:169], v[66:69]
  s_waitcnt lgkmcnt(9)
  v_mfma_f32_16x16x32_bf16 v[62:65], v[232:235], v[162:165], v[62:65]
  s_waitcnt lgkmcnt(8)
  v_mfma_f32_16x16x32_bf16 v[62:65], v[236:239], v[220:223], v[62:65]
  s_waitcnt lgkmcnt(6)
  v_mfma_f32_16x16x32_bf16 v[58:61], v[236:239], v[216:219], v[58:61]
  v_mfma_f32_16x16x32_bf16 v[58:61], v[232:235], v[158:161], v[58:61]
  s_waitcnt lgkmcnt(5)
  v_mfma_f32_16x16x32_bf16 v[54:57], v[232:235], v[154:157], v[54:57]
  s_waitcnt lgkmcnt(4)
  v_mfma_f32_16x16x32_bf16 v[54:57], v[236:239], v[200:203], v[54:57]
  s_waitcnt lgkmcnt(2)
  v_mfma_f32_16x16x32_bf16 v[74:77], v[154:157], v[240:243], v[74:77]
  s_waitcnt lgkmcnt(0)
  v_mfma_f32_16x16x32_bf16 v[74:77], v[200:203], v[244:247], v[74:77]
  v_mfma_f32_16x16x32_bf16 v[78:81], v[216:219], v[244:247], v[78:81]
  v_mfma_f32_16x16x32_bf16 v[78:81], v[158:161], v[240:243], v[78:81]
  v_mfma_f32_16x16x32_bf16 v[82:85], v[162:165], v[240:243], v[82:85]
  v_mfma_f32_16x16x32_bf16 v[82:85], v[220:223], v[244:247], v[82:85]
  v_mfma_f32_16x16x32_bf16 v[86:89], v[224:227], v[244:247], v[86:89]
  v_mfma_f32_16x16x32_bf16 v[86:89], v[166:169], v[240:243], v[86:89]
  v_mfma_f32_16x16x32_bf16 v[90:93], v[170:173], v[240:243], v[90:93]
  v_mfma_f32_16x16x32_bf16 v[90:93], v[228:231], v[244:247], v[90:93]
  s_waitcnt vmcnt(8)
  s_barrier
  ds_read_b64_tr_b16 v[232:233], v25 offset:36864
  ds_read_b64_tr_b16 v[234:235], v25 offset:37376
  s_add_u32 m0, s53, 52608
  ds_read_b64_tr_b16 v[236:237], v25 offset:40960
  buffer_load_dwordx4 v18, s[20:23], s51 offen offset:640 lds
  ds_read_b64_tr_b16 v[238:239], v25 offset:41472
  ds_read_b64_tr_b16 v[240:241], v25 offset:45056
  s_add_u32 m0, s52, 61440
  s_mov_b32 s48, 983040
  buffer_load_dwordx4 v20, s[24:27], s48 offen lds
  ds_read_b64_tr_b16 v[242:243], v25 offset:45568
  ds_read_b64_tr_b16 v[244:245], v25 offset:49152
  ds_read_b64_tr_b16 v[246:247], v25 offset:49664
  s_add_u32 m0, s52, 65536
  s_mov_b32 s48, 1081344
  buffer_load_dwordx4 v20, s[24:27], s48 offen lds
  ds_read_b64_tr_b16 v[248:249], v25 offset:53248
  ds_read_b64_tr_b16 v[250:251], v25 offset:53760
  ds_read_b64_tr_b16 v[252:253], v25 offset:57344
  ds_read_b64_tr_b16 v[254:255], v25 offset:57856
  s_waitcnt lgkmcnt(10)
  v_mfma_f32_16x16x32_bf16 v[50:53], v[232:235], v[170:173], v[50:53]
  s_waitcnt lgkmcnt(8)
  v_mfma_f32_16x16x32_bf16 v[50:53], v[236:239], v[228:231], v[50:53]
  v_mfma_f32_16x16x32_bf16 v[46:49], v[236:239], v[224:227], v[46:49]
  v_mfma_f32_16x16x32_bf16 v[46:49], v[232:235], v[166:169], v[46:49]
  v_mfma_f32_16x16x32_bf16 v[42:45], v[232:235], v[162:165], v[42:45]
  v_mfma_f32_16x16x32_bf16 v[42:45], v[236:239], v[220:223], v[42:45]
  v_mfma_f32_16x16x32_bf16 v[38:41], v[236:239], v[216:219], v[38:41]
  v_mfma_f32_16x16x32_bf16 v[38:41], v[232:235], v[158:161], v[38:41]
  v_smfmac_f32_16x16x64_bf16 v[126:129], v[34:37], v[232:239], v32
  s_waitcnt lgkmcnt(6)
  v_mfma_f32_16x16x32_bf16 v[94:97], v[240:243], v[158:161], v[94:97]
  s_waitcnt lgkmcnt(4)
  v_mfma_f32_16x16x32_bf16 v[94:97], v[244:247], v[216:219], v[94:97]
  v_mfma_f32_16x16x32_bf16 v[98:101], v[244:247], v[220:223], v[98:101]
  v_mfma_f32_16x16x32_bf16 v[98:101], v[240:243], v[162:165], v[98:101]
  v_mfma_f32_16x16x32_bf16 v[102:105], v[240:243], v[166:169], v[102:105]
  v_mfma_f32_16x16x32_bf16 v[102:105], v[244:247], v[224:227], v[102:105]
  v_mfma_f32_16x16x32_bf16 v[106:109], v[244:247], v[228:231], v[106:109]
  v_mfma_f32_16x16x32_bf16 v[106:109], v[240:243], v[170:173], v[106:109]
  v_smfmac_f32_16x16x64_bf16 v[138:141], v[34:37], v[240:247], v32
  s_waitcnt lgkmcnt(2)
  v_mfma_f32_16x16x32_bf16 v[122:125], v[248:251], v[170:173], v[122:125]
  s_waitcnt lgkmcnt(0)
  v_mfma_f32_16x16x32_bf16 v[122:125], v[252:255], v[228:231], v[122:125]
  v_mfma_f32_16x16x32_bf16 v[118:121], v[252:255], v[224:227], v[118:121]
  v_mfma_f32_16x16x32_bf16 v[118:121], v[248:251], v[166:169], v[118:121]
  v_mfma_f32_16x16x32_bf16 v[114:117], v[248:251], v[162:165], v[114:117]
  v_mfma_f32_16x16x32_bf16 v[114:117], v[252:255], v[220:223], v[114:117]
  v_mfma_f32_16x16x32_bf16 v[110:113], v[252:255], v[216:219], v[110:113]
  v_mfma_f32_16x16x32_bf16 v[110:113], v[248:251], v[158:161], v[110:113]
  v_smfmac_f32_16x16x64_bf16 v[142:145], v[34:37], v[248:255], v32
  s_waitcnt vmcnt(6)
  s_barrier
  ds_read_b64_tr_b16 v[232:233], v26 offset:0
  ds_read_b64_tr_b16 v[234:235], v26 offset:512
  s_add_u32 m0, s52, 77824
  s_mov_b32 s48, 983040
  buffer_load_dwordx4 v21, s[28:31], s48 offen lds
  ds_read_b64_tr_b16 v[236:237], v26 offset:4096
  ds_read_b64_tr_b16 v[238:239], v26 offset:4608
  ds_read_b128 v[170:173], v23 offset:32768
  s_add_u32 m0, s52, 81920
  s_mov_b32 s48, 1081344
  buffer_load_dwordx4 v21, s[28:31], s48 offen lds
  ds_read_b128 v[228:231], v24 offset:32768
  ds_read_b128 v[166:169], v23 offset:30720
  ds_read_b128 v[224:227], v24 offset:30720
  s_add_u32 m0, s53, 7424
  ds_read_b128 v[162:165], v23 offset:28672
  buffer_load_dwordx4 v18, s[20:23], s50 offen offset:768 lds
  ds_read_b128 v[220:223], v24 offset:28672
  ds_read_b128 v[158:161], v23 offset:26624
  s_add_u32 m0, s53, 15616
  ds_read_b128 v[216:219], v24 offset:26624
  buffer_load_dwordx4 v18, s[20:23], s51 offen offset:768 lds
  ds_read_b128 v[154:157], v23 offset:24576
  ds_read_b128 v[200:203], v24 offset:24576
  s_bitcmp1_b32 s2, 7
  s_cbranch_scc1 L_A0p3
  global_load_dword v177, v211, s[0:1]
L_A0p3:
  ds_read_b64_tr_b16 v[240:241], v26 offset:8192
  ds_read_b64_tr_b16 v[242:243], v26 offset:8704
  ds_read_b64_tr_b16 v[244:245], v26 offset:12288
  ds_read_b64_tr_b16 v[246:247], v26 offset:12800
  s_waitcnt lgkmcnt(13)
  v_mfma_f32_16x16x32_bf16 v[70:73], v[232:235], v[170:173], v[70:73]
  s_waitcnt lgkmcnt(12)
  v_mfma_f32_16x16x32_bf16 v[70:73], v[236:239], v[228:231], v[70:73]
  s_waitcnt lgkmcnt(10)
  v_mfma_f32_16x16x32_bf16 v[66:69], v[236:239], v[224:227], v[66:69]
  v_mfma_f32_16x16x32_bf16 v[66:69], v[232:235], v[166:169], v[66:69]
  s_waitcnt lgkmcnt(9)
  v_mfma_f32_16x16x32_bf16 v[62:65], v[232:235], v[162:165], v[62:65]
  s_waitcnt lgkmcnt(8)
  v_mfma_f32_16x16x32_bf16 v[62:65], v[236:239], v[220:223], v[62:65]
  s_waitcnt lgkmcnt(6)
  v_mfma_f32_16x16x32_bf16 v[58:61], v[236:239], v[216:219], v[58:61]
  v_mfma_f32_16x16x32_bf16 v[58:61], v[232:235], v[158:161], v[58:61]
  s_waitcnt lgkmcnt(5)
  v_mfma_f32_16x16x32_bf16 v[54:57], v[232:235], v[154:157], v[54:57]
  s_waitcnt lgkmcnt(4)
  v_mfma_f32_16x16x32_bf16 v[54:57], v[236:239], v[200:203], v[54:57]
  s_waitcnt lgkmcnt(2)
  v_mfma_f32_16x16x32_bf16 v[74:77], v[154:157], v[240:243], v[74:77]
  s_waitcnt lgkmcnt(0)
  v_mfma_f32_16x16x32_bf16 v[74:77], v[200:203], v[244:247], v[74:77]
  v_mfma_f32_16x16x32_bf16 v[78:81], v[216:219], v[244:247], v[78:81]
  v_mfma_f32_16x16x32_bf16 v[78:81], v[158:161], v[240:243], v[78:81]
  v_mfma_f32_16x16x32_bf16 v[82:85], v[162:165], v[240:243], v[82:85]
  v_mfma_f32_16x16x32_bf16 v[82:85], v[220:223], v[244:247], v[82:85]
  v_mfma_f32_16x16x32_bf16 v[86:89], v[224:227], v[244:247], v[86:89]
  v_mfma_f32_16x16x32_bf16 v[86:89], v[166:169], v[240:243], v[86:89]
  v_mfma_f32_16x16x32_bf16 v[90:93], v[170:173], v[240:243], v[90:93]
  v_mfma_f32_16x16x32_bf16 v[90:93], v[228:231], v[244:247], v[90:93]
  s_waitcnt vmcnt(8)
  s_barrier
  ds_read_b64_tr_b16 v[232:233], v26 offset:16384
  ds_read_b64_tr_b16 v[234:235], v26 offset:16896
  s_add_u32 m0, s52, 102400
  s_mov_b32 s48, 1179648
  buffer_load_dwordx4 v20, s[24:27], s48 offen lds
  ds_read_b64_tr_b16 v[236:237], v26 offset:20480
  ds_read_b64_tr_b16 v[238:239], v26 offset:20992
  ds_read_b64_tr_b16 v[240:241], v26 offset:24576
  s_add_u32 m0, s52, 106496
  s_mov_b32 s48, 1277952
  buffer_load_dwordx4 v20, s[24:27], s48 offen lds
  ds_read_b64_tr_b16 v[242:243], v26 offset:25088
  ds_read_b64_tr_b16 v[244:245], v26 offset:28672
  ds_read_b64_tr_b16 v[246:247], v26 offset:29184
  s_add_u32 m0, s52, 118784
  s_mov_b32 s48, 1179648
  buffer_load_dwordx4 v21, s[28:31], s48 offen lds
  ds_read_b64_tr_b16 v[248:249], v26 offset:32768
  ds_read_b64_tr_b16 v[250:251], v26 offset:33280
  ds_read_b64_tr_b16 v[252:253], v26 offset:36864
  ds_read_b64_tr_b16 v[254:255], v26 offset:37376
  s_waitcnt lgkmcnt(10)
  v_mfma_f32_16x16x32_bf16 v[50:53], v[232:235], v[170:173], v[50:53]
  s_waitcnt lgkmcnt(8)
  v_mfma_f32_16x16x32_bf16 v[50:53], v[236:239], v[228:231], v[50:53]
  v_mfma_f32_16x16x32_bf16 v[46:49], v[236:239], v[224:227], v[46:49]
  v_mfma_f32_16x16x32_bf16 v[46:49], v[232:235], v[166:169], v[46:49]
  v_mfma_f32_16x16x32_bf16 v[42:45], v[232:235], v[162:165], v[42:45]
  v_mfma_f32_16x16x32_bf16 v[42:45], v[236:239], v[220:223], v[42:45]
  v_mfma_f32_16x16x32_bf16 v[38:41], v[236:239], v[216:219], v[38:41]
  v_mfma_f32_16x16x32_bf16 v[38:41], v[232:235], v[158:161], v[38:41]
  v_smfmac_f32_16x16x64_bf16 v[126:129], v[34:37], v[232:239], v32
  s_waitcnt lgkmcnt(6)
  v_mfma_f32_16x16x32_bf16 v[94:97], v[240:243], v[158:161], v[94:97]
  s_waitcnt lgkmcnt(4)
  v_mfma_f32_16x16x32_bf16 v[94:97], v[244:247], v[216:219], v[94:97]
  v_mfma_f32_16x16x32_bf16 v[98:101], v[244:247], v[220:223], v[98:101]
  v_mfma_f32_16x16x32_bf16 v[98:101], v[240:243], v[162:165], v[98:101]
  v_mfma_f32_16x16x32_bf16 v[102:105], v[240:243], v[166:169], v[102:105]
  v_mfma_f32_16x16x32_bf16 v[102:105], v[244:247], v[224:227], v[102:105]
  v_mfma_f32_16x16x32_bf16 v[106:109], v[244:247], v[228:231], v[106:109]
  v_mfma_f32_16x16x32_bf16 v[106:109], v[240:243], v[170:173], v[106:109]
  v_smfmac_f32_16x16x64_bf16 v[138:141], v[34:37], v[240:247], v32
  s_waitcnt lgkmcnt(2)
  v_mfma_f32_16x16x32_bf16 v[122:125], v[248:251], v[170:173], v[122:125]
  s_waitcnt lgkmcnt(0)
  v_mfma_f32_16x16x32_bf16 v[122:125], v[252:255], v[228:231], v[122:125]
  v_mfma_f32_16x16x32_bf16 v[118:121], v[252:255], v[224:227], v[118:121]
  v_mfma_f32_16x16x32_bf16 v[118:121], v[248:251], v[166:169], v[118:121]
  v_mfma_f32_16x16x32_bf16 v[114:117], v[248:251], v[162:165], v[114:117]
  v_mfma_f32_16x16x32_bf16 v[114:117], v[252:255], v[220:223], v[114:117]
  v_mfma_f32_16x16x32_bf16 v[110:113], v[252:255], v[216:219], v[110:113]
  v_mfma_f32_16x16x32_bf16 v[110:113], v[248:251], v[158:161], v[110:113]
  v_smfmac_f32_16x16x64_bf16 v[142:145], v[34:37], v[248:255], v32
  s_waitcnt vmcnt(7)
  s_barrier
  ds_read_b64_tr_b16 v[232:233], v25 offset:0
  ds_read_b64_tr_b16 v[234:235], v25 offset:512
  s_add_u32 m0, s52, 122880
  s_mov_b32 s48, 1277952
  buffer_load_dwordx4 v21, s[28:31], s48 offen lds
  ds_read_b64_tr_b16 v[236:237], v25 offset:4096
  ds_read_b64_tr_b16 v[238:239], v25 offset:4608
  ds_read_b128 v[170:173], v23 offset:51200
  ds_read_b128 v[228:231], v24 offset:51200
  s_add_u32 m0, s53, 25728
  ds_read_b128 v[166:169], v23 offset:49152
  buffer_load_dwordx4 v18, s[20:23], s50 offen offset:896 lds
  ds_read_b128 v[224:227], v24 offset:49152
  ds_read_b128 v[162:165], v23 offset:47104
  ds_read_b128 v[220:223], v24 offset:47104
  s_add_u32 m0, s53, 33920
  ds_read_b128 v[158:161], v23 offset:45056
  buffer_load_dwordx4 v18, s[20:23], s51 offen offset:896 lds
  ds_read_b128 v[216:219], v24 offset:45056
  ds_read_b128 v[154:157], v23 offset:43008
  ds_read_b128 v[200:203], v24 offset:43008
  s_add_u32 m0, s52, 143360
  s_mov_b32 s48, 1376256
  buffer_load_dwordx4 v20, s[24:27], s48 offen lds
  ds_read_b64_tr_b16 v[240:241], v25 offset:8192
  ds_read_b64_tr_b16 v[242:243], v25 offset:8704
  ds_read_b64_tr_b16 v[244:245], v25 offset:12288
  ds_read_b64_tr_b16 v[246:247], v25 offset:12800
  s_waitcnt lgkmcnt(13)
  v_mfma_f32_16x16x32_bf16 v[70:73], v[232:235], v[170:173], v[70:73]
  s_waitcnt lgkmcnt(12)
  v_mfma_f32_16x16x32_bf16 v[70:73], v[236:239], v[228:231], v[70:73]
  s_waitcnt lgkmcnt(10)
  v_mfma_f32_16x16x32_bf16 v[66:69], v[236:239], v[224:227], v[66:69]
  v_mfma_f32_16x16x32_bf16 v[66:69], v[232:235], v[166:169], v[66:69]
  s_waitcnt lgkmcnt(9)
  v_mfma_f32_16x16x32_bf16 v[62:65], v[232:235], v[162:165], v[62:65]
  s_waitcnt lgkmcnt(8)
  v_mfma_f32_16x16x32_bf16 v[62:65], v[236:239], v[220:223], v[62:65]
  s_waitcnt lgkmcnt(6)
  v_mfma_f32_16x16x32_bf16 v[58:61], v[236:239], v[216:219], v[58:61]
  v_mfma_f32_16x16x32_bf16 v[58:61], v[232:235], v[158:161], v[58:61]
  s_waitcnt lgkmcnt(5)
  v_mfma_f32_16x16x32_bf16 v[54:57], v[232:235], v[154:157], v[54:57]
  s_waitcnt lgkmcnt(4)
  v_mfma_f32_16x16x32_bf16 v[54:57], v[236:239], v[200:203], v[54:57]
  s_waitcnt lgkmcnt(2)
  v_mfma_f32_16x16x32_bf16 v[74:77], v[154:157], v[240:243], v[74:77]
  s_waitcnt lgkmcnt(0)
  v_mfma_f32_16x16x32_bf16 v[74:77], v[200:203], v[244:247], v[74:77]
  v_mfma_f32_16x16x32_bf16 v[78:81], v[216:219], v[244:247], v[78:81]
  v_mfma_f32_16x16x32_bf16 v[78:81], v[158:161], v[240:243], v[78:81]
  v_mfma_f32_16x16x32_bf16 v[82:85], v[162:165], v[240:243], v[82:85]
  v_mfma_f32_16x16x32_bf16 v[82:85], v[220:223], v[244:247], v[82:85]
  v_mfma_f32_16x16x32_bf16 v[86:89], v[224:227], v[244:247], v[86:89]
  v_mfma_f32_16x16x32_bf16 v[86:89], v[166:169], v[240:243], v[86:89]
  v_mfma_f32_16x16x32_bf16 v[90:93], v[170:173], v[240:243], v[90:93]
  v_mfma_f32_16x16x32_bf16 v[90:93], v[228:231], v[244:247], v[90:93]
  s_waitcnt vmcnt(9)
  s_barrier
  ds_read_b64_tr_b16 v[232:233], v25 offset:16384
  ds_read_b64_tr_b16 v[234:235], v25 offset:16896
  s_add_u32 m0, s52, 147456
  s_mov_b32 s48, 1474560
  buffer_load_dwordx4 v20, s[24:27], s48 offen lds
  ds_read_b64_tr_b16 v[236:237], v25 offset:20480
  ds_read_b64_tr_b16 v[238:239], v25 offset:20992
  ds_read_b64_tr_b16 v[240:241], v25 offset:24576
  s_add_u32 m0, s52, 159744
  s_mov_b32 s48, 1376256
  buffer_load_dwordx4 v21, s[28:31], s48 offen lds
  ds_read_b64_tr_b16 v[242:243], v25 offset:25088
  ds_read_b64_tr_b16 v[244:245], v25 offset:28672
  ds_read_b64_tr_b16 v[246:247], v25 offset:29184
  s_add_u32 m0, s52, 61440
  s_mov_b32 s48, 1474560
  buffer_load_dwordx4 v21, s[28:31], s48 offen lds
  ds_read_b64_tr_b16 v[248:249], v25 offset:32768
  ds_read_b64_tr_b16 v[250:251], v25 offset:33280
  ds_read_b64_tr_b16 v[252:253], v25 offset:36864
  ds_read_b64_tr_b16 v[254:255], v25 offset:37376
  s_waitcnt lgkmcnt(10)
  v_mfma_f32_16x16x32_bf16 v[50:53], v[232:235], v[170:173], v[50:53]
  s_waitcnt lgkmcnt(8)
  v_mfma_f32_16x16x32_bf16 v[50:53], v[236:239], v[228:231], v[50:53]
  v_mfma_f32_16x16x32_bf16 v[46:49], v[236:239], v[224:227], v[46:49]
  v_mfma_f32_16x16x32_bf16 v[46:49], v[232:235], v[166:169], v[46:49]
  v_mfma_f32_16x16x32_bf16 v[42:45], v[232:235], v[162:165], v[42:45]
  v_mfma_f32_16x16x32_bf16 v[42:45], v[236:239], v[220:223], v[42:45]
  v_mfma_f32_16x16x32_bf16 v[38:41], v[236:239], v[216:219], v[38:41]
  v_mfma_f32_16x16x32_bf16 v[38:41], v[232:235], v[158:161], v[38:41]
  v_smfmac_f32_16x16x64_bf16 v[126:129], v[34:37], v[232:239], v32
  s_waitcnt lgkmcnt(6)
  v_mfma_f32_16x16x32_bf16 v[94:97], v[240:243], v[158:161], v[94:97]
  s_waitcnt lgkmcnt(4)
  v_mfma_f32_16x16x32_bf16 v[94:97], v[244:247], v[216:219], v[94:97]
  v_mfma_f32_16x16x32_bf16 v[98:101], v[244:247], v[220:223], v[98:101]
  v_mfma_f32_16x16x32_bf16 v[98:101], v[240:243], v[162:165], v[98:101]
  v_mfma_f32_16x16x32_bf16 v[102:105], v[240:243], v[166:169], v[102:105]
  v_mfma_f32_16x16x32_bf16 v[102:105], v[244:247], v[224:227], v[102:105]
  v_mfma_f32_16x16x32_bf16 v[106:109], v[244:247], v[228:231], v[106:109]
  v_mfma_f32_16x16x32_bf16 v[106:109], v[240:243], v[170:173], v[106:109]
  v_smfmac_f32_16x16x64_bf16 v[138:141], v[34:37], v[240:247], v32
  s_waitcnt lgkmcnt(2)
  v_mfma_f32_16x16x32_bf16 v[122:125], v[248:251], v[170:173], v[122:125]
  s_waitcnt lgkmcnt(0)
  v_mfma_f32_16x16x32_bf16 v[122:125], v[252:255], v[228:231], v[122:125]
  v_mfma_f32_16x16x32_bf16 v[118:121], v[252:255], v[224:227], v[118:121]
  v_mfma_f32_16x16x32_bf16 v[118:121], v[248:251], v[166:169], v[118:121]
  v_mfma_f32_16x16x32_bf16 v[114:117], v[248:251], v[162:165], v[114:117]
  v_mfma_f32_16x16x32_bf16 v[114:117], v[252:255], v[220:223], v[114:117]
  v_mfma_f32_16x16x32_bf16 v[110:113], v[252:255], v[216:219], v[110:113]
  v_mfma_f32_16x16x32_bf16 v[110:113], v[248:251], v[158:161], v[110:113]
  v_smfmac_f32_16x16x64_bf16 v[142:145], v[34:37], v[248:255], v32
  s_waitcnt vmcnt(8)
  s_barrier
  ds_read_b64_tr_b16 v[232:233], v25 offset:40960
  ds_read_b64_tr_b16 v[234:235], v25 offset:41472
  s_cmp_eq_u32 s64, 9
  s_cselect_b64 s[16:17], s[40:41], s[16:17]
  s_cselect_b32 s18, s42, s18
  s_add_u32 m0, s53, 43008
  s_lshl_b32 s60, 0, s64
  buffer_load_dwordx4 v7, s[16:19], s60 offen lds
  ds_read_b64_tr_b16 v[236:237], v25 offset:45056
  ds_read_b64_tr_b16 v[238:239], v25 offset:45568
  ds_read_b128 v[170:173], v23 offset:14336
  ds_read_b128 v[228:231], v24 offset:14336
  s_add_u32 m0, s53, 51200
  s_lshl_b32 s60, 4, s64
  buffer_load_dwordx4 v7, s[16:19], s60 offen lds
  ds_read_b128 v[166:169], v23 offset:12288
  ds_read_b128 v[224:227], v24 offset:12288
  ds_read_b128 v[162:165], v23 offset:10240
  ds_read_b128 v[220:223], v24 offset:10240
  s_add_u32 m0, s53, 81920
  s_lshl_b32 s60, 1, s64
  buffer_load_dwordx4 v7, s[16:19], s60 offen lds
  ds_read_b128 v[158:161], v23 offset:8192
  ds_read_b128 v[216:219], v24 offset:8192
  ds_read_b128 v[154:157], v23 offset:6144
  ds_read_b128 v[200:203], v24 offset:6144
  s_add_u32 m0, s53, 90112
  s_lshl_b32 s60, 5, s64
  buffer_load_dwordx4 v7, s[16:19], s60 offen lds
  ds_read_b64_tr_b16 v[240:241], v25 offset:49152
  ds_read_b64_tr_b16 v[242:243], v25 offset:49664
  ds_read_b64_tr_b16 v[244:245], v25 offset:53248
  ds_read_b64_tr_b16 v[246:247], v25 offset:53760
  s_waitcnt lgkmcnt(13)
  v_mfma_f32_16x16x32_bf16 v[70:73], v[232:235], v[170:173], v[70:73]
  s_waitcnt lgkmcnt(12)
  v_mfma_f32_16x16x32_bf16 v[70:73], v[236:239], v[228:231], v[70:73]
  s_waitcnt lgkmcnt(10)
  v_mfma_f32_16x16x32_bf16 v[66:69], v[236:239], v[224:227], v[66:69]
  v_mfma_f32_16x16x32_bf16 v[66:69], v[232:235], v[166:169], v[66:69]
  s_waitcnt lgkmcnt(9)
  v_mfma_f32_16x16x32_bf16 v[62:65], v[232:235], v[162:165], v[62:65]
  s_waitcnt lgkmcnt(8)
  v_mfma_f32_16x16x32_bf16 v[62:65], v[236:239], v[220:223], v[62:65]
  s_waitcnt lgkmcnt(6)
  v_mfma_f32_16x16x32_bf16 v[58:61], v[236:239], v[216:219], v[58:61]
  v_mfma_f32_16x16x32_bf16 v[58:61], v[232:235], v[158:161], v[58:61]
  s_waitcnt lgkmcnt(5)
  v_mfma_f32_16x16x32_bf16 v[54:57], v[232:235], v[154:157], v[54:57]
  s_waitcnt lgkmcnt(4)
  v_mfma_f32_16x16x32_bf16 v[54:57], v[236:239], v[200:203], v[54:57]
  s_waitcnt lgkmcnt(2)
  v_mfma_f32_16x16x32_bf16 v[74:77], v[154:157], v[240:243], v[74:77]
  s_waitcnt lgkmcnt(0)
  v_mfma_f32_16x16x32_bf16 v[74:77], v[200:203], v[244:247], v[74:77]
  v_mfma_f32_16x16x32_bf16 v[78:81], v[216:219], v[244:247], v[78:81]
  v_mfma_f32_16x16x32_bf16 v[78:81], v[158:161], v[240:243], v[78:81]
  v_mfma_f32_16x16x32_bf16 v[82:85], v[162:165], v[240:243], v[82:85]
  v_mfma_f32_16x16x32_bf16 v[82:85], v[220:223], v[244:247], v[82:85]
  v_mfma_f32_16x16x32_bf16 v[86:89], v[224:227], v[244:247], v[86:89]
  v_mfma_f32_16x16x32_bf16 v[86:89], v[166:169], v[240:243], v[86:89]
  v_mfma_f32_16x16x32_bf16 v[90:93], v[170:173], v[240:243], v[90:93]
  v_mfma_f32_16x16x32_bf16 v[90:93], v[228:231], v[244:247], v[90:93]
  s_waitcnt vmcnt(10)
  s_barrier
  ds_read_b64_tr_b16 v[232:233], v25 offset:57344
  ds_read_b64_tr_b16 v[234:235], v25 offset:57856
  s_add_u32 m0, s53, 98304
  s_lshl_b32 s60, 8, s64
  buffer_load_dwordx4 v7, s[16:19], s60 offen lds
  ds_read_b64_tr_b16 v[236:237], v26 offset:0
  ds_read_b64_tr_b16 v[238:239], v26 offset:512
  s_add_u32 m0, s53, 106496
  s_lshl_b32 s60, 12, s64
  buffer_load_dwordx4 v7, s[16:19], s60 offen lds
  ds_read_b64_tr_b16 v[240:241], v26 offset:4096
  ds_read_b64_tr_b16 v[242:243], v26 offset:4608
  ds_read_b64_tr_b16 v[244:245], v26 offset:8192
  s_add_u32 m0, s53, 6144
  s_lshl_b32 s60, 9, s64
  buffer_load_dwordx4 v7, s[16:19], s60 offen lds
  ds_read_b64_tr_b16 v[246:247], v26 offset:8704
  ds_read_b64_tr_b16 v[248:249], v26 offset:12288
  s_add_u32 m0, s53, 14336
  s_lshl_b32 s60, 13, s64
  buffer_load_dwordx4 v7, s[16:19], s60 offen lds
  ds_read_b64_tr_b16 v[250:251], v26 offset:12800
  ds_read_b64_tr_b16 v[252:253], v26 offset:16384
  ds_read_b64_tr_b16 v[254:255], v26 offset:16896
  s_waitcnt lgkmcnt(10)
  v_mfma_f32_16x16x32_bf16 v[50:53], v[232:235], v[170:173], v[50:53]
  s_waitcnt lgkmcnt(8)
  v_mfma_f32_16x16x32_bf16 v[50:53], v[236:239], v[228:231], v[50:53]
  v_mfma_f32_16x16x32_bf16 v[46:49], v[236:239], v[224:227], v[46:49]
  v_mfma_f32_16x16x32_bf16 v[46:49], v[232:235], v[166:169], v[46:49]
  v_mfma_f32_16x16x32_bf16 v[42:45], v[232:235], v[162:165], v[42:45]
  v_mfma_f32_16x16x32_bf16 v[42:45], v[236:239], v[220:223], v[42:45]
  v_mfma_f32_16x16x32_bf16 v[38:41], v[236:239], v[216:219], v[38:41]
  v_mfma_f32_16x16x32_bf16 v[38:41], v[232:235], v[158:161], v[38:41]
  v_smfmac_f32_16x16x64_bf16 v[126:129], v[34:37], v[232:239], v32
  s_waitcnt lgkmcnt(6)
  v_mfma_f32_16x16x32_bf16 v[94:97], v[240:243], v[158:161], v[94:97]
  s_waitcnt lgkmcnt(4)
  v_mfma_f32_16x16x32_bf16 v[94:97], v[244:247], v[216:219], v[94:97]
  v_mfma_f32_16x16x32_bf16 v[98:101], v[244:247], v[220:223], v[98:101]
  v_mfma_f32_16x16x32_bf16 v[98:101], v[240:243], v[162:165], v[98:101]
  v_mfma_f32_16x16x32_bf16 v[102:105], v[240:243], v[166:169], v[102:105]
  v_mfma_f32_16x16x32_bf16 v[102:105], v[244:247], v[224:227], v[102:105]
  v_mfma_f32_16x16x32_bf16 v[106:109], v[244:247], v[228:231], v[106:109]
  v_mfma_f32_16x16x32_bf16 v[106:109], v[240:243], v[170:173], v[106:109]
  v_smfmac_f32_16x16x64_bf16 v[138:141], v[34:37], v[240:247], v32
  s_waitcnt lgkmcnt(2)
  v_mfma_f32_16x16x32_bf16 v[122:125], v[248:251], v[170:173], v[122:125]
  s_waitcnt lgkmcnt(0)
  v_mfma_f32_16x16x32_bf16 v[122:125], v[252:255], v[228:231], v[122:125]
  v_mfma_f32_16x16x32_bf16 v[118:121], v[252:255], v[224:227], v[118:121]
  v_mfma_f32_16x16x32_bf16 v[118:121], v[248:251], v[166:169], v[118:121]
  v_mfma_f32_16x16x32_bf16 v[114:117], v[248:251], v[162:165], v[114:117]
  v_mfma_f32_16x16x32_bf16 v[114:117], v[252:255], v[220:223], v[114:117]
  v_mfma_f32_16x16x32_bf16 v[110:113], v[252:255], v[216:219], v[110:113]
  v_mfma_f32_16x16x32_bf16 v[110:113], v[248:251], v[158:161], v[110:113]
  v_smfmac_f32_16x16x64_bf16 v[142:145], v[34:37], v[248:255], v32
  s_waitcnt vmcnt(10)
  s_barrier
  ds_read_b64_tr_b16 v[232:233], v26 offset:20480
  ds_read_b64_tr_b16 v[234:235], v26 offset:20992
  s_add_u32 m0, s53, 114688
  s_lshl_b32 s60, 16, s64
  buffer_load_dwordx4 v7, s[16:19], s60 offen lds
  ds_read_b64_tr_b16 v[236:237], v26 offset:24576
  ds_read_b64_tr_b16 v[238:239], v26 offset:25088
  ds_read_b128 v[170:173], v23 offset:32768
  ds_read_b128 v[228:231], v24 offset:32768
  ds_read_b128 v[166:169], v23 offset:30720
  s_add_u32 m0, s53, 122880
  s_lshl_b32 s60, 20, s64
  buffer_load_dwordx4 v7, s[16:19], s60 offen lds
  ds_read_b128 v[224:227], v24 offset:30720
  ds_read_b128 v[162:165], v23 offset:28672
  ds_read_b128 v[220:223], v24 offset:28672
  ds_read_b128 v[158:161], v23 offset:26624
  ds_read_b128 v[216:219], v24 offset:26624
  s_add_u32 m0, s53, 131072
  s_lshl_b32 s60, 17, s64
  buffer_load_dwordx4 v7, s[16:19], s60 offen lds
  ds_read_b128 v[154:157], v23 offset:24576
  ds_read_b128 v[200:203], v24 offset:24576
  ds_read_b64_tr_b16 v[240:241], v26 offset:28672
  ds_read_b64_tr_b16 v[242:243], v26 offset:29184
  ds_read_b64_tr_b16 v[244:245], v26 offset:32768
  ds_read_b64_tr_b16 v[246:247], v26 offset:33280
  s_waitcnt lgkmcnt(13)
  v_mfma_f32_16x16x32_bf16 v[70:73], v[232:235], v[170:173], v[70:73]
  s_waitcnt lgkmcnt(12)
  v_mfma_f32_16x16x32_bf16 v[70:73], v[236:239], v[228:231], v[70:73]
  s_waitcnt lgkmcnt(10)
  v_mfma_f32_16x16x32_bf16 v[66:69], v[236:239], v[224:227], v[66:69]
  v_mfma_f32_16x16x32_bf16 v[66:69], v[232:235], v[166:169], v[66:69]
  s_waitcnt lgkmcnt(9)
  v_mfma_f32_16x16x32_bf16 v[62:65], v[232:235], v[162:165], v[62:65]
  s_waitcnt lgkmcnt(8)
  v_mfma_f32_16x16x32_bf16 v[62:65], v[236:239], v[220:223], v[62:65]
  s_waitcnt lgkmcnt(6)
  v_mfma_f32_16x16x32_bf16 v[58:61], v[236:239], v[216:219], v[58:61]
  v_mfma_f32_16x16x32_bf16 v[58:61], v[232:235], v[158:161], v[58:61]
  s_waitcnt lgkmcnt(5)
  v_mfma_f32_16x16x32_bf16 v[54:57], v[232:235], v[154:157], v[54:57]
  s_waitcnt lgkmcnt(4)
  v_mfma_f32_16x16x32_bf16 v[54:57], v[236:239], v[200:203], v[54:57]
  s_waitcnt lgkmcnt(2)
  v_mfma_f32_16x16x32_bf16 v[74:77], v[154:157], v[240:243], v[74:77]
  s_waitcnt lgkmcnt(0)
  v_mfma_f32_16x16x32_bf16 v[74:77], v[200:203], v[244:247], v[74:77]
  v_mfma_f32_16x16x32_bf16 v[78:81], v[216:219], v[244:247], v[78:81]
  v_mfma_f32_16x16x32_bf16 v[78:81], v[158:161], v[240:243], v[78:81]
  v_mfma_f32_16x16x32_bf16 v[82:85], v[162:165], v[240:243], v[82:85]
  v_mfma_f32_16x16x32_bf16 v[82:85], v[220:223], v[244:247], v[82:85]
  v_mfma_f32_16x16x32_bf16 v[86:89], v[224:227], v[244:247], v[86:89]
  v_mfma_f32_16x16x32_bf16 v[86:89], v[166:169], v[240:243], v[86:89]
  v_mfma_f32_16x16x32_bf16 v[90:93], v[170:173], v[240:243], v[90:93]
  v_mfma_f32_16x16x32_bf16 v[90:93], v[228:231], v[244:247], v[90:93]
  s_waitcnt vmcnt(11)
  s_barrier
  ds_read_b64_tr_b16 v[232:233], v26 offset:36864
  ds_read_b64_tr_b16 v[234:235], v26 offset:37376
  s_add_u32 m0, s53, 139264
  s_lshl_b32 s60, 21, s64
  buffer_load_dwordx4 v7, s[16:19], s60 offen lds
  ds_read_b64_tr_b16 v[236:237], v25 offset:0
  ds_read_b64_tr_b16 v[238:239], v25 offset:512
  s_add_u32 m0, s53, 22528
  s_lshl_b32 s60, 24, s64
  buffer_load_dwordx4 v7, s[16:19], s60 offen lds
  ds_read_b64_tr_b16 v[240:241], v25 offset:4096
  ds_read_b64_tr_b16 v[242:243], v25 offset:4608
  ds_read_b64_tr_b16 v[244:245], v25 offset:8192
  s_add_u32 m0, s53, 30720
  s_lshl_b32 s60, 28, s64
  buffer_load_dwordx4 v7, s[16:19], s60 offen lds
L_A0w1:
  s_cbranch_execz L_A0r
  s_nop 0
  ds_read_b64_tr_b16 v[246:247], v25 offset:8704
  ds_read_b64_tr_b16 v[248:249], v25 offset:12288
  s_add_u32 m0, s53, 147456
  s_lshl_b32 s60, 25, s64
  buffer_load_dwordx4 v7, s[16:19], s60 offen lds
  ds_read_b64_tr_b16 v[250:251], v25 offset:12800
  ds_read_b64_tr_b16 v[252:253], v25 offset:16384
  ds_read_b64_tr_b16 v[254:255], v25 offset:16896
  s_waitcnt lgkmcnt(10)
  v_mfma_f32_16x16x32_bf16 v[50:53], v[232:235], v[170:173], v[50:53]
  s_waitcnt lgkmcnt(8)
  v_mfma_f32_16x16x32_bf16 v[50:53], v[236:239], v[228:231], v[50:53]
  v_mfma_f32_16x16x32_bf16 v[46:49], v[236:239], v[224:227], v[46:49]
  v_mfma_f32_16x16x32_bf16 v[46:49], v[232:235], v[166:169], v[46:49]
  v_mfma_f32_16x16x32_bf16 v[42:45], v[232:235], v[162:165], v[42:45]
  v_mfma_f32_16x16x32_bf16 v[42:45], v[236:239], v[220:223], v[42:45]
  v_mfma_f32_16x16x32_bf16 v[38:41], v[236:239], v[216:219], v[38:41]
  v_mfma_f32_16x16x32_bf16 v[38:41], v[232:235], v[158:161], v[38:41]
  v_smfmac_f32_16x16x64_bf16 v[126:129], v[34:37], v[232:239], v32
  s_waitcnt lgkmcnt(4)
  v_smfmac_f32_16x16x64_bf16 v[138:141], v[34:37], v[240:247], v32
  s_waitcnt lgkmcnt(0)
  v_smfmac_f32_16x16x64_bf16 v[142:145], v[34:37], v[248:255], v32
  v_mfma_f32_16x16x32_bf16 v[94:97], v[240:243], v[158:161], v[94:97]
  v_mfma_f32_16x16x32_bf16 v[94:97], v[244:247], v[216:219], v[94:97]
  v_mfma_f32_16x16x32_bf16 v[98:101], v[244:247], v[220:223], v[98:101]
  v_mfma_f32_16x16x32_bf16 v[98:101], v[240:243], v[162:165], v[98:101]
  v_mfma_f32_16x16x32_bf16 v[102:105], v[240:243], v[166:169], v[102:105]
  v_mfma_f32_16x16x32_bf16 v[102:105], v[244:247], v[224:227], v[102:105]
  v_mfma_f32_16x16x32_bf16 v[106:109], v[244:247], v[228:231], v[106:109]
  v_mfma_f32_16x16x32_bf16 v[106:109], v[240:243], v[170:173], v[106:109]
  v_mfma_f32_16x16x32_bf16 v[122:125], v[248:251], v[170:173], v[122:125]
  v_mfma_f32_16x16x32_bf16 v[122:125], v[252:255], v[228:231], v[122:125]
  v_mfma_f32_16x16x32_bf16 v[118:121], v[252:255], v[224:227], v[118:121]
  v_mfma_f32_16x16x32_bf16 v[118:121], v[248:251], v[166:169], v[118:121]
  v_mfma_f32_16x16x32_bf16 v[114:117], v[248:251], v[162:165], v[114:117]
  v_add_f32_e64 v126, v126, v127
  v_mfma_f32_16x16x32_bf16 v[114:117], v[252:255], v[220:223], v[114:117]
  v_add_f32_e64 v138, v138, v139
  v_mfma_f32_16x16x32_bf16 v[110:113], v[252:255], v[216:219], v[110:113]
  v_add_f32_e64 v142, v142, v143
  v_mfma_f32_16x16x32_bf16 v[110:113], v[248:251], v[158:161], v[110:113]
  s_barrier
  s_mov_b32 exec_lo, 0x10001
  s_mov_b32 exec_hi, 0x10001
  ds_write_b128 v3, v[54:57] offset:4864
  s_mov_b64 exec, 0xffff
  ds_write_b32 v5, v74 offset:5120
  s_mov_b64 exec, -1
  ds_write_b32 v5, v126 offset:4608
  ds_write_b32 v5, v138 offset:5376
  ds_write_b32 v5, v142 offset:5632
  ds_read_b128 v[130:133], v3 offset:4864
  ds_read_b32 v134, v5 offset:5120
  s_add_u32 m0, s53, 155648
  s_lshl_b32 s60, 29, s64
  buffer_load_dwordx4 v7, s[16:19], s60 offen lds
  ds_read_b128 v[126:129], v3 offset:4608
  ds_read_b128 v[138:141], v3 offset:5376
  s_add_u32 m0, s53, 151552
  s_lshl_b32 s60, 32, s64
  buffer_load_dwordx4 v7, s[16:19], s60 offen lds
  ds_read_b128 v[142:145], v3 offset:5632
  ds_read_b128 v[180:183], v30 offset:1024
  s_add_u32 m0, s53, 159744
  s_lshl_b32 s60, 36, s64
  buffer_load_dwordx4 v7, s[16:19], s60 offen lds
  ds_read_b128 v[22:25], v30 offset:768
  ds_read_b128 v[18:21], v30 offset:512
  s_add_u32 m0, s53, 59392
  s_lshl_b32 s60, 33, s64
  buffer_load_dwordx4 v7, s[16:19], s60 offen lds
  ds_read_b128 v[150:153], v30 offset:256
  ds_read_b128 v[176:179], v30 offset:0
  s_setprio 3
  ds_read_b128 v[168:171], v31 offset:4096
  ds_read_b128 v[164:167], v31 offset:3328
  ds_read_b128 v[26:29], v31 offset:4032
  ds_read_b128 v[172:175], v31 offset:3264
  s_waitcnt lgkmcnt(8)
  v_pk_fma_f32 v[70:71], v[180:181], v[130:131], v[70:71] op_sel_hi:[0,1,1] neg_lo:[1,0,0] neg_hi:[1,0,0]
  v_pk_fma_f32 v[72:73], v[180:181], v[132:133], v[72:73] op_sel_hi:[0,1,1] neg_lo:[1,0,0] neg_hi:[1,0,0]
  v_pk_mul_f32 v[70:71], v[180:181], v[70:71] op_sel:[1,0]
  v_pk_mul_f32 v[72:73], v[180:181], v[72:73] op_sel:[1,0]
  v_cvt_pk_bf16_f32 v70, v70, v71
  v_cvt_pk_bf16_f32 v71, v72, v73
  s_waitcnt lgkmcnt(2)
  v_pk_fma_f32 v[90:91], v[164:165], v[134:135], v[90:91] op_sel_hi:[1,0,1] neg_lo:[1,0,0] neg_hi:[1,0,0]
  v_pk_fma_f32 v[92:93], v[166:167], v[134:135], v[92:93] op_sel_hi:[1,0,1] neg_lo:[1,0,0] neg_hi:[1,0,0]
  v_pk_mul_f32 v[90:91], v[90:91], v[168:169]
  v_pk_mul_f32 v[92:93], v[92:93], v[170:171]
  v_cvt_pk_bf16_f32 v162, v90, v91
  v_cvt_pk_bf16_f32 v163, v92, v93
  ds_write_b64 v10, v[70:71] offset:38912
  ds_write_b64 v10, v[162:163] offset:40960
  v_pk_fma_f32 v[50:51], v[180:181], v[126:127], v[50:51] op_sel_hi:[0,1,1] neg_lo:[1,0,0] neg_hi:[1,0,0]
  v_pk_fma_f32 v[52:53], v[180:181], v[128:129], v[52:53] op_sel_hi:[0,1,1] neg_lo:[1,0,0] neg_hi:[1,0,0]
  v_cvt_pk_bf16_f32 v72, v50, v51
  v_cvt_pk_bf16_f32 v73, v52, v53
  ds_read_b128 v[168:171], v31 offset:3968
  ds_read_b128 v[164:167], v31 offset:3200
  v_pk_fma_f32 v[66:67], v[22:23], v[130:131], v[66:67] op_sel_hi:[0,1,1] neg_lo:[1,0,0] neg_hi:[1,0,0]
  v_pk_fma_f32 v[68:69], v[22:23], v[132:133], v[68:69] op_sel_hi:[0,1,1] neg_lo:[1,0,0] neg_hi:[1,0,0]
  v_pk_mul_f32 v[66:67], v[22:23], v[66:67] op_sel:[1,0]
  v_pk_mul_f32 v[68:69], v[22:23], v[68:69] op_sel:[1,0]
  v_cvt_pk_bf16_f32 v66, v66, v67
  v_cvt_pk_bf16_f32 v67, v68, v69
  s_waitcnt lgkmcnt(4)
  v_pk_fma_f32 v[86:87], v[172:173], v[134:135], v[86:87] op_sel_hi:[1,0,1] neg_lo:[1,0,0] neg_hi:[1,0,0]
  v_pk_fma_f32 v[88:89], v[174:175], v[134:135], v[88:89] op_sel_hi:[1,0,1] neg_lo:[1,0,0] neg_hi:[1,0,0]
  v_pk_mul_f32 v[86:87], v[86:87], v[26:27]
  v_pk_mul_f32 v[88:89], v[88:89], v[28:29]
  v_cvt_pk_bf16_f32 v160, v86, v87
  v_cvt_pk_bf16_f32 v161, v88, v89
  v_pk_fma_f32 v[46:47], v[22:23], v[126:127], v[46:47] op_sel_hi:[0,1,1] neg_lo:[1,0,0] neg_hi:[1,0,0]
  v_pk_fma_f32 v[48:49], v[22:23], v[128:129], v[48:49] op_sel_hi:[0,1,1] neg_lo:[1,0,0] neg_hi:[1,0,0]
  v_cvt_pk_bf16_f32 v68, v46, v47
  v_cvt_pk_bf16_f32 v69, v48, v49
  ds_read_b128 v[26:29], v31 offset:3904
  s_add_u32 m0, s53, 67584
  s_lshl_b32 s60, 37, s64
  buffer_load_dwordx4 v7, s[16:19], s60 offen lds
  ds_read_b128 v[172:175], v31 offset:3136
  v_pk_fma_f32 v[62:63], v[18:19], v[130:131], v[62:63] op_sel_hi:[0,1,1] neg_lo:[1,0,0] neg_hi:[1,0,0]
  v_pk_fma_f32 v[64:65], v[18:19], v[132:133], v[64:65] op_sel_hi:[0,1,1] neg_lo:[1,0,0] neg_hi:[1,0,0]
  v_pk_mul_f32 v[62:63], v[18:19], v[62:63] op_sel:[1,0]
  v_pk_mul_f32 v[64:65], v[18:19], v[64:65] op_sel:[1,0]
  v_cvt_pk_bf16_f32 v62, v62, v63
  v_cvt_pk_bf16_f32 v63, v64, v65
  s_waitcnt lgkmcnt(2)
  v_pk_fma_f32 v[82:83], v[164:165], v[134:135], v[82:83] op_sel_hi:[1,0,1] neg_lo:[1,0,0] neg_hi:[1,0,0]
  v_pk_fma_f32 v[84:85], v[166:167], v[134:135], v[84:85] op_sel_hi:[1,0,1] neg_lo:[1,0,0] neg_hi:[1,0,0]
  v_pk_mul_f32 v[82:83], v[82:83], v[168:169]
  v_pk_mul_f32 v[84:85], v[84:85], v[170:171]
  v_cvt_pk_bf16_f32 v158, v82, v83
  v_cvt_pk_bf16_f32 v159, v84, v85
  v_pk_fma_f32 v[42:43], v[18:19], v[126:127], v[42:43] op_sel_hi:[0,1,1] neg_lo:[1,0,0] neg_hi:[1,0,0]
  v_pk_fma_f32 v[44:45], v[18:19], v[128:129], v[44:45] op_sel_hi:[0,1,1] neg_lo:[1,0,0] neg_hi:[1,0,0]
  v_cvt_pk_bf16_f32 v64, v42, v43
  v_cvt_pk_bf16_f32 v65, v44, v45
  ds_read_b128 v[168:171], v31 offset:3840
  ds_read_b128 v[164:167], v31 offset:3072
  v_pk_fma_f32 v[58:59], v[150:151], v[130:131], v[58:59] op_sel_hi:[0,1,1] neg_lo:[1,0,0] neg_hi:[1,0,0]
  v_pk_fma_f32 v[60:61], v[150:151], v[132:133], v[60:61] op_sel_hi:[0,1,1] neg_lo:[1,0,0] neg_hi:[1,0,0]
  v_pk_mul_f32 v[58:59], v[150:151], v[58:59] op_sel:[1,0]
  v_pk_mul_f32 v[60:61], v[150:151], v[60:61] op_sel:[1,0]
  v_cvt_pk_bf16_f32 v58, v58, v59
  v_cvt_pk_bf16_f32 v59, v60, v61
  s_waitcnt lgkmcnt(2)
  v_pk_fma_f32 v[78:79], v[172:173], v[134:135], v[78:79] op_sel_hi:[1,0,1] neg_lo:[1,0,0] neg_hi:[1,0,0]
  v_pk_fma_f32 v[80:81], v[174:175], v[134:135], v[80:81] op_sel_hi:[1,0,1] neg_lo:[1,0,0] neg_hi:[1,0,0]
  v_pk_mul_f32 v[78:79], v[78:79], v[26:27]
  v_pk_mul_f32 v[80:81], v[80:81], v[28:29]
  v_cvt_pk_bf16_f32 v156, v78, v79
  v_cvt_pk_bf16_f32 v157, v80, v81
  v_pk_fma_f32 v[38:39], v[150:151], v[126:127], v[38:39] op_sel_hi:[0,1,1] neg_lo:[1,0,0] neg_hi:[1,0,0]
  v_pk_fma_f32 v[40:41], v[150:151], v[128:129], v[40:41] op_sel_hi:[0,1,1] neg_lo:[1,0,0] neg_hi:[1,0,0]
  v_cvt_pk_bf16_f32 v60, v38, v39
  v_cvt_pk_bf16_f32 v61, v40, v41
  s_waitcnt lgkmcnt(0)
  s_barrier
  v_pk_fma_f32 v[54:55], v[176:177], v[130:131], v[54:55] op_sel_hi:[0,1,1] neg_lo:[1,0,0] neg_hi:[1,0,0]
  v_pk_fma_f32 v[56:57], v[176:177], v[132:133], v[56:57] op_sel_hi:[0,1,1] neg_lo:[1,0,0] neg_hi:[1,0,0]
  v_pk_mul_f32 v[54:55], v[176:177], v[54:55] op_sel:[1,0]
  v_pk_mul_f32 v[56:57], v[176:177], v[56:57] op_sel:[1,0]
  v_cvt_pk_bf16_f32 v54, v54, v55
  v_cvt_pk_bf16_f32 v55, v56, v57
  v_pk_fma_f32 v[74:75], v[164:165], v[134:135], v[74:75] op_sel_hi:[1,0,1] neg_lo:[1,0,0] neg_hi:[1,0,0]
  v_pk_fma_f32 v[76:77], v[166:167], v[134:135], v[76:77] op_sel_hi:[1,0,1] neg_lo:[1,0,0] neg_hi:[1,0,0]
  v_pk_mul_f32 v[74:75], v[74:75], v[168:169]
  v_pk_mul_f32 v[76:77], v[76:77], v[170:171]
  v_cvt_pk_bf16_f32 v154, v74, v75
  v_cvt_pk_bf16_f32 v155, v76, v77
  v_mfma_f32_16x16x16_bf16 v[50:53], v[70:71], v[72:73], 0
  s_cmp_eq_u32 s46, 0
  s_cselect_b32 s66, 0xf149f2ca, 0
  v_mov_b32 v74, s66
  v_mov_b32 v75, s66
  v_mfma_f32_16x16x16_bf16 v[90:93], v[66:67], v[72:73], 0
  v_mov_b32 v76, s66
  v_mov_b32 v77, s66
  v_mfma_f32_16x16x16_bf16 v[46:49], v[66:67], v[68:69], 0
  v_bfe_i32 v172, v1, 0, 1
  v_and_b32_e64 v175, 14, v1
  v_mfma_f32_16x16x16_bf16 v[86:89], v[62:63], v[68:69], 0
  v_lshrrev_b32 v3, 2, v31
  v_sub_u32 v175, v175, v3
  v_mfma_f32_16x16x16_bf16 v[42:45], v[62:63], v[64:65], 0
  v_not_b32 v173, v175
  v_ashrrev_i32 v173, 31, v173
  v_sub_u32_e64 v174, 1, v175
  v_mfma_f32_16x16x16_bf16 v[82:85], v[58:59], v[64:65], 0
  v_ashrrev_i32_e64 v174, 31, v174
  v_xor_b32 v175, 0xffff, v172
  v_mfma_f32_16x16x16_bf16 v[38:41], v[58:59], v[60:61], 0
  v_and_b32 v28, v175, v173
  v_and_b32 v29, v175, v174
  v_mfma_f32_16x16x16_bf16 v[78:81], v[54:55], v[60:61], v[74:77]
  v_xor_b32 v26, v175, v28
  v_xor_b32 v27, v175, v29
  v_bitop3_b32 v50, v172, v51, v50 bitop3:0xca
  v_bitop3_b32 v51, v172, v53, v52 bitop3:0xca
  v_bitop3_b32 v90, v172, v91, v90 bitop3:0xca
  v_bitop3_b32 v91, v172, v93, v92 bitop3:0xca
  v_bitop3_b32 v50, v173, v50, v90 bitop3:0xca
  v_bitop3_b32 v51, v174, v51, v91 bitop3:0xca
  v_max_f32_e64 v52, v50, v51
  v_bitop3_b32 v46, v172, v47, v46 bitop3:0xca
  v_bitop3_b32 v47, v172, v49, v48 bitop3:0xca
  v_bitop3_b32 v86, v172, v87, v86 bitop3:0xca
  v_bitop3_b32 v87, v172, v89, v88 bitop3:0xca
  v_bitop3_b32 v46, v173, v46, v86 bitop3:0xca
  v_bitop3_b32 v47, v174, v47, v87 bitop3:0xca
  v_max_f32_e64 v48, v46, v47
  v_bitop3_b32 v42, v172, v43, v42 bitop3:0xca
  v_bitop3_b32 v43, v172, v45, v44 bitop3:0xca
  v_bitop3_b32 v82, v172, v83, v82 bitop3:0xca
  v_bitop3_b32 v83, v172, v85, v84 bitop3:0xca
  v_bitop3_b32 v42, v173, v42, v82 bitop3:0xca
  v_bitop3_b32 v43, v174, v43, v83 bitop3:0xca
  v_max_f32_e64 v44, v42, v43
  v_bitop3_b32 v38, v172, v39, v38 bitop3:0xca
  v_bitop3_b32 v39, v172, v41, v40 bitop3:0xca
  v_bitop3_b32 v78, v172, v79, v78 bitop3:0xca
  v_bitop3_b32 v79, v172, v81, v80 bitop3:0xca
  v_bitop3_b32 v38, v173, v38, v78 bitop3:0xca
  v_bitop3_b32 v39, v174, v39, v79 bitop3:0xca
  v_max_f32 v40, v38, v39
  v_permlane16_swap_b32 v48, v52
  v_mul_f32 v41, 0xbe800000, v152
  v_permlane16_swap_b32 v40, v44
  v_max_f32 v48, v48, v52
  v_max_f32_e64 v40, v40, v44
  v_mul_f32 v45, 0xbe800000, v20
  v_mul_f32 v49, 0xbe800000, v24
  v_permlane32_swap_b32 v40, v48
  v_max_f32 v40, v40, v48
  v_mov_b32_e64 v48, v40
  v_mul_f32 v53, 0xbe800000, v182
  s_nop 0
  v_permlane32_swap_b32 v40, v48
  v_mov_b32 v44, v40
  v_mov_b32 v52, v48
  s_nop 0
  v_permlane16_swap_b32 v40, v44
  v_permlane16_swap_b32_e64 v48, v52
  v_pk_add_f32 v[38:39], v[38:39], v[40:41] op_sel_hi:[1,0] neg_lo:[0,1] neg_hi:[0,1]
  v_pk_mul_f32 v[38:39], v[40:41], v[38:39] op_sel:[1,0]
  v_exp_f32 v38, v38
  v_exp_f32 v39, v39
  v_pk_add_f32 v[42:43], v[42:43], v[44:45] op_sel_hi:[1,0] neg_lo:[0,1] neg_hi:[0,1]
  v_pk_mul_f32 v[42:43], v[44:45], v[42:43] op_sel:[1,0]
  v_exp_f32 v42, v42
  v_exp_f32 v43, v43
  v_pk_add_f32 v[46:47], v[46:47], v[48:49] op_sel_hi:[1,0] neg_lo:[0,1] neg_hi:[0,1]
  v_pk_mul_f32 v[46:47], v[48:49], v[46:47] op_sel:[1,0]
  v_exp_f32 v46, v46
  v_exp_f32 v47, v47
  v_pk_add_f32 v[50:51], v[50:51], v[52:53] op_sel_hi:[1,0] neg_lo:[0,1] neg_hi:[0,1]
  v_pk_mul_f32 v[50:51], v[52:53], v[50:51] op_sel:[1,0]
  v_exp_f32 v50, v50
  v_exp_f32 v51, v51
  v_cvt_pk_bf16_f32 v38, v38, v38
  v_cvt_pk_bf16_f32 v39, v39, v39
  v_and_b32 v58, v38, v26
  v_and_b32 v59, v39, v27
  v_and_b32 v60, v38, v28
  v_and_b32 v61, v39, v29
  v_cvt_pk_bf16_f32 v42, v42, v42
  v_cvt_pk_bf16_f32 v43, v43, v43
  v_mfma_f32_16x16x32_bf16 v[78:81], v[34:37], v[58:61], 0
  v_and_b32 v62, v42, v26
  v_and_b32 v63, v43, v27
  v_mfma_f32_16x16x32_bf16 v[38:41], v[154:157], v[58:61], 0
  v_and_b32 v64, v42, v28
  v_and_b32 v65, v43, v29
  v_cvt_pk_bf16_f32 v46, v46, v46
  v_cvt_pk_bf16_f32 v47, v47, v47
  v_mfma_f32_16x16x32_bf16 v[82:85], v[34:37], v[62:65], 0
  v_and_b32 v66, v46, v26
  v_and_b32 v67, v47, v27
  v_mfma_f32_16x16x32_bf16 v[42:45], v[156:159], v[62:65], 0
  v_and_b32 v68, v46, v28
  v_and_b32 v69, v47, v29
  v_cvt_pk_bf16_f32 v50, v50, v50
  v_cvt_pk_bf16_f32 v51, v51, v51
  v_mfma_f32_16x16x32_bf16 v[86:89], v[34:37], v[66:69], 0
  v_and_b32 v70, v50, v26
  v_and_b32 v71, v51, v27
  v_mfma_f32_16x16x32_bf16 v[46:49], v[158:161], v[66:69], 0
  v_and_b32 v72, v50, v28
  v_and_b32_e64 v73, v51, v29
  s_nop 1
  v_mfma_f32_16x16x32_bf16 v[90:93], v[34:37], v[70:73], 0
  v_mfma_f32_16x16x32_bf16 v[50:53], v[160:163], v[70:73], 0
  v_pk_fma_f32 v[94:95], v[150:151], v[138:139], v[94:95] op_sel_hi:[0,1,1] neg_lo:[1,0,0] neg_hi:[1,0,0]
  v_pk_fma_f32 v[96:97], v[150:151], v[140:141], v[96:97] op_sel_hi:[0,1,1] neg_lo:[1,0,0] neg_hi:[1,0,0]
  v_pk_fma_f32 v[110:111], v[150:151], v[142:143], v[110:111] op_sel_hi:[0,1,1] neg_lo:[1,0,0] neg_hi:[1,0,0]
  v_pk_fma_f32 v[112:113], v[150:151], v[144:145], v[112:113] op_sel_hi:[0,1,1] neg_lo:[1,0,0] neg_hi:[1,0,0]
  v_pk_mul_f32 v[146:147], v[94:95], v[152:153] op_sel_hi:[1,0]
  v_pk_mul_f32 v[148:149], v[96:97], v[152:153] op_sel_hi:[1,0]
  v_exp_f32 v146, v146
  v_exp_f32 v147, v147
  v_exp_f32 v148, v148
  v_exp_f32 v149, v149
  v_pk_mul_f32 v[94:95], v[94:95], v[110:111]
  v_pk_mul_f32 v[96:97], v[96:97], v[112:113]
  v_pk_fma_f32 v[146:147], v[152:153], v[146:147], v[152:153] op_sel:[1,0,1]
  v_pk_fma_f32 v[148:149], v[152:153], v[148:149], v[152:153] op_sel:[1,0,1]
  v_rcp_f32 v146, v146
  v_rcp_f32 v147, v147
  v_rcp_f32 v148, v148
  v_rcp_f32 v149, v149
  v_pk_mul_f32 v[94:95], v[94:95], v[146:147]
  v_pk_mul_f32 v[96:97], v[96:97], v[148:149]
  v_cvt_pk_bf16_f32 v110, v94, v95
  v_cvt_pk_bf16_f32 v111, v96, v97
  v_pk_fma_f32 v[98:99], v[18:19], v[138:139], v[98:99] op_sel_hi:[0,1,1] neg_lo:[1,0,0] neg_hi:[1,0,0]
  v_pk_fma_f32 v[100:101], v[18:19], v[140:141], v[100:101] op_sel_hi:[0,1,1] neg_lo:[1,0,0] neg_hi:[1,0,0]
  v_pk_fma_f32 v[114:115], v[18:19], v[142:143], v[114:115] op_sel_hi:[0,1,1] neg_lo:[1,0,0] neg_hi:[1,0,0]
  v_pk_fma_f32 v[116:117], v[18:19], v[144:145], v[116:117] op_sel_hi:[0,1,1] neg_lo:[1,0,0] neg_hi:[1,0,0]
  v_pk_mul_f32 v[146:147], v[98:99], v[20:21] op_sel_hi:[1,0]
  v_pk_mul_f32 v[148:149], v[100:101], v[20:21] op_sel_hi:[1,0]
  v_exp_f32 v146, v146
  v_exp_f32 v147, v147
  v_exp_f32 v148, v148
  v_exp_f32 v149, v149
  v_pk_mul_f32 v[98:99], v[98:99], v[114:115]
  v_pk_mul_f32 v[100:101], v[100:101], v[116:117]
  v_pk_fma_f32 v[146:147], v[20:21], v[146:147], v[20:21] op_sel:[1,0,1]
  v_pk_fma_f32 v[148:149], v[20:21], v[148:149], v[20:21] op_sel:[1,0,1]
  v_rcp_f32 v146, v146
  v_rcp_f32 v147, v147
  v_rcp_f32 v148, v148
  v_rcp_f32 v149, v149
  v_pk_mul_f32 v[98:99], v[98:99], v[146:147]
  v_pk_mul_f32 v[100:101], v[100:101], v[148:149]
  v_cvt_pk_bf16_f32 v112, v98, v99
  v_cvt_pk_bf16_f32 v113, v100, v101
  s_nop 0
  v_permlane16_swap_b32 v110, v112
  v_permlane16_swap_b32_e64 v111, v113
  buffer_store_dwordx4 v[110:113], v2, s[40:43], s55 offen sc1
  v_pk_fma_f32 v[102:103], v[22:23], v[138:139], v[102:103] op_sel_hi:[0,1,1] neg_lo:[1,0,0] neg_hi:[1,0,0]
  v_pk_fma_f32 v[104:105], v[22:23], v[140:141], v[104:105] op_sel_hi:[0,1,1] neg_lo:[1,0,0] neg_hi:[1,0,0]
  v_pk_fma_f32 v[118:119], v[22:23], v[142:143], v[118:119] op_sel_hi:[0,1,1] neg_lo:[1,0,0] neg_hi:[1,0,0]
  v_pk_fma_f32 v[120:121], v[22:23], v[144:145], v[120:121] op_sel_hi:[0,1,1] neg_lo:[1,0,0] neg_hi:[1,0,0]
  v_pk_mul_f32 v[146:147], v[102:103], v[24:25] op_sel_hi:[1,0]
  v_pk_mul_f32 v[148:149], v[104:105], v[24:25] op_sel_hi:[1,0]
  v_exp_f32 v146, v146
  v_exp_f32 v147, v147
  v_exp_f32 v148, v148
  v_exp_f32 v149, v149
  v_pk_mul_f32 v[102:103], v[102:103], v[118:119]
  v_pk_mul_f32 v[104:105], v[104:105], v[120:121]
  v_pk_fma_f32 v[146:147], v[24:25], v[146:147], v[24:25] op_sel:[1,0,1]
  v_pk_fma_f32 v[148:149], v[24:25], v[148:149], v[24:25] op_sel:[1,0,1]
  v_rcp_f32 v146, v146
  v_rcp_f32 v147, v147
  v_rcp_f32 v148, v148
  v_rcp_f32 v149, v149
  v_pk_mul_f32 v[102:103], v[102:103], v[146:147]
  v_pk_mul_f32 v[104:105], v[104:105], v[148:149]
  v_cvt_pk_bf16_f32 v118, v102, v103
  v_cvt_pk_bf16_f32 v119, v104, v105
  v_pk_fma_f32 v[106:107], v[180:181], v[138:139], v[106:107] op_sel_hi:[0,1,1] neg_lo:[1,0,0] neg_hi:[1,0,0]
  v_pk_fma_f32 v[108:109], v[180:181], v[140:141], v[108:109] op_sel_hi:[0,1,1] neg_lo:[1,0,0] neg_hi:[1,0,0]
  v_pk_fma_f32 v[122:123], v[180:181], v[142:143], v[122:123] op_sel_hi:[0,1,1] neg_lo:[1,0,0] neg_hi:[1,0,0]
  v_pk_fma_f32 v[124:125], v[180:181], v[144:145], v[124:125] op_sel_hi:[0,1,1] neg_lo:[1,0,0] neg_hi:[1,0,0]
  v_pk_mul_f32 v[146:147], v[106:107], v[182:183] op_sel_hi:[1,0]
  v_pk_mul_f32 v[148:149], v[108:109], v[182:183] op_sel_hi:[1,0]
  v_exp_f32 v146, v146
  v_exp_f32 v147, v147
  v_exp_f32 v148, v148
  v_exp_f32 v149, v149
  v_pk_mul_f32 v[106:107], v[106:107], v[122:123]
  v_pk_mul_f32 v[108:109], v[108:109], v[124:125]
  v_pk_fma_f32 v[146:147], v[182:183], v[146:147], v[182:183] op_sel:[1,0,1]
  v_pk_fma_f32 v[148:149], v[182:183], v[148:149], v[182:183] op_sel:[1,0,1]
  v_rcp_f32 v146, v146
  v_rcp_f32 v147, v147
  v_rcp_f32 v148, v148
  v_rcp_f32 v149, v149
  v_pk_mul_f32 v[106:107], v[106:107], v[146:147]
  v_pk_mul_f32 v[108:109], v[108:109], v[148:149]
  v_cvt_pk_bf16_f32 v120, v106, v107
  v_cvt_pk_bf16_f32 v121, v108, v109
  s_nop 0
  v_permlane16_swap_b32 v118, v120
  v_permlane16_swap_b32_e64 v119, v121
  buffer_store_dwordx4 v[118:121], v2, s[40:43], s56 offen sc1
  v_rcp_f32 v78, v78
  v_rcp_f32 v82, v82
  v_rcp_f32 v86, v86
  v_rcp_f32 v90, v90
  v_pk_mul_f32 v[38:39], v[38:39], v[78:79] op_sel_hi:[1,0]
  v_pk_mul_f32 v[40:41], v[40:41], v[78:79] op_sel_hi:[1,0]
  v_cvt_pk_bf16_f32 v164, v38, v39
  v_cvt_pk_bf16_f32 v165, v40, v41
  v_pk_mul_f32 v[42:43], v[42:43], v[82:83] op_sel_hi:[1,0]
  v_pk_mul_f32 v[44:45], v[44:45], v[82:83] op_sel_hi:[1,0]
  v_cvt_pk_bf16_f32 v166, v42, v43
  v_cvt_pk_bf16_f32 v167, v44, v45
  s_nop 0
  v_permlane16_swap_b32 v164, v166
  v_permlane16_swap_b32_e64 v165, v167
  buffer_store_dwordx4 v[164:167], v2, s[40:43], s57 offen sc1
  v_pk_mul_f32 v[46:47], v[46:47], v[86:87] op_sel_hi:[1,0]
  v_pk_mul_f32 v[48:49], v[48:49], v[86:87] op_sel_hi:[1,0]
  v_cvt_pk_bf16_f32 v168, v46, v47
  v_cvt_pk_bf16_f32 v169, v48, v49
  v_pk_mul_f32 v[50:51], v[50:51], v[90:91] op_sel_hi:[1,0]
  v_pk_mul_f32 v[52:53], v[52:53], v[90:91] op_sel_hi:[1,0]
  v_cvt_pk_bf16_f32 v170, v50, v51
  v_cvt_pk_bf16_f32 v171, v52, v53
  s_nop 0
  v_permlane16_swap_b32 v168, v170
  v_permlane16_swap_b32_e64 v169, v171
  buffer_store_dwordx4 v[168:171], v2, s[40:43], s58 offen sc1
  s_waitcnt vmcnt(22)
  ds_read_b64_tr_b16 v[216:217], v12 offset:43008
  ds_read_b64_tr_b16 v[220:221], v13 offset:43008
  ds_read_b64_tr_b16 v[224:225], v14 offset:43008
  ds_read_b64_tr_b16 v[228:229], v15 offset:43008
  s_waitcnt vmcnt(20)
  ds_read_b64_tr_b16 v[218:219], v212 offset:0
  ds_read_b64_tr_b16 v[222:223], v213 offset:0
  ds_read_b64_tr_b16 v[226:227], v214 offset:0
  ds_read_b64_tr_b16 v[230:231], v215 offset:0
  s_waitcnt vmcnt(18)
  ds_read_b64_tr_b16 v[232:233], v212 offset:16384
  ds_read_b64_tr_b16 v[236:237], v213 offset:16384
  ds_read_b64_tr_b16 v[240:241], v214 offset:16384
  ds_read_b64_tr_b16 v[244:245], v215 offset:16384
  s_waitcnt vmcnt(16)
  ds_read_b64_tr_b16 v[234:235], v12 offset:6144
  ds_read_b64_tr_b16 v[238:239], v13 offset:6144
  ds_read_b64_tr_b16 v[242:243], v14 offset:6144
  ds_read_b64_tr_b16 v[246:247], v15 offset:6144
  s_waitcnt vmcnt(14)
  ds_read_b64_tr_b16 v[248:249], v212 offset:32768
  ds_read_b64_tr_b16 v[252:253], v213 offset:32768
  ds_read_b64_tr_b16 v[200:201], v214 offset:32768
  ds_read_b64_tr_b16 v[204:205], v215 offset:32768
  s_waitcnt vmcnt(12)
  ds_read_b64_tr_b16 v[250:251], v212 offset:49152
  ds_read_b64_tr_b16 v[254:255], v213 offset:49152
  ds_read_b64_tr_b16 v[202:203], v214 offset:49152
  ds_read_b64_tr_b16 v[206:207], v215 offset:49152
  s_waitcnt vmcnt(10)
  ds_read_b64_tr_b16 v[208:209], v12 offset:22528
  ds_read_b64_tr_b16 v[192:193], v13 offset:22528
  ds_read_b64_tr_b16 v[188:189], v14 offset:22528
  ds_read_b64_tr_b16 v[184:185], v15 offset:22528
  s_waitcnt vmcnt(8)
  ds_read_b64_tr_b16 v[210:211], v196 offset:0
  ds_read_b64_tr_b16 v[194:195], v197 offset:0
  ds_read_b64_tr_b16 v[190:191], v198 offset:0
  ds_read_b64_tr_b16 v[186:187], v199 offset:0
  s_waitcnt vmcnt(6)
  ds_read_b64_tr_b16 v[180:181], v196 offset:4096
  ds_read_b64_tr_b16 v[176:177], v197 offset:4096
  ds_read_b64_tr_b16 v[172:173], v198 offset:4096
  ds_read_b64_tr_b16 v[168:169], v199 offset:4096
  s_waitcnt vmcnt(4)
  ds_read_b64_tr_b16 v[182:183], v12 offset:59392
  ds_read_b64_tr_b16 v[178:179], v13 offset:59392
  ds_read_b64_tr_b16 v[174:175], v14 offset:59392
  ds_read_b64_tr_b16 v[170:171], v15 offset:59392
  buffer_load_dwordx2 v[20:21], v8, s[20:23], 0 offen
  buffer_load_dwordx2 v[22:23], v11, s[20:23], 0 offen
  s_waitcnt lgkmcnt(14)
  s_lshl_b32 s60, s5, s64
  v_add_u32_e64 v7, s60, v7
  s_add_u32 m0, s53, 43008
  s_lshl_b32 s60, 0, s64
  buffer_load_dwordx4 v7, s[16:19], s60 offen lds
  s_add_u32 m0, s53, 51200
  s_lshl_b32 s60, 4, s64
  buffer_load_dwordx4 v7, s[16:19], s60 offen lds
  s_add_u32 m0, s53, 81920
  s_lshl_b32 s60, 1, s64
  buffer_load_dwordx4 v7, s[16:19], s60 offen lds
  s_add_u32 m0, s53, 90112
  s_lshl_b32 s60, 5, s64
  buffer_load_dwordx4 v7, s[16:19], s60 offen lds
  s_add_u32 m0, s53, 98304
  s_lshl_b32 s60, 8, s64
  buffer_load_dwordx4 v7, s[16:19], s60 offen lds
  s_add_u32 m0, s53, 106496
  s_lshl_b32 s60, 12, s64
  buffer_load_dwordx4 v7, s[16:19], s60 offen lds
  s_waitcnt vmcnt(8)
  s_mov_b64 exec, 1
  ds_add_rtn_u32 v3, v1, v6 offset:5888
  s_waitcnt lgkmcnt(0)
  v_readfirstlane_b32 s66, v3
  s_mov_b64 exec, -1
  s_xor_b32 s66, s66, 3
  s_lshl_b32 s66, s66, 24
  v_add_u32 v3, s66, v33
  buffer_store_dword v6, v3, s[40:43], 0 offen sc1
  s_setprio 0
  s_add_u32 m0, s53, 6144
  s_lshl_b32 s60, 9, s64
  buffer_load_dwordx4 v7, s[16:19], s60 offen lds
  s_add_u32 m0, s53, 14336
  s_lshl_b32 s60, 13, s64
  buffer_load_dwordx4 v7, s[16:19], s60 offen lds
  s_add_u32 m0, s53, 114688
  s_lshl_b32 s60, 16, s64
  buffer_load_dwordx4 v7, s[16:19], s60 offen lds
  s_add_u32 m0, s53, 122880
  s_lshl_b32 s60, 20, s64
  buffer_load_dwordx4 v7, s[16:19], s60 offen lds
  s_add_u32 m0, s53, 131072
  s_lshl_b32 s60, 17, s64
  buffer_load_dwordx4 v7, s[16:19], s60 offen lds
  s_add_u32 m0, s53, 139264
  s_lshl_b32 s60, 21, s64
  buffer_load_dwordx4 v7, s[16:19], s60 offen lds
  s_add_u32 m0, s53, 22528
  s_lshl_b32 s60, 24, s64
  buffer_load_dwordx4 v7, s[16:19], s60 offen lds
  s_add_u32 m0, s53, 30720
  s_lshl_b32 s60, 28, s64
  buffer_load_dwordx4 v7, s[16:19], s60 offen lds
  s_add_u32 m0, s53, 147456
  s_lshl_b32 s60, 25, s64
  buffer_load_dwordx4 v7, s[16:19], s60 offen lds
  s_add_u32 m0, s53, 155648
  s_lshl_b32 s60, 29, s64
  buffer_load_dwordx4 v7, s[16:19], s60 offen lds
  s_buffer_load_dwordx2 s[28:29], s[40:43], s65 offset:0 glc
  s_add_u32 m0, s53, 151552
  s_lshl_b32 s60, 32, s64
  buffer_load_dwordx4 v7, s[16:19], s60 offen lds
  s_add_u32 m0, s53, 159744
  s_lshl_b32 s60, 36, s64
  buffer_load_dwordx4 v7, s[16:19], s60 offen lds
  s_add_u32 m0, s53, 59392
  s_lshl_b32 s60, 33, s64
  buffer_load_dwordx4 v7, s[16:19], s60 offen lds
  s_add_u32 m0, s53, 67584
  s_lshl_b32 s60, 37, s64
  buffer_load_dwordx4 v7, s[16:19], s60 offen lds
  s_branch L_P0
.p2align 12
L_A1:
  s_mov_b32 s34, 0x1c0000
  s_mov_b32 s35, 0x20000
  s_mov_b64 s[32:33], s[14:15]
  v_lshrrev_b32 v3, 3, v1
  s_lshl_b32 s66, s45, 2
  v_add_u32 v3, s66, v3
  v_lshrrev_b32_e64 v4, 1, v3
  v_bitop3_b32 v4, v4, v1, 7 bitop3:0x28
  v_lshlrev_b32_e64 v4, 4, v4
  v_lshl_add_u32 v3, v3, 10, v4
  s_sub_u32 s67, s50, 0x4000
  s_cselect_b32 s67, 1073741824, s67
  v_add_u32 v19, s67, v3
  s_lshl_b32 s54, s45, 9
  s_cmp_eq_u32 s45, 0
  s_cselect_b32 s62, 4294967040, -1
  s_add_u32 m0, s54, 6144
  s_mov_b32 exec_lo, s62
  s_mov_b32 exec_hi, 0
  buffer_load_dwordx4 v19, s[20:23], 0 offen lds
  s_mov_b64 exec, -1
  s_setprio 2
  s_mov_b32 s48, 0
  s_mov_b32 s49, 0
  v_lshlrev_b32_e64 v2, 4, v1
  s_cmp_eq_u32 s45, 0
  s_cselect_b64 s[6:7], s[6:7], s[12:13]
  s_cmp_eq_u32 s45, 2
  s_cselect_b64 s[6:7], s[14:15], s[6:7]
  s_add_u32 m0, s52, 86016
  s_mov_b32 s48, 0
  buffer_load_dwordx4 v21, s[28:31], s48 offen lds
  v_and_b32 v11, 15, v1
  v_lshrrev_b32_e64 v4, 4, v1
  v_bfe_u32 v190, v1, 1, 3
  v_xor_b32 v190, v190, v4
  v_lshlrev_b32 v190, 4, v190
  v_lshl_add_u32 v23, v11, 7, v190
  v_xor_b32_e64 v24, 64, v23
  v_bfe_u32 v190, v1, 3, 2
  v_xor_b32 v190, s45, v190
  v_lshlrev_b32 v190, 5, v190
  v_lshl_add_u32 v190, v4, 10, v190
  v_bfe_u32 v191, v1, 2, 2
  v_lshl_add_u32 v190, v191, 7, v190
  v_and_b32_e64 v3, 3, v1
  v_lshl_add_u32 v190, v3, 3, v190
  v_add_u32 v25, 61440, v190
  v_add_u32 v26, 122880, v190
  v_mov_b32 v34, 0x3f803f80
  v_mov_b32 v35, 0x3f803f80
  v_mov_b32 v36, 0x3f803f80
  v_mov_b32 v37, 0x3f803f80
  v_and_b32 v3, 0x70, v2
  ds_write_b128 v3, v[34:37] offset:6144
  ds_write_b128 v3, v[34:37] offset:24576
  ds_write_b128 v3, v[34:37] offset:43008
  s_add_u32 m0, s52, 90112
  s_mov_b32 s48, 114688
  buffer_load_dwordx4 v21, s[28:31], s48 offen lds
  s_add_u32 s40, s38, 0
  s_addc_u32 s41, s39, 0
  s_mov_b64 s[12:13], s[18:19]
  s_mov_b32 s42, 0x970000
  s_mov_b32 s43, 0x20000
  s_mov_b32 s38, 0x100
  s_mov_b32 s39, 0x20000
  s_mov_b32 s10, 0x80000
  s_mov_b32 s11, 0x20000
  s_mov_b32 s18, 0x1c0000
  s_mov_b32 s19, 0x20000
  s_mov_b32 s14, 0x200000
  s_mov_b32 s15, 0x20000
  s_and_b32 s66, s2, 7
  s_bfe_u32 s67, s2, 0x20003
  s_lshl2_add_u32 s66, s66, s67
  s_lshr_b32 s60, s2, 5
  s_and_b32 s67, s66, 30
  s_add_u32 s61, s66, s67
  s_lshl3_add_u32 s66, s66, s60
  s_lshl_b32 s66, s66, 9
  s_add_u32 s64, s66, 9437440
  s_lshl_b32 s66, s45, 28
  v_lshl_add_u32 v3, v1, 2, s66
  v_mov_b32 v188, 0
  s_add_u32 m0, s52, 94208
  s_mov_b32 s48, 0
  buffer_load_dwordx4 v21, s[32:35], s48 offen lds
  v_mov_b32 v189, 0
  buffer_store_dword v188, v3, s[40:43], s64 offen sc1
  ds_write_b32 v188, v188 offset:5892
  ds_write_b32 v188, v188 offset:5896
  s_bitcmp1_b32 s45, 1
  s_cselect_b64 s[8:9], s[16:17], s[8:9]
  s_cselect_b32 s10, s18, s10
  s_cselect_b32 s67, 7, 2
  s_cselect_b32 s5, 512, 0
  v_lshrrev_b32 v3, 3, v1
  v_cmp_gt_u32 vcc, s67, v3
  s_mul_i32 s67, s67, s2
  v_add_u32 v3, s67, v3
  v_and_b32 v4, 0x70, v2
  v_lshl_add_u32 v178, v3, 10, v4
  v_add_u32_e64 v3, s5, v3
  v_lshl_add_u32 v179, v3, 7, v4
  s_bitcmp1_b32 s45, 0
  s_cselect_b64 vcc, 0, vcc
  v_mov_b32_e64 v4, 1073741824
  v_add_u32 v179, 9601024, v179
  v_cndmask_b32 v178, v4, v178, vcc
  v_cndmask_b32 v179, v4, v179, vcc
  s_and_b32 s67, s47, 3
  s_lshl_b32 s67, s67, 6
  s_add_u32 s67, s67, 256
  v_subrev_u32 v176, s67, v0
  s_lshl_b32 s67, s46, 4
  v_lshl_add_u32 v176, v176, 22, s67
  s_add_u32 m0, s52, 98304
  s_mov_b32 s48, 114688
  buffer_load_dwordx4 v21, s[32:35], s48 offen lds
  v_mov_b32_e64 v6, 1
  s_or_b32 s67, s2, 0
  s_cmp_eq_u32 s45, 0
  s_cselect_b32 s66, 6, 7
  s_mul_i32 s67, s67, 3
  s_add_u32 s67, s67, 768
  s_mul_i32 s67, s67, s66
  s_mul_i32 s66, s66, 3
  s_sub_u32 s66, s66, 1
  s_cmp_eq_u32 s45, 3
  s_cselect_b32 s66, 0, s66
  v_min_u32 v209, s66, v1
  v_add_lshl_u32 v209, v209, s67, 7
  s_mov_b64 exec, 0
  s_branch L_P1wA
L_A1r:
  s_mov_b64 exec, -1
  s_waitcnt vmcnt(6)
  v_lshlrev_b32_e64 v200, 16, v184
  v_and_b32 v201, 0xffff0000, v184
  v_lshlrev_b32_e64 v202, 16, v185
  v_and_b32 v203, 0xffff0000, v185
  v_lshlrev_b32_e64 v204, 16, v186
  v_and_b32 v205, 0xffff0000, v186
  v_lshlrev_b32_e64 v206, 16, v187
  v_and_b32 v207, 0xffff0000, v187
  v_pk_add_f32 v[184:185], v[200:201], v[202:203]
  v_pk_add_f32 v[186:187], v[204:205], v[206:207]
  v_pk_add_f32 v[184:185], v[184:185], v[186:187]
  v_add_f32 v188, v184, v185
  s_add_u32 s63, s63, s53
  s_add_u32 m0, s53, 26496
  s_nop 0
  buffer_load_dwordx4 v18, s[20:23], s50 offen offset:128 lds
  s_lshr_b32 s63, s63, 6
  v_add_f32_dpp v188, v188, v188 row_ror:8 row_mask:0xf bank_mask:0xf
  s_nop 1
  v_add_f32_dpp v188, v188, v188 row_ror:4 row_mask:0xf bank_mask:0xf
  s_nop 1
  v_add_f32_dpp v188, v188, v188 row_ror:2 row_mask:0xf bank_mask:0xf
  s_nop 1
  v_add_f32_dpp v188, v188, v188 row_ror:1 row_mask:0xf bank_mask:0xf
  v_mov_b32 v191, v188
  s_nop 1
  v_permlane16_swap_b32 v188, v191
  v_add_f32 v188, v188, v191
  v_mov_b32 v191, v188
  s_nop 1
  v_permlane32_swap_b32 v188, v191
  v_add_f32_e64 v188, v188, v191
  v_mul_f32 v188, 0x3b000000, v188
  v_pk_add_f32 v[200:201], v[200:201], v[188:189] op_sel_hi:[1,0] neg_lo:[0,1] neg_hi:[0,1]
  v_pk_add_f32 v[202:203], v[202:203], v[188:189] op_sel_hi:[1,0] neg_lo:[0,1] neg_hi:[0,1]
  v_pk_add_f32 v[204:205], v[204:205], v[188:189] op_sel_hi:[1,0] neg_lo:[0,1] neg_hi:[0,1]
  v_pk_add_f32 v[206:207], v[206:207], v[188:189] op_sel_hi:[1,0] neg_lo:[0,1] neg_hi:[0,1]
  v_pk_mul_f32 v[184:185], v[200:201], v[200:201]
  v_pk_fma_f32 v[184:185], v[202:203], v[202:203], v[184:185]
  v_pk_fma_f32 v[184:185], v[204:205], v[204:205], v[184:185]
  v_pk_fma_f32 v[184:185], v[206:207], v[206:207], v[184:185]
  v_add_f32_e64 v189, v184, v185
  s_add_u32 s63, s63, 9568256
  v_lshlrev_b32_e64 v190, 24, v1
  v_add_f32_dpp v189, v189, v189 row_ror:8 row_mask:0xf bank_mask:0xf
  s_add_u32 m0, s53, 34688
  s_nop 0
  buffer_load_dwordx4 v18, s[20:23], s51 offen offset:128 lds
  v_add_f32_dpp v189, v189, v189 row_ror:4 row_mask:0xf bank_mask:0xf
  s_nop 1
  v_add_f32_dpp v189, v189, v189 row_ror:2 row_mask:0xf bank_mask:0xf
  s_nop 1
  v_add_f32_dpp v189, v189, v189 row_ror:1 row_mask:0xf bank_mask:0xf
  v_mov_b32 v191, v189
  s_nop 1
  v_permlane16_swap_b32 v189, v191
  v_add_f32 v189, v189, v191
  v_mov_b32 v191, v189
  s_nop 1
  v_permlane32_swap_b32 v189, v191
  v_add_f32_e64 v189, v189, v191
  v_mul_f32 v189, 0x3b000000, v189
  v_cvt_pk_bf16_f32 v184, v188, v188
  v_and_b32 v184, 0xffff0000, v184
  v_cvt_pk_bf16_f32 v189, v189, v189
  v_and_b32 v189, 0xffff0000, v189
  v_add_f32 v189, 0x3727c5ac, v189
  v_cvt_pk_bf16_f32 v189, v189, v189
  v_and_b32 v189, 0xffff0000, v189
  v_sqrt_f32 v189, v189
  s_nop 0
  v_cvt_pk_bf16_f32 v189, v189, v189
  v_and_b32 v189, 0xffff0000, v189
  v_rcp_f32 v185, v189
  v_mul_f32 v187, v189, v189
  v_mul_f32 v186, 0xbfb8aa3b, v185
  buffer_store_dwordx4 v[184:187], v190, s[40:43], s63 offen sc1
  s_waitcnt lgkmcnt(0) vmcnt(8)
  s_barrier
  s_add_u32 m0, s54, 24448
  s_mov_b32 exec_lo, s62
  s_mov_b32 exec_hi, 0
  buffer_load_dwordx4 v19, s[20:23], 0 offen offset:128 lds
  s_mov_b64 exec, -1
  s_add_u32 m0, s52, 110592
  s_mov_b32 s48, 196608
  buffer_load_dwordx4 v20, s[24:27], s48 offen lds
  s_add_u32 m0, s52, 114688
  s_mov_b32 s48, 294912
  buffer_load_dwordx4 v20, s[24:27], s48 offen lds
  s_add_u32 m0, s52, 126976
  s_mov_b32 s48, 229376
  buffer_load_dwordx4 v21, s[28:31], s48 offen lds
  buffer_load_dwordx4 v[192:195], v178, s[8:11], 0 offen offset:384
  ds_read_b64_tr_b16 v[232:233], v25 offset:0
  ds_read_b64_tr_b16 v[234:235], v25 offset:512
  ds_read_b64_tr_b16 v[236:237], v25 offset:4096
  ds_read_b64_tr_b16 v[238:239], v25 offset:4608
  ds_read_b128 v[170:173], v23 offset:22528
  ds_read_b128 v[228:231], v24 offset:22528
  ds_read_b128 v[166:169], v23 offset:20480
  ds_read_b128 v[224:227], v24 offset:20480
  ds_read_b128 v[162:165], v23 offset:18432
  ds_read_b128 v[220:223], v24 offset:18432
  ds_read_b128 v[158:161], v23 offset:16384
  ds_read_b128 v[216:219], v24 offset:16384
  ds_read_b64_tr_b16 v[240:241], v25 offset:8192
  ds_read_b64_tr_b16 v[242:243], v25 offset:8704
  ds_read_b64_tr_b16 v[244:245], v25 offset:12288
  ds_read_b64_tr_b16 v[246:247], v25 offset:12800
  s_waitcnt lgkmcnt(0) vmcnt(8)
  s_barrier
  v_mfma_f32_16x16x32_bf16 v[70:73], v[232:235], v[170:173], 0
  v_mfma_f32_16x16x32_bf16 v[70:73], v[236:239], v[228:231], v[70:73]
  v_mfma_f32_16x16x32_bf16 v[66:69], v[236:239], v[224:227], 0
  v_mfma_f32_16x16x32_bf16 v[66:69], v[232:235], v[166:169], v[66:69]
  v_mfma_f32_16x16x32_bf16 v[62:65], v[232:235], v[162:165], 0
  v_mfma_f32_16x16x32_bf16 v[62:65], v[236:239], v[220:223], v[62:65]
  v_mfma_f32_16x16x32_bf16 v[58:61], v[236:239], v[216:219], 0
  v_mfma_f32_16x16x32_bf16 v[58:61], v[232:235], v[158:161], v[58:61]
  v_mfma_f32_16x16x32_bf16 v[78:81], v[158:161], v[240:243], 0
  v_mfma_f32_16x16x32_bf16 v[78:81], v[216:219], v[244:247], v[78:81]
  v_mfma_f32_16x16x32_bf16 v[82:85], v[220:223], v[244:247], 0
  v_mfma_f32_16x16x32_bf16 v[82:85], v[162:165], v[240:243], v[82:85]
  v_mfma_f32_16x16x32_bf16 v[86:89], v[166:169], v[240:243], 0
  v_mfma_f32_16x16x32_bf16 v[86:89], v[224:227], v[244:247], v[86:89]
  v_mfma_f32_16x16x32_bf16 v[90:93], v[228:231], v[244:247], 0
  v_mfma_f32_16x16x32_bf16 v[90:93], v[170:173], v[240:243], v[90:93]
  s_add_u32 m0, s52, 131072
  s_mov_b32 s48, 344064
  buffer_load_dwordx4 v21, s[28:31], s48 offen lds
  ds_read_b64_tr_b16 v[232:233], v25 offset:16384
  ds_read_b64_tr_b16 v[234:235], v25 offset:16896
  s_add_u32 m0, s52, 135168
  s_mov_b32 s48, 229376
  buffer_load_dwordx4 v21, s[32:35], s48 offen lds
  ds_read_b64_tr_b16 v[236:237], v25 offset:20480
  ds_read_b64_tr_b16 v[238:239], v25 offset:20992
  s_add_u32 m0, s52, 139264
  s_mov_b32 s48, 344064
  buffer_load_dwordx4 v21, s[32:35], s48 offen lds
  ds_read_b64_tr_b16 v[240:241], v25 offset:24576
  ds_read_b64_tr_b16 v[242:243], v25 offset:25088
  ds_read_b64_tr_b16 v[244:245], v25 offset:28672
  s_add_u32 m0, s53, 44800
  ds_read_b64_tr_b16 v[246:247], v25 offset:29184
  buffer_load_dwordx4 v18, s[20:23], s50 offen offset:256 lds
  ds_read_b64_tr_b16 v[248:249], v25 offset:32768
  s_add_u32 m0, s53, 52992
  ds_read_b64_tr_b16 v[250:251], v25 offset:33280
  buffer_load_dwordx4 v18, s[20:23], s51 offen offset:256 lds
  ds_read_b64_tr_b16 v[252:253], v25 offset:36864
  ds_read_b64_tr_b16 v[254:255], v25 offset:37376
  s_waitcnt lgkmcnt(0) vmcnt(7)
  s_barrier
  v_mfma_f32_16x16x32_bf16 v[50:53], v[232:235], v[170:173], 0
  v_mfma_f32_16x16x32_bf16 v[50:53], v[236:239], v[228:231], v[50:53]
  v_mfma_f32_16x16x32_bf16 v[46:49], v[236:239], v[224:227], 0
  v_mfma_f32_16x16x32_bf16 v[46:49], v[232:235], v[166:169], v[46:49]
  v_mfma_f32_16x16x32_bf16 v[42:45], v[232:235], v[162:165], 0
  v_mfma_f32_16x16x32_bf16 v[42:45], v[236:239], v[220:223], v[42:45]
  v_mfma_f32_16x16x32_bf16 v[38:41], v[236:239], v[216:219], 0
  v_mfma_f32_16x16x32_bf16 v[38:41], v[232:235], v[158:161], v[38:41]
  v_mfma_f32_16x16x32_bf16 v[94:97], v[240:243], v[158:161], 0
  v_mfma_f32_16x16x32_bf16 v[94:97], v[244:247], v[216:219], v[94:97]
  v_mfma_f32_16x16x32_bf16 v[98:101], v[244:247], v[220:223], 0
  v_mfma_f32_16x16x32_bf16 v[98:101], v[240:243], v[162:165], v[98:101]
  v_mfma_f32_16x16x32_bf16 v[102:105], v[240:243], v[166:169], 0
  v_mfma_f32_16x16x32_bf16 v[102:105], v[244:247], v[224:227], v[102:105]
  v_mfma_f32_16x16x32_bf16 v[106:109], v[244:247], v[228:231], 0
  v_mfma_f32_16x16x32_bf16 v[106:109], v[240:243], v[170:173], v[106:109]
  v_mfma_f32_16x16x32_bf16 v[122:125], v[248:251], v[170:173], 0
  v_mfma_f32_16x16x32_bf16 v[122:125], v[252:255], v[228:231], v[122:125]
  v_mfma_f32_16x16x32_bf16 v[118:121], v[252:255], v[224:227], 0
  v_mfma_f32_16x16x32_bf16 v[118:121], v[248:251], v[166:169], v[118:121]
  v_mfma_f32_16x16x32_bf16 v[114:117], v[248:251], v[162:165], 0
  v_mfma_f32_16x16x32_bf16 v[114:117], v[252:255], v[220:223], v[114:117]
  v_mfma_f32_16x16x32_bf16 v[110:113], v[252:255], v[216:219], 0
  v_mfma_f32_16x16x32_bf16 v[110:113], v[248:251], v[158:161], v[110:113]
  s_add_u32 m0, s54, 42752
  s_mov_b32 exec_lo, s62
  s_mov_b32 exec_hi, 0
  buffer_load_dwordx4 v19, s[20:23], 0 offen offset:256 lds
  s_mov_b64 exec, -1
  ds_read_b64_tr_b16 v[232:233], v25 offset:40960
  ds_read_b64_tr_b16 v[234:235], v25 offset:41472
  s_add_u32 m0, s52, 151552
  s_mov_b32 s48, 393216
  buffer_load_dwordx4 v20, s[24:27], s48 offen lds
  ds_read_b64_tr_b16 v[236:237], v25 offset:45056
  ds_read_b64_tr_b16 v[238:239], v25 offset:45568
  ds_read_b128 v[170:173], v23 offset:40960
  s_add_u32 m0, s52, 155648
  s_mov_b32 s48, 491520
  buffer_load_dwordx4 v20, s[24:27], s48 offen lds
  ds_read_b128 v[228:231], v24 offset:40960
  ds_read_b128 v[166:169], v23 offset:38912
  ds_read_b128 v[224:227], v24 offset:38912
  s_add_u32 m0, s52, 65536
  s_mov_b32 s48, 458752
  buffer_load_dwordx4 v21, s[28:31], s48 offen lds
  ds_read_b128 v[162:165], v23 offset:36864
  ds_read_b128 v[220:223], v24 offset:36864
  global_load_dword v177, v209, s[6:7]
  ds_read_b128 v[158:161], v23 offset:34816
  ds_read_b128 v[216:219], v24 offset:34816
  ds_read_b64_tr_b16 v[240:241], v25 offset:49152
  s_waitcnt vmcnt(10)
  buffer_store_dwordx4 v[192:195], v179, s[40:43], 0 offen sc1
  ds_read_b64_tr_b16 v[242:243], v25 offset:49664
  ds_read_b64_tr_b16 v[244:245], v25 offset:53248
  ds_read_b64_tr_b16 v[246:247], v25 offset:53760
  s_or_b32 s67, s2, 0
  s_sub_u32 s69, s45, 1
  s_cselect_b64 s[0:1], s[8:9], s[16:17]
  s_cselect_b32 s68, 16, 56
  s_cselect_b32 s69, 0, s69
  s_mul_i32 s69, s69, 19
  v_min_u32 v211, 18, v1
  v_add_u32 v211, s69, v211
  s_sub_u32 s69, s68, 1
  v_min_u32 v211, s69, v211
  s_mul_i32 s68, s68, s67
  v_and_b32 v3, 7, v211
  v_cmp_eq_u32 vcc, 3, v3
  v_add_lshl_u32 v211, v211, s68, 7
  v_xor_b32 v3, 128, v211
  v_cndmask_b32 v211, v211, v3, vcc
  s_lshl_b32 s66, s46, 13
  s_lshl2_add_u32 s66, s47, s66
  s_add_u32 s66, s66, 9437568
  v_lshl_add_u32 v33, v11, 9, s66
  v_lshrrev_b32 v3, 4, v1
  v_lshl_add_u32 v33, v3, 28, v33
  s_mul_i32 s66, s46, 589824
  s_add_u32 s66, s66, 294912
  s_add_u32 s66, s66, s52
  s_lshl_b32 s67, s47, 12
  s_add_u32 s57, s66, s67
  s_xor_b32 s67, s67, 8192
  s_add_u32 s55, s66, s67
  s_add_u32 s55, s55, 114688
  s_add_u32 s56, s55, 147456
  s_add_u32 s58, s57, 147456
  s_and_b32 s67, s45, 1
  s_lshl4_add_u32 s65, s67, s64
  s_bitcmp1_b32 s45, 1
  s_cselect_b32 s67, 48, 0
  s_cselect_b32 s68, 32, 0
  s_lshl4_add_u32 s69, s45, s67
  s_add_u32 s68, s68, s69
  s_lshr_b32 s67, 255, s60
  s_and_b32 s67, s67, s61
  s_bitcmp1_b32 s67, 0
  s_cselect_b32 s66, 8, 0
  s_cselect_b32 s5, -8, 8
  s_add_u32 s69, s69, s66
  s_add_u32 s68, s68, s66
  s_lshl_b32 s5, s5, 2
  s_mul_i32 s66, s61, 144
  s_add_u32 s66, s66, s68
  s_lshl_b32 s66, s66, 10
  v_and_b32 v3, 0x300, v2
  v_add3_u32 v9, v3, v2, s66
  v_lshrrev_b32 v4, 3, v1
  v_and_b32 v3, 6, v4
  v_bitop3_b32 v3, v3, v1, 7 bitop3:0x28
  v_lshlrev_b32 v3, 4, v3
  v_and_b32 v5, 4, v4
  v_add_u32_e64 v4, v4, v5
  s_lshl_b32 s60, s60, 7
  s_lshl_b32 s69, s69, 14
  s_add_u32 s69, s69, s60
  s_lshl_b32 s68, s68, 11
  s_add_u32 s68, s68, 9601024
  s_cmp_eq_u32 s60, 384
  s_cselect_b32 s69, s68, s69
  s_cselect_b32 s64, 9, 12
  s_cselect_b32 s67, 7, 10
  v_lshl_add_u32 v3, v4, s67, v3
  v_add_u32 v7, s69, v3
  v_lshrrev_b32 v3, 4, v0
  v_lshlrev_b32 v4, 3, v11
  v_lshl_add_u32 v3, v3, 10, v4
  s_lshl_b32 s66, s61, 15
  s_add_u32 s66, s66, s60
  v_add_u32 v8, s66, v3
  v_lshrrev_b32 v3, 5, v1
  v_lshl_add_u32 v3, v3, 13, s53
  v_bfe_u32 v4, v1, 2, 3
  v_lshl_add_u32 v3, v4, 7, v3
  v_bfe_u32 v4, v1, 3, 2
  v_lshl_add_u32 v3, v4, 5, v3
  v_and_b32_e64 v4, 3, v1
  v_lshl_add_u32 v12, v4, 3, v3
  v_xor_b32 v13, 32, v12
  v_xor_b32 v14, 64, v12
  v_xor_b32 v15, 96, v12
  v_add_u32 v212, 81920, v12
  v_add_u32 v213, 81920, v13
  v_add_u32 v214, 81920, v14
  v_add_u32 v215, 81920, v15
  s_lshl_b32 s66, s46, 11
  s_sub_u32 s66, s66, 256
  s_cselect_b32 s67, 256, 0
  s_add_u32 s66, s66, 9568256
  s_min_u32 s61, s52, 2048
  v_add_u32 v29, s61, v2
  v_subrev_u32 v3, s67, v29
  v_add_u32 v29, s66, v29
  s_sub_u32 s67, 2304, s67
  v_cmp_gt_u32 vcc, s67, v3
  v_mov_b32 v4, 1073741824
  s_nop 0
  v_cndmask_b32 v29, v4, v29, vcc
  s_lshl_b32 s66, s45, 6
  v_lshlrev_b32 v30, 4, v11
  v_lshl_add_u32 v5, v11, 2, s66
  v_and_b32 v31, 0x30, v1
  v_add_u32_e64 v3, s66, v31
  s_lshl_b32 s66, s45, 9
  v_lshl_add_u32 v10, v1, 3, s66
  v_lshrrev_b32 v182, 3, v1
  v_and_b32_e64 v182, 6, v182
  s_movk_i32 s66, 0x9c
  v_lshrrev_b32 v182, v182, s66
  v_lshrrev_b32_e64 v183, 2, v1
  v_bitop3_b32 v16, v182, v183, 3 bitop3:0x28
  v_lshrrev_b32 v183, 4, v0
  v_lshlrev_b32 v182, 2, v16
  v_sub_u32_e64 v182, v182, v183
  s_add_u32 s66, s45, 80
  v_add_u32_e64 v182, s66, v182
  v_lshl_add_u32 v11, v182, 10, v8
  s_waitcnt lgkmcnt(0) vmcnt(8)
  s_barrier
  v_mfma_f32_16x16x32_bf16 v[70:73], v[232:235], v[170:173], v[70:73]
  v_mfma_f32_16x16x32_bf16 v[70:73], v[236:239], v[228:231], v[70:73]
  v_mfma_f32_16x16x32_bf16 v[66:69], v[236:239], v[224:227], v[66:69]
  v_mfma_f32_16x16x32_bf16 v[66:69], v[232:235], v[166:169], v[66:69]
  v_mfma_f32_16x16x32_bf16 v[62:65], v[232:235], v[162:165], v[62:65]
  v_mfma_f32_16x16x32_bf16 v[62:65], v[236:239], v[220:223], v[62:65]
  v_mfma_f32_16x16x32_bf16 v[58:61], v[236:239], v[216:219], v[58:61]
  v_mfma_f32_16x16x32_bf16 v[58:61], v[232:235], v[158:161], v[58:61]
  v_mfma_f32_16x16x32_bf16 v[78:81], v[158:161], v[240:243], v[78:81]
  v_mfma_f32_16x16x32_bf16 v[78:81], v[216:219], v[244:247], v[78:81]
  v_mfma_f32_16x16x32_bf16 v[82:85], v[220:223], v[244:247], v[82:85]
  v_mfma_f32_16x16x32_bf16 v[82:85], v[162:165], v[240:243], v[82:85]
  v_mfma_f32_16x16x32_bf16 v[86:89], v[166:169], v[240:243], v[86:89]
  v_mfma_f32_16x16x32_bf16 v[86:89], v[224:227], v[244:247], v[86:89]
  v_mfma_f32_16x16x32_bf16 v[90:93], v[228:231], v[244:247], v[90:93]
  v_mfma_f32_16x16x32_bf16 v[90:93], v[170:173], v[240:243], v[90:93]
  s_add_u32 m0, s52, 69632
  s_mov_b32 s48, 573440
  buffer_load_dwordx4 v21, s[28:31], s48 offen lds
  ds_read_b64_tr_b16 v[232:233], v25 offset:57344
  ds_read_b64_tr_b16 v[234:235], v25 offset:57856
  s_add_u32 m0, s52, 73728
  s_mov_b32 s48, 458752
  buffer_load_dwordx4 v21, s[32:35], s48 offen lds
  ds_read_b64_tr_b16 v[236:237], v26 offset:0
  ds_read_b64_tr_b16 v[238:239], v26 offset:512
  s_add_u32 m0, s52, 77824
  s_mov_b32 s48, 573440
  buffer_load_dwordx4 v21, s[32:35], s48 offen lds
  ds_read_b64_tr_b16 v[240:241], v26 offset:4096
  ds_read_b64_tr_b16 v[242:243], v26 offset:4608
  ds_read_b64_tr_b16 v[244:245], v26 offset:8192
  s_add_u32 m0, s53, 7808
  ds_read_b64_tr_b16 v[246:247], v26 offset:8704
  buffer_load_dwordx4 v18, s[20:23], s50 offen offset:384 lds
  ds_read_b64_tr_b16 v[248:249], v26 offset:12288
  s_add_u32 m0, s53, 16000
  ds_read_b64_tr_b16 v[250:251], v26 offset:12800
  buffer_load_dwordx4 v18, s[20:23], s51 offen offset:384 lds
  ds_read_b64_tr_b16 v[252:253], v26 offset:16384
  ds_read_b64_tr_b16 v[254:255], v26 offset:16896
  s_waitcnt lgkmcnt(0) vmcnt(5)
  s_barrier
  v_mfma_f32_16x16x32_bf16 v[50:53], v[232:235], v[170:173], v[50:53]
  v_mfma_f32_16x16x32_bf16 v[50:53], v[236:239], v[228:231], v[50:53]
  v_mfma_f32_16x16x32_bf16 v[46:49], v[236:239], v[224:227], v[46:49]
  v_mfma_f32_16x16x32_bf16 v[46:49], v[232:235], v[166:169], v[46:49]
  v_mfma_f32_16x16x32_bf16 v[42:45], v[232:235], v[162:165], v[42:45]
  v_mfma_f32_16x16x32_bf16 v[42:45], v[236:239], v[220:223], v[42:45]
  v_mfma_f32_16x16x32_bf16 v[38:41], v[236:239], v[216:219], v[38:41]
  v_mfma_f32_16x16x32_bf16 v[38:41], v[232:235], v[158:161], v[38:41]
  v_mfma_f32_16x16x32_bf16 v[94:97], v[240:243], v[158:161], v[94:97]
  v_mfma_f32_16x16x32_bf16 v[94:97], v[244:247], v[216:219], v[94:97]
  v_mfma_f32_16x16x32_bf16 v[98:101], v[244:247], v[220:223], v[98:101]
  v_mfma_f32_16x16x32_bf16 v[98:101], v[240:243], v[162:165], v[98:101]
  v_mfma_f32_16x16x32_bf16 v[102:105], v[240:243], v[166:169], v[102:105]
  v_mfma_f32_16x16x32_bf16 v[102:105], v[244:247], v[224:227], v[102:105]
  v_mfma_f32_16x16x32_bf16 v[106:109], v[244:247], v[228:231], v[106:109]
  v_mfma_f32_16x16x32_bf16 v[106:109], v[240:243], v[170:173], v[106:109]
  v_mfma_f32_16x16x32_bf16 v[122:125], v[248:251], v[170:173], v[122:125]
  v_mfma_f32_16x16x32_bf16 v[122:125], v[252:255], v[228:231], v[122:125]
  v_mfma_f32_16x16x32_bf16 v[118:121], v[252:255], v[224:227], v[118:121]
  v_mfma_f32_16x16x32_bf16 v[118:121], v[248:251], v[166:169], v[118:121]
  v_mfma_f32_16x16x32_bf16 v[114:117], v[248:251], v[162:165], v[114:117]
  v_mfma_f32_16x16x32_bf16 v[114:117], v[252:255], v[220:223], v[114:117]
  v_mfma_f32_16x16x32_bf16 v[110:113], v[252:255], v[216:219], v[110:113]
  v_mfma_f32_16x16x32_bf16 v[110:113], v[248:251], v[158:161], v[110:113]
  s_add_u32 m0, s54, 5760
  s_mov_b32 exec_lo, s62
  s_mov_b32 exec_hi, 0
  buffer_load_dwordx4 v19, s[20:23], 0 offen offset:384 lds
  s_mov_b64 exec, -1
  ds_read_b64_tr_b16 v[232:233], v26 offset:20480
  ds_read_b64_tr_b16 v[234:235], v26 offset:20992
  ds_read_b64_tr_b16 v[236:237], v26 offset:24576
  s_add_u32 m0, s52, 90112
  s_mov_b32 s48, 589824
  buffer_load_dwordx4 v20, s[24:27], s48 offen lds
  ds_read_b64_tr_b16 v[238:239], v26 offset:25088
  ds_read_b128 v[170:173], v23 offset:59392
  ds_read_b128 v[228:231], v24 offset:59392
  s_add_u32 m0, s52, 94208
  s_mov_b32 s48, 688128
  buffer_load_dwordx4 v20, s[24:27], s48 offen lds
  ds_read_b128 v[166:169], v23 offset:57344
  ds_read_b128 v[224:227], v24 offset:57344
  ds_read_b128 v[162:165], v23 offset:55296
  s_add_u32 m0, s52, 106496
  s_mov_b32 s48, 688128
  buffer_load_dwordx4 v21, s[28:31], s48 offen lds
  ds_read_b128 v[220:223], v24 offset:55296
  ds_read_b128 v[158:161], v23 offset:53248
  ds_read_b128 v[216:219], v24 offset:53248
  s_and_b32 s3, s45, 1
  s_cmp_eq_u32 s3, 0
  s_cbranch_scc0 L_Aa4
  buffer_atomic_add v6, v176, s[36:39], 0 offen sc1
L_Aa4:
  ds_read_b64_tr_b16 v[240:241], v26 offset:28672
  ds_read_b64_tr_b16 v[242:243], v26 offset:29184
  ds_read_b64_tr_b16 v[244:245], v26 offset:32768
  ds_read_b64_tr_b16 v[246:247], v26 offset:33280
  s_waitcnt lgkmcnt(0) vmcnt(6)
  s_barrier
  v_mfma_f32_16x16x32_bf16 v[70:73], v[232:235], v[170:173], v[70:73]
  v_mfma_f32_16x16x32_bf16 v[70:73], v[236:239], v[228:231], v[70:73]
  v_mfma_f32_16x16x32_bf16 v[66:69], v[236:239], v[224:227], v[66:69]
  v_mfma_f32_16x16x32_bf16 v[66:69], v[232:235], v[166:169], v[66:69]
  v_mfma_f32_16x16x32_bf16 v[62:65], v[232:235], v[162:165], v[62:65]
  v_mfma_f32_16x16x32_bf16 v[62:65], v[236:239], v[220:223], v[62:65]
  v_mfma_f32_16x16x32_bf16 v[58:61], v[236:239], v[216:219], v[58:61]
  v_mfma_f32_16x16x32_bf16 v[58:61], v[232:235], v[158:161], v[58:61]
  v_mfma_f32_16x16x32_bf16 v[78:81], v[158:161], v[240:243], v[78:81]
  v_mfma_f32_16x16x32_bf16 v[78:81], v[216:219], v[244:247], v[78:81]
  v_mfma_f32_16x16x32_bf16 v[82:85], v[220:223], v[244:247], v[82:85]
  v_mfma_f32_16x16x32_bf16 v[82:85], v[162:165], v[240:243], v[82:85]
  v_mfma_f32_16x16x32_bf16 v[86:89], v[166:169], v[240:243], v[86:89]
  v_mfma_f32_16x16x32_bf16 v[86:89], v[224:227], v[244:247], v[86:89]
  v_mfma_f32_16x16x32_bf16 v[90:93], v[228:231], v[244:247], v[90:93]
  v_mfma_f32_16x16x32_bf16 v[90:93], v[170:173], v[240:243], v[90:93]
  s_add_u32 m0, s52, 110592
  s_mov_b32 s48, 802816
  buffer_load_dwordx4 v21, s[28:31], s48 offen lds
  ds_read_b64_tr_b16 v[232:233], v26 offset:36864
  s_add_u32 m0, s52, 114688
  s_mov_b32 s48, 688128
  buffer_load_dwordx4 v21, s[32:35], s48 offen lds
  ds_read_b64_tr_b16 v[234:235], v26 offset:37376
  ds_read_b64_tr_b16 v[236:237], v25 offset:0
  s_add_u32 m0, s52, 118784
  s_mov_b32 s48, 802816
  buffer_load_dwordx4 v21, s[32:35], s48 offen lds
  ds_read_b64_tr_b16 v[238:239], v25 offset:512
  ds_read_b64_tr_b16 v[240:241], v25 offset:4096
  s_add_u32 m0, s53, 26112
  ds_read_b64_tr_b16 v[242:243], v25 offset:4608
  buffer_load_dwordx4 v18, s[20:23], s50 offen offset:512 lds
L_A1w0:
  s_cbranch_execz L_A1w1
  s_nop 0
  s_add_u32 m0, s53, 34304
  ds_read_b64_tr_b16 v[244:245], v25 offset:8192
  buffer_load_dwordx4 v18, s[20:23], s51 offen offset:512 lds
  ds_read_b64_tr_b16 v[246:247], v25 offset:8704
  s_add_u32 m0, s54, 24064
  s_mov_b32 exec_lo, s62
  s_mov_b32 exec_hi, 0
  buffer_load_dwordx4 v19, s[20:23], 0 offen offset:512 lds
  s_mov_b64 exec, -1
  ds_read_b64_tr_b16 v[248:249], v25 offset:12288
  ds_read_b64_tr_b16 v[250:251], v25 offset:12800
  s_and_b32 s3, s45, 1
  s_cmp_eq_u32 s3, 1
  s_cbranch_scc0 L_Aa5
  buffer_atomic_add v6, v176, s[36:39], 0 offen sc1
L_Aa5:
  ds_read_b64_tr_b16 v[252:253], v25 offset:16384
  ds_read_b64_tr_b16 v[254:255], v25 offset:16896
  s_waitcnt lgkmcnt(0) vmcnt(7)
  s_barrier
  v_mfma_f32_16x16x32_bf16 v[50:53], v[232:235], v[170:173], v[50:53]
  v_mfma_f32_16x16x32_bf16 v[50:53], v[236:239], v[228:231], v[50:53]
  v_mfma_f32_16x16x32_bf16 v[46:49], v[236:239], v[224:227], v[46:49]
  v_mfma_f32_16x16x32_bf16 v[46:49], v[232:235], v[166:169], v[46:49]
  v_mfma_f32_16x16x32_bf16 v[42:45], v[232:235], v[162:165], v[42:45]
  v_mfma_f32_16x16x32_bf16 v[42:45], v[236:239], v[220:223], v[42:45]
  v_mfma_f32_16x16x32_bf16 v[38:41], v[236:239], v[216:219], v[38:41]
  v_mfma_f32_16x16x32_bf16 v[38:41], v[232:235], v[158:161], v[38:41]
  v_mfma_f32_16x16x32_bf16 v[94:97], v[240:243], v[158:161], v[94:97]
  v_mfma_f32_16x16x32_bf16 v[94:97], v[244:247], v[216:219], v[94:97]
  v_mfma_f32_16x16x32_bf16 v[98:101], v[244:247], v[220:223], v[98:101]
  v_mfma_f32_16x16x32_bf16 v[98:101], v[240:243], v[162:165], v[98:101]
  v_mfma_f32_16x16x32_bf16 v[102:105], v[240:243], v[166:169], v[102:105]
  v_mfma_f32_16x16x32_bf16 v[102:105], v[244:247], v[224:227], v[102:105]
  v_mfma_f32_16x16x32_bf16 v[106:109], v[244:247], v[228:231], v[106:109]
  v_mfma_f32_16x16x32_bf16 v[106:109], v[240:243], v[170:173], v[106:109]
  v_mfma_f32_16x16x32_bf16 v[122:125], v[248:251], v[170:173], v[122:125]
  v_mfma_f32_16x16x32_bf16 v[122:125], v[252:255], v[228:231], v[122:125]
  v_mfma_f32_16x16x32_bf16 v[118:121], v[252:255], v[224:227], v[118:121]
  v_mfma_f32_16x16x32_bf16 v[118:121], v[248:251], v[166:169], v[118:121]
  v_mfma_f32_16x16x32_bf16 v[114:117], v[248:251], v[162:165], v[114:117]
  v_mfma_f32_16x16x32_bf16 v[114:117], v[252:255], v[220:223], v[114:117]
  v_mfma_f32_16x16x32_bf16 v[110:113], v[252:255], v[216:219], v[110:113]
  v_mfma_f32_16x16x32_bf16 v[110:113], v[248:251], v[158:161], v[110:113]
  s_add_u32 m0, s52, 131072
  s_mov_b32 s48, 786432
  buffer_load_dwordx4 v20, s[24:27], s48 offen lds
  ds_read_b64_tr_b16 v[232:233], v25 offset:20480
  ds_read_b64_tr_b16 v[234:235], v25 offset:20992
  ds_read_b64_tr_b16 v[236:237], v25 offset:24576
  ds_read_b64_tr_b16 v[238:239], v25 offset:25088
  s_add_u32 m0, s52, 135168
  s_mov_b32 s48, 884736
  buffer_load_dwordx4 v20, s[24:27], s48 offen lds
  ds_read_b128 v[170:173], v23 offset:22528
  ds_read_b128 v[228:231], v24 offset:22528
  ds_read_b128 v[166:169], v23 offset:20480
  ds_read_b128 v[224:227], v24 offset:20480
  s_add_u32 m0, s52, 147456
  s_mov_b32 s48, 917504
  buffer_load_dwordx4 v21, s[28:31], s48 offen lds
  ds_read_b128 v[162:165], v23 offset:18432
  ds_read_b128 v[220:223], v24 offset:18432
  ds_read_b128 v[158:161], v23 offset:16384
  ds_read_b128 v[216:219], v24 offset:16384
  s_add_u32 m0, s52, 151552
  s_mov_b32 s48, 1032192
  buffer_load_dwordx4 v21, s[28:31], s48 offen lds
  ds_read_b64_tr_b16 v[240:241], v25 offset:28672
  ds_read_b64_tr_b16 v[242:243], v25 offset:29184
  ds_read_b64_tr_b16 v[244:245], v25 offset:32768
  ds_read_b64_tr_b16 v[246:247], v25 offset:33280
  s_waitcnt lgkmcnt(0) vmcnt(7)
  s_barrier
  v_mfma_f32_16x16x32_bf16 v[70:73], v[232:235], v[170:173], v[70:73]
  v_mfma_f32_16x16x32_bf16 v[70:73], v[236:239], v[228:231], v[70:73]
  v_mfma_f32_16x16x32_bf16 v[66:69], v[236:239], v[224:227], v[66:69]
  v_mfma_f32_16x16x32_bf16 v[66:69], v[232:235], v[166:169], v[66:69]
  v_mfma_f32_16x16x32_bf16 v[62:65], v[232:235], v[162:165], v[62:65]
  v_mfma_f32_16x16x32_bf16 v[62:65], v[236:239], v[220:223], v[62:65]
  v_mfma_f32_16x16x32_bf16 v[58:61], v[236:239], v[216:219], v[58:61]
  v_mfma_f32_16x16x32_bf16 v[58:61], v[232:235], v[158:161], v[58:61]
  v_mfma_f32_16x16x32_bf16 v[78:81], v[158:161], v[240:243], v[78:81]
  v_mfma_f32_16x16x32_bf16 v[78:81], v[216:219], v[244:247], v[78:81]
  v_mfma_f32_16x16x32_bf16 v[82:85], v[220:223], v[244:247], v[82:85]
  v_mfma_f32_16x16x32_bf16 v[82:85], v[162:165], v[240:243], v[82:85]
  v_mfma_f32_16x16x32_bf16 v[86:89], v[166:169], v[240:243], v[86:89]
  v_mfma_f32_16x16x32_bf16 v[86:89], v[224:227], v[244:247], v[86:89]
  v_mfma_f32_16x16x32_bf16 v[90:93], v[228:231], v[244:247], v[90:93]
  v_mfma_f32_16x16x32_bf16 v[90:93], v[170:173], v[240:243], v[90:93]
  s_add_u32 m0, s52, 155648
  s_mov_b32 s48, 917504
  buffer_load_dwordx4 v21, s[32:35], s48 offen lds
  ds_read_b64_tr_b16 v[232:233], v25 offset:36864
  ds_read_b64_tr_b16 v[234:235], v25 offset:37376
  s_add_u32 m0, s52, 159744
  s_mov_b32 s48, 1032192
  buffer_load_dwordx4 v21, s[32:35], s48 offen lds
  ds_read_b64_tr_b16 v[236:237], v25 offset:40960
  ds_read_b64_tr_b16 v[238:239], v25 offset:41472
  s_add_u32 m0, s53, 44416
  ds_read_b64_tr_b16 v[240:241], v25 offset:45056
  buffer_load_dwordx4 v18, s[20:23], s50 offen offset:640 lds
  ds_read_b64_tr_b16 v[242:243], v25 offset:45568
  s_add_u32 m0, s53, 52608
  ds_read_b64_tr_b16 v[244:245], v25 offset:49152
  buffer_load_dwordx4 v18, s[20:23], s51 offen offset:640 lds
  ds_read_b64_tr_b16 v[246:247], v25 offset:49664
  s_add_u32 m0, s54, 42368
  s_mov_b32 exec_lo, s62
  s_mov_b32 exec_hi, 0
  buffer_load_dwordx4 v19, s[20:23], 0 offen offset:640 lds
  s_mov_b64 exec, -1
  ds_read_b64_tr_b16 v[248:249], v25 offset:53248
  ds_read_b64_tr_b16 v[250:251], v25 offset:53760
  s_add_u32 m0, s52, 69632
  s_mov_b32 s48, 983040
  buffer_load_dwordx4 v20, s[24:27], s48 offen lds
  ds_read_b64_tr_b16 v[252:253], v25 offset:57344
  ds_read_b64_tr_b16 v[254:255], v25 offset:57856
  s_waitcnt lgkmcnt(0) vmcnt(8)
  s_barrier
  v_mfma_f32_16x16x32_bf16 v[50:53], v[232:235], v[170:173], v[50:53]
  v_mfma_f32_16x16x32_bf16 v[50:53], v[236:239], v[228:231], v[50:53]
  v_mfma_f32_16x16x32_bf16 v[46:49], v[236:239], v[224:227], v[46:49]
  v_mfma_f32_16x16x32_bf16 v[46:49], v[232:235], v[166:169], v[46:49]
  v_mfma_f32_16x16x32_bf16 v[42:45], v[232:235], v[162:165], v[42:45]
  v_mfma_f32_16x16x32_bf16 v[42:45], v[236:239], v[220:223], v[42:45]
  v_mfma_f32_16x16x32_bf16 v[38:41], v[236:239], v[216:219], v[38:41]
  v_mfma_f32_16x16x32_bf16 v[38:41], v[232:235], v[158:161], v[38:41]
  v_mfma_f32_16x16x32_bf16 v[94:97], v[240:243], v[158:161], v[94:97]
  v_mfma_f32_16x16x32_bf16 v[94:97], v[244:247], v[216:219], v[94:97]
  v_mfma_f32_16x16x32_bf16 v[98:101], v[244:247], v[220:223], v[98:101]
  v_mfma_f32_16x16x32_bf16 v[98:101], v[240:243], v[162:165], v[98:101]
  v_mfma_f32_16x16x32_bf16 v[102:105], v[240:243], v[166:169], v[102:105]
  v_mfma_f32_16x16x32_bf16 v[102:105], v[244:247], v[224:227], v[102:105]
  v_mfma_f32_16x16x32_bf16 v[106:109], v[244:247], v[228:231], v[106:109]
  v_mfma_f32_16x16x32_bf16 v[106:109], v[240:243], v[170:173], v[106:109]
  v_mfma_f32_16x16x32_bf16 v[122:125], v[248:251], v[170:173], v[122:125]
  v_mfma_f32_16x16x32_bf16 v[122:125], v[252:255], v[228:231], v[122:125]
  v_mfma_f32_16x16x32_bf16 v[118:121], v[252:255], v[224:227], v[118:121]
  v_mfma_f32_16x16x32_bf16 v[118:121], v[248:251], v[166:169], v[118:121]
  v_mfma_f32_16x16x32_bf16 v[114:117], v[248:251], v[162:165], v[114:117]
  v_mfma_f32_16x16x32_bf16 v[114:117], v[252:255], v[220:223], v[114:117]
  v_mfma_f32_16x16x32_bf16 v[110:113], v[252:255], v[216:219], v[110:113]
  v_mfma_f32_16x16x32_bf16 v[110:113], v[248:251], v[158:161], v[110:113]
  s_add_u32 m0, s52, 73728
  s_mov_b32 s48, 1081344
  buffer_load_dwordx4 v20, s[24:27], s48 offen lds
  ds_read_b64_tr_b16 v[232:233], v26 offset:0
  ds_read_b64_tr_b16 v[234:235], v26 offset:512
  ds_read_b64_tr_b16 v[236:237], v26 offset:4096
  s_add_u32 m0, s52, 86016
  s_mov_b32 s48, 1146880
  buffer_load_dwordx4 v21, s[28:31], s48 offen lds
  ds_read_b64_tr_b16 v[238:239], v26 offset:4608
  ds_read_b128 v[170:173], v23 offset:40960
  ds_read_b128 v[228:231], v24 offset:40960
  s_add_u32 m0, s52, 90112
  s_mov_b32 s48, 1261568
  buffer_load_dwordx4 v21, s[28:31], s48 offen lds
  ds_read_b128 v[166:169], v23 offset:38912
  ds_read_b128 v[224:227], v24 offset:38912
  ds_read_b128 v[162:165], v23 offset:36864
  s_add_u32 m0, s52, 94208
  s_mov_b32 s48, 1146880
  buffer_load_dwordx4 v21, s[32:35], s48 offen lds
  ds_read_b128 v[220:223], v24 offset:36864
  ds_read_b128 v[158:161], v23 offset:34816
  ds_read_b128 v[216:219], v24 offset:34816
  s_bitcmp1_b32 s2, 7
  s_cbranch_scc1 L_A1p3
  global_load_dword v177, v211, s[0:1]
L_A1p3:
  ds_read_b64_tr_b16 v[240:241], v26 offset:8192
  ds_read_b64_tr_b16 v[242:243], v26 offset:8704
  ds_read_b64_tr_b16 v[244:245], v26 offset:12288
  ds_read_b64_tr_b16 v[246:247], v26 offset:12800
  s_waitcnt lgkmcnt(0) vmcnt(8)
  s_barrier
  v_mfma_f32_16x16x32_bf16 v[70:73], v[232:235], v[170:173], v[70:73]
  v_mfma_f32_16x16x32_bf16 v[70:73], v[236:239], v[228:231], v[70:73]
  v_mfma_f32_16x16x32_bf16 v[66:69], v[236:239], v[224:227], v[66:69]
  v_mfma_f32_16x16x32_bf16 v[66:69], v[232:235], v[166:169], v[66:69]
  v_mfma_f32_16x16x32_bf16 v[62:65], v[232:235], v[162:165], v[62:65]
  v_mfma_f32_16x16x32_bf16 v[62:65], v[236:239], v[220:223], v[62:65]
  v_mfma_f32_16x16x32_bf16 v[58:61], v[236:239], v[216:219], v[58:61]
  v_mfma_f32_16x16x32_bf16 v[58:61], v[232:235], v[158:161], v[58:61]
  v_mfma_f32_16x16x32_bf16 v[78:81], v[158:161], v[240:243], v[78:81]
  v_mfma_f32_16x16x32_bf16 v[78:81], v[216:219], v[244:247], v[78:81]
  v_mfma_f32_16x16x32_bf16 v[82:85], v[220:223], v[244:247], v[82:85]
  v_mfma_f32_16x16x32_bf16 v[82:85], v[162:165], v[240:243], v[82:85]
  v_mfma_f32_16x16x32_bf16 v[86:89], v[166:169], v[240:243], v[86:89]
  v_mfma_f32_16x16x32_bf16 v[86:89], v[224:227], v[244:247], v[86:89]
  v_mfma_f32_16x16x32_bf16 v[90:93], v[228:231], v[244:247], v[90:93]
  v_mfma_f32_16x16x32_bf16 v[90:93], v[170:173], v[240:243], v[90:93]
  s_add_u32 m0, s52, 98304
  s_mov_b32 s48, 1261568
  buffer_load_dwordx4 v21, s[32:35], s48 offen lds
  ds_read_b64_tr_b16 v[232:233], v26 offset:16384
  ds_read_b64_tr_b16 v[234:235], v26 offset:16896
  s_add_u32 m0, s53, 7424
  ds_read_b64_tr_b16 v[236:237], v26 offset:20480
  buffer_load_dwordx4 v18, s[20:23], s50 offen offset:768 lds
  ds_read_b64_tr_b16 v[238:239], v26 offset:20992
  s_add_u32 m0, s53, 15616
  ds_read_b64_tr_b16 v[240:241], v26 offset:24576
  buffer_load_dwordx4 v18, s[20:23], s51 offen offset:768 lds
  ds_read_b64_tr_b16 v[242:243], v26 offset:25088
  s_add_u32 m0, s54, 5376
  s_mov_b32 exec_lo, s62
  s_mov_b32 exec_hi, 0
  buffer_load_dwordx4 v19, s[20:23], 0 offen offset:768 lds
  s_mov_b64 exec, -1
  ds_read_b64_tr_b16 v[244:245], v26 offset:28672
  ds_read_b64_tr_b16 v[246:247], v26 offset:29184
  s_add_u32 m0, s52, 110592
  s_mov_b32 s48, 1179648
  buffer_load_dwordx4 v20, s[24:27], s48 offen lds
  ds_read_b64_tr_b16 v[248:249], v26 offset:32768
  ds_read_b64_tr_b16 v[250:251], v26 offset:33280
  s_add_u32 m0, s52, 114688
  s_mov_b32 s48, 1277952
  buffer_load_dwordx4 v20, s[24:27], s48 offen lds
  ds_read_b64_tr_b16 v[252:253], v26 offset:36864
  ds_read_b64_tr_b16 v[254:255], v26 offset:37376
  s_waitcnt lgkmcnt(0) vmcnt(9)
  s_barrier
  v_mfma_f32_16x16x32_bf16 v[50:53], v[232:235], v[170:173], v[50:53]
  v_mfma_f32_16x16x32_bf16 v[50:53], v[236:239], v[228:231], v[50:53]
  v_mfma_f32_16x16x32_bf16 v[46:49], v[236:239], v[224:227], v[46:49]
  v_mfma_f32_16x16x32_bf16 v[46:49], v[232:235], v[166:169], v[46:49]
  v_mfma_f32_16x16x32_bf16 v[42:45], v[232:235], v[162:165], v[42:45]
  v_mfma_f32_16x16x32_bf16 v[42:45], v[236:239], v[220:223], v[42:45]
  v_mfma_f32_16x16x32_bf16 v[38:41], v[236:239], v[216:219], v[38:41]
  v_mfma_f32_16x16x32_bf16 v[38:41], v[232:235], v[158:161], v[38:41]
  v_mfma_f32_16x16x32_bf16 v[94:97], v[240:243], v[158:161], v[94:97]
  v_mfma_f32_16x16x32_bf16 v[94:97], v[244:247], v[216:219], v[94:97]
  v_mfma_f32_16x16x32_bf16 v[98:101], v[244:247], v[220:223], v[98:101]
  v_mfma_f32_16x16x32_bf16 v[98:101], v[240:243], v[162:165], v[98:101]
  v_mfma_f32_16x16x32_bf16 v[102:105], v[240:243], v[166:169], v[102:105]
  v_mfma_f32_16x16x32_bf16 v[102:105], v[244:247], v[224:227], v[102:105]
  v_mfma_f32_16x16x32_bf16 v[106:109], v[244:247], v[228:231], v[106:109]
  v_mfma_f32_16x16x32_bf16 v[106:109], v[240:243], v[170:173], v[106:109]
  v_mfma_f32_16x16x32_bf16 v[122:125], v[248:251], v[170:173], v[122:125]
  v_mfma_f32_16x16x32_bf16 v[122:125], v[252:255], v[228:231], v[122:125]
  v_mfma_f32_16x16x32_bf16 v[118:121], v[252:255], v[224:227], v[118:121]
  v_mfma_f32_16x16x32_bf16 v[118:121], v[248:251], v[166:169], v[118:121]
  v_mfma_f32_16x16x32_bf16 v[114:117], v[248:251], v[162:165], v[114:117]
  v_mfma_f32_16x16x32_bf16 v[114:117], v[252:255], v[220:223], v[114:117]
  v_mfma_f32_16x16x32_bf16 v[110:113], v[252:255], v[216:219], v[110:113]
  v_mfma_f32_16x16x32_bf16 v[110:113], v[248:251], v[158:161], v[110:113]
  buffer_load_dword v174, v2, s[36:39], s52 offen sc1
  ds_read_b64_tr_b16 v[232:233], v25 offset:0
  ds_read_b64_tr_b16 v[234:235], v25 offset:512
  ds_read_b64_tr_b16 v[236:237], v25 offset:4096
  s_add_u32 m0, s52, 126976
  s_mov_b32 s48, 1376256
  buffer_load_dwordx4 v21, s[28:31], s48 offen lds
  ds_read_b64_tr_b16 v[238:239], v25 offset:4608
  ds_read_b128 v[170:173], v23 offset:59392
  ds_read_b128 v[228:231], v24 offset:59392
  s_add_u32 m0, s52, 131072
  s_mov_b32 s48, 1490944
  buffer_load_dwordx4 v21, s[28:31], s48 offen lds
  ds_read_b128 v[166:169], v23 offset:57344
  ds_read_b128 v[224:227], v24 offset:57344
  ds_read_b128 v[162:165], v23 offset:55296
  s_add_u32 m0, s52, 135168
  s_mov_b32 s48, 1376256
  buffer_load_dwordx4 v21, s[32:35], s48 offen lds
  ds_read_b128 v[220:223], v24 offset:55296
  ds_read_b128 v[158:161], v23 offset:53248
  ds_read_b128 v[216:219], v24 offset:53248
  s_add_u32 m0, s52, 139264
  s_mov_b32 s48, 1490944
  buffer_load_dwordx4 v21, s[32:35], s48 offen lds
  ds_read_b64_tr_b16 v[240:241], v25 offset:8192
  ds_read_b64_tr_b16 v[242:243], v25 offset:8704
  ds_read_b64_tr_b16 v[244:245], v25 offset:12288
  ds_read_b64_tr_b16 v[246:247], v25 offset:12800
  s_waitcnt lgkmcnt(0) vmcnt(10)
  s_barrier
  v_mfma_f32_16x16x32_bf16 v[70:73], v[232:235], v[170:173], v[70:73]
  v_mfma_f32_16x16x32_bf16 v[70:73], v[236:239], v[228:231], v[70:73]
  v_mfma_f32_16x16x32_bf16 v[66:69], v[236:239], v[224:227], v[66:69]
  v_mfma_f32_16x16x32_bf16 v[66:69], v[232:235], v[166:169], v[66:69]
  v_mfma_f32_16x16x32_bf16 v[62:65], v[232:235], v[162:165], v[62:65]
  v_mfma_f32_16x16x32_bf16 v[62:65], v[236:239], v[220:223], v[62:65]
  v_mfma_f32_16x16x32_bf16 v[58:61], v[236:239], v[216:219], v[58:61]
  v_mfma_f32_16x16x32_bf16 v[58:61], v[232:235], v[158:161], v[58:61]
  v_mfma_f32_16x16x32_bf16 v[78:81], v[158:161], v[240:243], v[78:81]
  v_mfma_f32_16x16x32_bf16 v[78:81], v[216:219], v[244:247], v[78:81]
  v_mfma_f32_16x16x32_bf16 v[82:85], v[220:223], v[244:247], v[82:85]
  v_mfma_f32_16x16x32_bf16 v[82:85], v[162:165], v[240:243], v[82:85]
  v_mfma_f32_16x16x32_bf16 v[86:89], v[166:169], v[240:243], v[86:89]
  v_mfma_f32_16x16x32_bf16 v[86:89], v[224:227], v[244:247], v[86:89]
  v_mfma_f32_16x16x32_bf16 v[90:93], v[228:231], v[244:247], v[90:93]
  v_mfma_f32_16x16x32_bf16 v[90:93], v[170:173], v[240:243], v[90:93]
  s_add_u32 m0, s53, 25728
  ds_read_b64_tr_b16 v[232:233], v25 offset:16384
  buffer_load_dwordx4 v18, s[20:23], s50 offen offset:896 lds
  ds_read_b64_tr_b16 v[234:235], v25 offset:16896
  s_add_u32 m0, s53, 33920
  ds_read_b64_tr_b16 v[236:237], v25 offset:20480
  buffer_load_dwordx4 v18, s[20:23], s51 offen offset:896 lds
  ds_read_b64_tr_b16 v[238:239], v25 offset:20992
  s_add_u32 m0, s54, 23680
  s_mov_b32 exec_lo, s62
  s_mov_b32 exec_hi, 0
  buffer_load_dwordx4 v19, s[20:23], 0 offen offset:896 lds
  s_mov_b64 exec, -1
  ds_read_b64_tr_b16 v[240:241], v25 offset:24576
  ds_read_b64_tr_b16 v[242:243], v25 offset:25088
  s_add_u32 m0, s52, 151552
  s_mov_b32 s48, 1376256
  buffer_load_dwordx4 v20, s[24:27], s48 offen lds
  ds_read_b64_tr_b16 v[244:245], v25 offset:28672
  ds_read_b64_tr_b16 v[246:247], v25 offset:29184
  s_add_u32 m0, s52, 155648
  s_mov_b32 s48, 1474560
  buffer_load_dwordx4 v20, s[24:27], s48 offen lds
  ds_read_b64_tr_b16 v[248:249], v25 offset:32768
  ds_read_b64_tr_b16 v[250:251], v25 offset:33280
  s_add_u32 m0, s52, 65536
  s_mov_b32 s48, 1605632
  buffer_load_dwordx4 v21, s[28:31], s48 offen lds
  ds_read_b64_tr_b16 v[252:253], v25 offset:36864
  ds_read_b64_tr_b16 v[254:255], v25 offset:37376
  s_cmp_eq_u32 s45, 0
  s_cselect_b32 s67, 0xffff, 0
  s_waitcnt vmcnt(10)
  v_cmp_gt_u32 vcc, 16, v174
  s_nop 0
  s_and_b32 s66, vcc_lo, s67
  s_cbranch_scc0 L_Ack
  s_mov_b32 s68, 262144
L_Acl:
  s_sleep 8
  buffer_load_dword v174, v2, s[36:39], s52 offen sc1
  s_sub_u32 s68, s68, 1
  s_waitcnt vmcnt(0)
  s_cbranch_scc1 L_Ack
  v_cmp_gt_u32 vcc, 16, v174
  s_nop 0
  s_and_b32 s66, vcc_lo, s67
  s_cbranch_scc1 L_Acl
L_Ack:
  s_waitcnt lgkmcnt(0)
  s_barrier
  v_mfma_f32_16x16x32_bf16 v[50:53], v[232:235], v[170:173], v[50:53]
  v_mfma_f32_16x16x32_bf16 v[50:53], v[236:239], v[228:231], v[50:53]
  v_mfma_f32_16x16x32_bf16 v[46:49], v[236:239], v[224:227], v[46:49]
  v_mfma_f32_16x16x32_bf16 v[46:49], v[232:235], v[166:169], v[46:49]
  v_mfma_f32_16x16x32_bf16 v[42:45], v[232:235], v[162:165], v[42:45]
  v_mfma_f32_16x16x32_bf16 v[42:45], v[236:239], v[220:223], v[42:45]
  v_mfma_f32_16x16x32_bf16 v[38:41], v[236:239], v[216:219], v[38:41]
  v_mfma_f32_16x16x32_bf16 v[38:41], v[232:235], v[158:161], v[38:41]
  v_mfma_f32_16x16x32_bf16 v[94:97], v[240:243], v[158:161], v[94:97]
  v_mfma_f32_16x16x32_bf16 v[94:97], v[244:247], v[216:219], v[94:97]
  v_mfma_f32_16x16x32_bf16 v[98:101], v[244:247], v[220:223], v[98:101]
  v_mfma_f32_16x16x32_bf16 v[98:101], v[240:243], v[162:165], v[98:101]
  v_mfma_f32_16x16x32_bf16 v[102:105], v[240:243], v[166:169], v[102:105]
  v_mfma_f32_16x16x32_bf16 v[102:105], v[244:247], v[224:227], v[102:105]
  v_mfma_f32_16x16x32_bf16 v[106:109], v[244:247], v[228:231], v[106:109]
  v_mfma_f32_16x16x32_bf16 v[106:109], v[240:243], v[170:173], v[106:109]
  v_mfma_f32_16x16x32_bf16 v[122:125], v[248:251], v[170:173], v[122:125]
  v_mfma_f32_16x16x32_bf16 v[122:125], v[252:255], v[228:231], v[122:125]
  v_mfma_f32_16x16x32_bf16 v[118:121], v[252:255], v[224:227], v[118:121]
  v_mfma_f32_16x16x32_bf16 v[118:121], v[248:251], v[166:169], v[118:121]
  v_mfma_f32_16x16x32_bf16 v[114:117], v[248:251], v[162:165], v[114:117]
  v_mfma_f32_16x16x32_bf16 v[114:117], v[252:255], v[220:223], v[114:117]
  v_mfma_f32_16x16x32_bf16 v[110:113], v[252:255], v[216:219], v[110:113]
  v_mfma_f32_16x16x32_bf16 v[110:113], v[248:251], v[158:161], v[110:113]
  s_add_u32 m0, s52, 69632
  s_mov_b32 s48, 1720320
  buffer_load_dwordx4 v21, s[28:31], s48 offen lds
  ds_read_b64_tr_b16 v[232:233], v25 offset:40960
  ds_read_b64_tr_b16 v[234:235], v25 offset:41472
  ds_read_b64_tr_b16 v[236:237], v25 offset:45056
  ds_read_b64_tr_b16 v[238:239], v25 offset:45568
  s_add_u32 m0, s52, 73728
  s_mov_b32 s48, 1605632
  buffer_load_dwordx4 v21, s[32:35], s48 offen lds
  ds_read_b128 v[170:173], v23 offset:22528
  ds_read_b128 v[228:231], v24 offset:22528
  ds_read_b128 v[166:169], v23 offset:20480
  ds_read_b128 v[224:227], v24 offset:20480
  s_add_u32 m0, s52, 77824
  s_mov_b32 s48, 1720320
  buffer_load_dwordx4 v21, s[32:35], s48 offen lds
  ds_read_b128 v[162:165], v23 offset:18432
  ds_read_b128 v[220:223], v24 offset:18432
  ds_read_b128 v[158:161], v23 offset:16384
  ds_read_b128 v[216:219], v24 offset:16384
  s_cmp_eq_u32 s64, 9
  s_cselect_b64 s[8:9], s[40:41], s[8:9]
  s_cselect_b32 s10, s42, s10
  s_add_u32 m0, s53, 43008
  s_lshl_b32 s60, 0, s64
  buffer_load_dwordx4 v7, s[8:11], s60 offen lds
  ds_read_b64_tr_b16 v[240:241], v25 offset:49152
  ds_read_b64_tr_b16 v[242:243], v25 offset:49664
  ds_read_b64_tr_b16 v[244:245], v25 offset:53248
  ds_read_b64_tr_b16 v[246:247], v25 offset:53760
  s_waitcnt lgkmcnt(0) vmcnt(10)
  s_barrier
  v_mfma_f32_16x16x32_bf16 v[70:73], v[232:235], v[170:173], v[70:73]
  v_mfma_f32_16x16x32_bf16 v[70:73], v[236:239], v[228:231], v[70:73]
  v_mfma_f32_16x16x32_bf16 v[66:69], v[236:239], v[224:227], v[66:69]
  v_mfma_f32_16x16x32_bf16 v[66:69], v[232:235], v[166:169], v[66:69]
  v_mfma_f32_16x16x32_bf16 v[62:65], v[232:235], v[162:165], v[62:65]
  v_mfma_f32_16x16x32_bf16 v[62:65], v[236:239], v[220:223], v[62:65]
  v_mfma_f32_16x16x32_bf16 v[58:61], v[236:239], v[216:219], v[58:61]
  v_mfma_f32_16x16x32_bf16 v[58:61], v[232:235], v[158:161], v[58:61]
  v_mfma_f32_16x16x32_bf16 v[78:81], v[158:161], v[240:243], v[78:81]
  v_mfma_f32_16x16x32_bf16 v[78:81], v[216:219], v[244:247], v[78:81]
  v_mfma_f32_16x16x32_bf16 v[82:85], v[220:223], v[244:247], v[82:85]
  v_mfma_f32_16x16x32_bf16 v[82:85], v[162:165], v[240:243], v[82:85]
  v_mfma_f32_16x16x32_bf16 v[86:89], v[166:169], v[240:243], v[86:89]
  v_mfma_f32_16x16x32_bf16 v[86:89], v[224:227], v[244:247], v[86:89]
  v_mfma_f32_16x16x32_bf16 v[90:93], v[228:231], v[244:247], v[90:93]
  v_mfma_f32_16x16x32_bf16 v[90:93], v[170:173], v[240:243], v[90:93]
  s_add_u32 m0, s61, 0
  s_lshr_b32 s61, s61, 2
  buffer_load_dwordx4 v29, s[40:43], 0 offen sc1 lds
  ds_read_b64_tr_b16 v[232:233], v25 offset:57344
  s_add_u32 m0, s61, 3072
  ds_read_b64_tr_b16 v[234:235], v25 offset:57856
  buffer_load_dword v29, s[40:43], 0 offen sc1 lds
  s_add_u32 m0, s61, 3836
  ds_read_b64_tr_b16 v[236:237], v26 offset:0
  buffer_load_dword v29, s[40:43], 0 offen offset:4 sc1 lds
  ds_read_b64_tr_b16 v[238:239], v26 offset:512
  s_add_u32 m0, s53, 51200
  s_lshl_b32 s60, 4, s64
  buffer_load_dwordx4 v7, s[8:11], s60 offen lds
  ds_read_b64_tr_b16 v[240:241], v26 offset:4096
  s_add_u32 m0, s53, 81920
  s_lshl_b32 s60, 1, s64
  buffer_load_dwordx4 v7, s[8:11], s60 offen lds
  ds_read_b64_tr_b16 v[242:243], v26 offset:4608
  s_add_u32 m0, s53, 90112
  s_lshl_b32 s60, 5, s64
  buffer_load_dwordx4 v7, s[8:11], s60 offen lds
  ds_read_b64_tr_b16 v[244:245], v26 offset:8192
  ds_read_b64_tr_b16 v[246:247], v26 offset:8704
  s_add_u32 m0, s53, 98304
  s_lshl_b32 s60, 8, s64
  buffer_load_dwordx4 v7, s[8:11], s60 offen lds
  ds_read_b64_tr_b16 v[248:249], v26 offset:12288
  s_add_u32 m0, s53, 106496
  s_lshl_b32 s60, 12, s64
  buffer_load_dwordx4 v7, s[8:11], s60 offen lds
  ds_read_b64_tr_b16 v[250:251], v26 offset:12800
  s_add_u32 m0, s53, 6144
  s_lshl_b32 s60, 9, s64
  buffer_load_dwordx4 v7, s[8:11], s60 offen lds
  ds_read_b64_tr_b16 v[252:253], v26 offset:16384
  ds_read_b64_tr_b16 v[254:255], v26 offset:16896
  s_waitcnt lgkmcnt(0) vmcnt(14)
  s_barrier
  v_mfma_f32_16x16x32_bf16 v[50:53], v[232:235], v[170:173], v[50:53]
  v_mfma_f32_16x16x32_bf16 v[50:53], v[236:239], v[228:231], v[50:53]
  v_mfma_f32_16x16x32_bf16 v[46:49], v[236:239], v[224:227], v[46:49]
  v_mfma_f32_16x16x32_bf16 v[46:49], v[232:235], v[166:169], v[46:49]
  v_mfma_f32_16x16x32_bf16 v[42:45], v[232:235], v[162:165], v[42:45]
  v_mfma_f32_16x16x32_bf16 v[42:45], v[236:239], v[220:223], v[42:45]
  v_mfma_f32_16x16x32_bf16 v[38:41], v[236:239], v[216:219], v[38:41]
  v_mfma_f32_16x16x32_bf16 v[38:41], v[232:235], v[158:161], v[38:41]
  v_mfma_f32_16x16x32_bf16 v[94:97], v[240:243], v[158:161], v[94:97]
  v_mfma_f32_16x16x32_bf16 v[94:97], v[244:247], v[216:219], v[94:97]
  v_mfma_f32_16x16x32_bf16 v[98:101], v[244:247], v[220:223], v[98:101]
  v_mfma_f32_16x16x32_bf16 v[98:101], v[240:243], v[162:165], v[98:101]
  v_mfma_f32_16x16x32_bf16 v[102:105], v[240:243], v[166:169], v[102:105]
  v_mfma_f32_16x16x32_bf16 v[102:105], v[244:247], v[224:227], v[102:105]
  v_mfma_f32_16x16x32_bf16 v[106:109], v[244:247], v[228:231], v[106:109]
  v_mfma_f32_16x16x32_bf16 v[106:109], v[240:243], v[170:173], v[106:109]
  v_mfma_f32_16x16x32_bf16 v[122:125], v[248:251], v[170:173], v[122:125]
  v_mfma_f32_16x16x32_bf16 v[122:125], v[252:255], v[228:231], v[122:125]
  v_mfma_f32_16x16x32_bf16 v[118:121], v[252:255], v[224:227], v[118:121]
  v_mfma_f32_16x16x32_bf16 v[118:121], v[248:251], v[166:169], v[118:121]
  v_mfma_f32_16x16x32_bf16 v[114:117], v[248:251], v[162:165], v[114:117]
  v_mfma_f32_16x16x32_bf16 v[114:117], v[252:255], v[220:223], v[114:117]
  v_mfma_f32_16x16x32_bf16 v[110:113], v[252:255], v[216:219], v[110:113]
  v_mfma_f32_16x16x32_bf16 v[110:113], v[248:251], v[158:161], v[110:113]
  s_add_u32 m0, s53, 14336
  s_lshl_b32 s60, 13, s64
  buffer_load_dwordx4 v7, s[8:11], s60 offen lds
  ds_read_b64_tr_b16 v[232:233], v26 offset:20480
  ds_read_b64_tr_b16 v[234:235], v26 offset:20992
  ds_read_b64_tr_b16 v[236:237], v26 offset:24576
  ds_read_b64_tr_b16 v[238:239], v26 offset:25088
  s_add_u32 m0, s53, 114688
  s_lshl_b32 s60, 16, s64
  buffer_load_dwordx4 v7, s[8:11], s60 offen lds
  ds_read_b128 v[170:173], v23 offset:40960
  ds_read_b128 v[228:231], v24 offset:40960
  ds_read_b128 v[166:169], v23 offset:38912
  ds_read_b128 v[224:227], v24 offset:38912
  s_add_u32 m0, s53, 122880
  s_lshl_b32 s60, 20, s64
  buffer_load_dwordx4 v7, s[8:11], s60 offen lds
  ds_read_b128 v[162:165], v23 offset:36864
  ds_read_b128 v[220:223], v24 offset:36864
  ds_read_b128 v[158:161], v23 offset:34816
  ds_read_b128 v[216:219], v24 offset:34816
  s_add_u32 m0, s53, 131072
  s_lshl_b32 s60, 17, s64
  buffer_load_dwordx4 v7, s[8:11], s60 offen lds
  ds_read_b64_tr_b16 v[240:241], v26 offset:28672
  ds_read_b64_tr_b16 v[242:243], v26 offset:29184
  ds_read_b64_tr_b16 v[244:245], v26 offset:32768
  ds_read_b64_tr_b16 v[246:247], v26 offset:33280
  s_waitcnt lgkmcnt(0) vmcnt(14)
  s_barrier
  v_mfma_f32_16x16x32_bf16 v[70:73], v[232:235], v[170:173], v[70:73]
  v_mfma_f32_16x16x32_bf16 v[70:73], v[236:239], v[228:231], v[70:73]
  v_mfma_f32_16x16x32_bf16 v[66:69], v[236:239], v[224:227], v[66:69]
  v_mfma_f32_16x16x32_bf16 v[66:69], v[232:235], v[166:169], v[66:69]
  v_mfma_f32_16x16x32_bf16 v[62:65], v[232:235], v[162:165], v[62:65]
  v_mfma_f32_16x16x32_bf16 v[62:65], v[236:239], v[220:223], v[62:65]
  v_mfma_f32_16x16x32_bf16 v[58:61], v[236:239], v[216:219], v[58:61]
  v_mfma_f32_16x16x32_bf16 v[58:61], v[232:235], v[158:161], v[58:61]
  v_mfma_f32_16x16x32_bf16 v[78:81], v[158:161], v[240:243], v[78:81]
  v_mfma_f32_16x16x32_bf16 v[78:81], v[216:219], v[244:247], v[78:81]
  v_mfma_f32_16x16x32_bf16 v[82:85], v[220:223], v[244:247], v[82:85]
  v_mfma_f32_16x16x32_bf16 v[82:85], v[162:165], v[240:243], v[82:85]
  v_mfma_f32_16x16x32_bf16 v[86:89], v[166:169], v[240:243], v[86:89]
  v_mfma_f32_16x16x32_bf16 v[86:89], v[224:227], v[244:247], v[86:89]
  v_mfma_f32_16x16x32_bf16 v[90:93], v[228:231], v[244:247], v[90:93]
  v_mfma_f32_16x16x32_bf16 v[90:93], v[170:173], v[240:243], v[90:93]
  s_add_u32 m0, s53, 139264
  s_lshl_b32 s60, 21, s64
  buffer_load_dwordx4 v7, s[8:11], s60 offen lds
  ds_read_b64_tr_b16 v[232:233], v26 offset:36864
  ds_read_b64_tr_b16 v[234:235], v26 offset:37376
  ds_read_b64_tr_b16 v[236:237], v25 offset:0
  ds_read_b64_tr_b16 v[238:239], v25 offset:512
  s_add_u32 m0, s53, 22528
  s_lshl_b32 s60, 24, s64
  buffer_load_dwordx4 v7, s[8:11], s60 offen lds
  ds_read_b64_tr_b16 v[240:241], v25 offset:4096
  ds_read_b64_tr_b16 v[242:243], v25 offset:4608
  ds_read_b64_tr_b16 v[244:245], v25 offset:8192
  ds_read_b64_tr_b16 v[246:247], v25 offset:8704
  s_add_u32 m0, s53, 30720
  s_lshl_b32 s60, 28, s64
  buffer_load_dwordx4 v7, s[8:11], s60 offen lds
  ds_read_b64_tr_b16 v[248:249], v25 offset:12288
L_A1w1:
  s_cbranch_execz L_A1r
  s_nop 0
  ds_read_b64_tr_b16 v[250:251], v25 offset:12800
  ds_read_b64_tr_b16 v[252:253], v25 offset:16384
  ds_read_b64_tr_b16 v[254:255], v25 offset:16896
  s_waitcnt lgkmcnt(0) vmcnt(13)
  s_barrier
  v_mfma_f32_16x16x32_bf16 v[50:53], v[232:235], v[170:173], v[50:53]
  v_mfma_f32_16x16x32_bf16 v[50:53], v[236:239], v[228:231], v[50:53]
  v_mfma_f32_16x16x32_bf16 v[46:49], v[236:239], v[224:227], v[46:49]
  v_mfma_f32_16x16x32_bf16 v[46:49], v[232:235], v[166:169], v[46:49]
  v_mfma_f32_16x16x32_bf16 v[42:45], v[232:235], v[162:165], v[42:45]
  v_mfma_f32_16x16x32_bf16 v[42:45], v[236:239], v[220:223], v[42:45]
  v_mfma_f32_16x16x32_bf16 v[38:41], v[236:239], v[216:219], v[38:41]
  v_mfma_f32_16x16x32_bf16 v[38:41], v[232:235], v[158:161], v[38:41]
  v_mfma_f32_16x16x32_bf16 v[94:97], v[240:243], v[158:161], v[94:97]
  v_mfma_f32_16x16x32_bf16 v[94:97], v[244:247], v[216:219], v[94:97]
  v_mfma_f32_16x16x32_bf16 v[98:101], v[244:247], v[220:223], v[98:101]
  v_mfma_f32_16x16x32_bf16 v[98:101], v[240:243], v[162:165], v[98:101]
  v_mfma_f32_16x16x32_bf16 v[102:105], v[240:243], v[166:169], v[102:105]
  v_mfma_f32_16x16x32_bf16 v[102:105], v[244:247], v[224:227], v[102:105]
  v_mfma_f32_16x16x32_bf16 v[106:109], v[244:247], v[228:231], v[106:109]
  v_mfma_f32_16x16x32_bf16 v[106:109], v[240:243], v[170:173], v[106:109]
  v_mfma_f32_16x16x32_bf16 v[122:125], v[248:251], v[170:173], v[122:125]
  v_mfma_f32_16x16x32_bf16 v[122:125], v[252:255], v[228:231], v[122:125]
  v_mfma_f32_16x16x32_bf16 v[118:121], v[252:255], v[224:227], v[118:121]
  v_mfma_f32_16x16x32_bf16 v[118:121], v[248:251], v[166:169], v[118:121]
  v_mfma_f32_16x16x32_bf16 v[114:117], v[248:251], v[162:165], v[114:117]
  v_mfma_f32_16x16x32_bf16 v[114:117], v[252:255], v[220:223], v[114:117]
  v_mfma_f32_16x16x32_bf16 v[110:113], v[252:255], v[216:219], v[110:113]
  v_mfma_f32_16x16x32_bf16 v[110:113], v[248:251], v[158:161], v[110:113]
  s_add_u32 m0, s53, 59392
  s_lshl_b32 s60, 25, s64
  buffer_load_dwordx4 v7, s[8:11], s60 offen lds
  ds_read_b128 v[180:183], v30 offset:2048
  ds_read_b128 v[22:25], v30 offset:1792
  ds_read_b128 v[18:21], v30 offset:1536
  ds_read_b128 v[150:153], v30 offset:1280
  s_waitcnt vmcnt(13)
  ds_read_b64_tr_b16 v[184:185], v12 offset:43008
  ds_read_b64_tr_b16 v[188:189], v13 offset:43008
  ds_read_b64_tr_b16 v[192:193], v14 offset:43008
  ds_read_b64_tr_b16 v[196:197], v15 offset:43008
  s_add_u32 m0, s53, 67584
  s_lshl_b32 s60, 29, s64
  buffer_load_dwordx4 v7, s[8:11], s60 offen lds
  s_waitcnt vmcnt(12)
  ds_read_b64_tr_b16 v[186:187], v212 offset:0
  ds_read_b64_tr_b16 v[190:191], v213 offset:0
  ds_read_b64_tr_b16 v[194:195], v214 offset:0
  ds_read_b64_tr_b16 v[198:199], v215 offset:0
  s_waitcnt vmcnt(10)
  ds_read_b64_tr_b16 v[200:201], v212 offset:16384
  ds_read_b64_tr_b16 v[204:205], v213 offset:16384
  ds_read_b64_tr_b16 v[216:217], v214 offset:16384
  ds_read_b64_tr_b16 v[220:221], v215 offset:16384
  s_setprio 2
  s_waitcnt lgkmcnt(8) vmcnt(7)
  s_lshl_b32 s60, s5, s64
  v_add_u32_e64 v7, s60, v7
  s_add_u32 m0, s53, 43008
  s_lshl_b32 s60, 0, s64
  buffer_load_dwordx4 v7, s[8:11], s60 offen lds
  s_waitcnt vmcnt(7)
  s_add_u32 m0, s53, 51200
  s_lshl_b32 s60, 4, s64
  buffer_load_dwordx4 v7, s[8:11], s60 offen lds
  ds_read_b64_tr_b16 v[202:203], v12 offset:6144
  ds_read_b64_tr_b16 v[206:207], v13 offset:6144
  ds_read_b64_tr_b16 v[218:219], v14 offset:6144
  ds_read_b64_tr_b16 v[222:223], v15 offset:6144
  s_waitcnt lgkmcnt(8) vmcnt(7)
  s_add_u32 m0, s53, 81920
  s_lshl_b32 s60, 1, s64
  buffer_load_dwordx4 v7, s[8:11], s60 offen lds
  s_waitcnt vmcnt(7)
  s_add_u32 m0, s53, 90112
  s_lshl_b32 s60, 5, s64
  buffer_load_dwordx4 v7, s[8:11], s60 offen lds
  ds_read_b64_tr_b16 v[224:225], v212 offset:32768
  ds_read_b64_tr_b16 v[228:229], v213 offset:32768
  ds_read_b64_tr_b16 v[232:233], v214 offset:32768
  ds_read_b64_tr_b16 v[236:237], v215 offset:32768
  s_barrier
  ds_read_b64 v[54:55], v10 offset:38912
  ds_read_b64 v[154:155], v10 offset:40960
  ds_read_b128 v[130:133], v3 offset:4864
  ds_read_b32 v134, v5 offset:5120
  ds_read_b128 v[126:129], v3 offset:4608
  ds_read_b128 v[138:141], v3 offset:5376
  ds_read_b128 v[142:145], v3 offset:5632
  s_waitcnt lgkmcnt(14) vmcnt(7)
  s_add_u32 m0, s53, 98304
  s_lshl_b32 s60, 8, s64
  buffer_load_dwordx4 v7, s[8:11], s60 offen lds
  s_waitcnt vmcnt(7)
  s_add_u32 m0, s53, 106496
  s_lshl_b32 s60, 12, s64
  buffer_load_dwordx4 v7, s[8:11], s60 offen lds
  ds_read_b64_tr_b16 v[226:227], v212 offset:49152
  ds_read_b64_tr_b16 v[230:231], v213 offset:49152
  ds_read_b64_tr_b16 v[234:235], v214 offset:49152
  ds_read_b64_tr_b16 v[238:239], v215 offset:49152
  s_waitcnt lgkmcnt(14) vmcnt(7)
  s_add_u32 m0, s53, 6144
  s_lshl_b32 s60, 9, s64
  buffer_load_dwordx4 v7, s[8:11], s60 offen lds
  s_waitcnt vmcnt(7)
  s_add_u32 m0, s53, 14336
  s_lshl_b32 s60, 13, s64
  buffer_load_dwordx4 v7, s[8:11], s60 offen lds
  ds_read_b64_tr_b16 v[240:241], v12 offset:22528
  ds_read_b64_tr_b16 v[244:245], v13 offset:22528
  ds_read_b64_tr_b16 v[248:249], v14 offset:22528
  ds_read_b64_tr_b16 v[252:253], v15 offset:22528
  s_waitcnt lgkmcnt(14) vmcnt(7)
  s_add_u32 m0, s53, 114688
  s_lshl_b32 s60, 16, s64
  buffer_load_dwordx4 v7, s[8:11], s60 offen lds
  s_waitcnt vmcnt(7)
  s_add_u32 m0, s53, 122880
  s_lshl_b32 s60, 20, s64
  buffer_load_dwordx4 v7, s[8:11], s60 offen lds
  ds_read_b64_tr_b16 v[242:243], v12 offset:59392
  ds_read_b64_tr_b16 v[246:247], v13 offset:59392
  ds_read_b64_tr_b16 v[250:251], v14 offset:59392
  ds_read_b64_tr_b16 v[254:255], v15 offset:59392
  s_waitcnt lgkmcnt(8) vmcnt(7)
  s_add_u32 m0, s53, 131072
  s_lshl_b32 s60, 17, s64
  buffer_load_dwordx4 v7, s[8:11], s60 offen lds
  s_waitcnt vmcnt(7)
  s_add_u32 m0, s53, 139264
  s_lshl_b32 s60, 21, s64
  buffer_load_dwordx4 v7, s[8:11], s60 offen lds
  s_waitcnt lgkmcnt(4) vmcnt(7)
  s_add_u32 m0, s53, 22528
  s_lshl_b32 s60, 24, s64
  buffer_load_dwordx4 v7, s[8:11], s60 offen lds
  s_waitcnt vmcnt(7)
  s_add_u32 m0, s53, 30720
  s_lshl_b32 s60, 28, s64
  buffer_load_dwordx4 v7, s[8:11], s60 offen lds
  s_waitcnt lgkmcnt(0) vmcnt(7)
  s_add_u32 m0, s53, 59392
  s_lshl_b32 s60, 25, s64
  buffer_load_dwordx4 v7, s[8:11], s60 offen lds
  s_waitcnt vmcnt(7)
  s_add_u32 m0, s53, 67584
  s_lshl_b32 s60, 29, s64
  buffer_load_dwordx4 v7, s[8:11], s60 offen lds
  ds_read_b128 v[168:171], v31 offset:4352
  ds_read_b128 v[164:167], v31 offset:3584
  ds_read_b128 v[26:29], v31 offset:4288
  ds_read_b128 v[172:175], v31 offset:3520
  v_pk_fma_f32 v[70:71], v[180:181], v[130:131], v[70:71] op_sel_hi:[0,1,1] neg_lo:[1,0,0] neg_hi:[1,0,0]
  v_pk_fma_f32 v[72:73], v[180:181], v[132:133], v[72:73] op_sel_hi:[0,1,1] neg_lo:[1,0,0] neg_hi:[1,0,0]
  v_pk_mul_f32 v[70:71], v[180:181], v[70:71] op_sel:[1,0]
  v_pk_mul_f32 v[72:73], v[180:181], v[72:73] op_sel:[1,0]
  v_cvt_pk_bf16_f32 v70, v70, v71
  v_cvt_pk_bf16_f32 v71, v72, v73
  s_waitcnt lgkmcnt(2)
  v_pk_fma_f32 v[90:91], v[164:165], v[134:135], v[90:91] op_sel_hi:[1,0,1] neg_lo:[1,0,0] neg_hi:[1,0,0]
  v_pk_fma_f32 v[92:93], v[166:167], v[134:135], v[92:93] op_sel_hi:[1,0,1] neg_lo:[1,0,0] neg_hi:[1,0,0]
  v_pk_mul_f32 v[90:91], v[90:91], v[168:169]
  v_pk_mul_f32 v[92:93], v[92:93], v[170:171]
  v_cvt_pk_bf16_f32 v162, v90, v91
  v_cvt_pk_bf16_f32 v163, v92, v93
  v_pk_fma_f32 v[50:51], v[180:181], v[126:127], v[50:51] op_sel_hi:[0,1,1] neg_lo:[1,0,0] neg_hi:[1,0,0]
  v_pk_fma_f32 v[52:53], v[180:181], v[128:129], v[52:53] op_sel_hi:[0,1,1] neg_lo:[1,0,0] neg_hi:[1,0,0]
  v_cvt_pk_bf16_f32 v72, v50, v51
  v_cvt_pk_bf16_f32 v73, v52, v53
  ds_read_b128 v[168:171], v31 offset:4224
  ds_read_b128 v[164:167], v31 offset:3456
  v_pk_fma_f32 v[66:67], v[22:23], v[130:131], v[66:67] op_sel_hi:[0,1,1] neg_lo:[1,0,0] neg_hi:[1,0,0]
  v_pk_fma_f32 v[68:69], v[22:23], v[132:133], v[68:69] op_sel_hi:[0,1,1] neg_lo:[1,0,0] neg_hi:[1,0,0]
  v_pk_mul_f32 v[66:67], v[22:23], v[66:67] op_sel:[1,0]
  v_pk_mul_f32 v[68:69], v[22:23], v[68:69] op_sel:[1,0]
  v_cvt_pk_bf16_f32 v66, v66, v67
  v_cvt_pk_bf16_f32 v67, v68, v69
  s_waitcnt lgkmcnt(2)
  v_pk_fma_f32 v[86:87], v[172:173], v[134:135], v[86:87] op_sel_hi:[1,0,1] neg_lo:[1,0,0] neg_hi:[1,0,0]
  v_pk_fma_f32 v[88:89], v[174:175], v[134:135], v[88:89] op_sel_hi:[1,0,1] neg_lo:[1,0,0] neg_hi:[1,0,0]
  v_pk_mul_f32 v[86:87], v[86:87], v[26:27]
  v_pk_mul_f32 v[88:89], v[88:89], v[28:29]
  v_cvt_pk_bf16_f32 v160, v86, v87
  v_cvt_pk_bf16_f32 v161, v88, v89
  v_pk_fma_f32 v[46:47], v[22:23], v[126:127], v[46:47] op_sel_hi:[0,1,1] neg_lo:[1,0,0] neg_hi:[1,0,0]
  v_pk_fma_f32 v[48:49], v[22:23], v[128:129], v[48:49] op_sel_hi:[0,1,1] neg_lo:[1,0,0] neg_hi:[1,0,0]
  v_cvt_pk_bf16_f32 v68, v46, v47
  v_cvt_pk_bf16_f32 v69, v48, v49
  ds_read_b128 v[26:29], v31 offset:4160
  ds_read_b128 v[172:175], v31 offset:3392
  v_pk_fma_f32 v[62:63], v[18:19], v[130:131], v[62:63] op_sel_hi:[0,1,1] neg_lo:[1,0,0] neg_hi:[1,0,0]
  v_pk_fma_f32 v[64:65], v[18:19], v[132:133], v[64:65] op_sel_hi:[0,1,1] neg_lo:[1,0,0] neg_hi:[1,0,0]
  v_pk_mul_f32 v[62:63], v[18:19], v[62:63] op_sel:[1,0]
  v_pk_mul_f32 v[64:65], v[18:19], v[64:65] op_sel:[1,0]
  v_cvt_pk_bf16_f32 v62, v62, v63
  v_cvt_pk_bf16_f32 v63, v64, v65
  s_waitcnt lgkmcnt(2)
  v_pk_fma_f32 v[82:83], v[164:165], v[134:135], v[82:83] op_sel_hi:[1,0,1] neg_lo:[1,0,0] neg_hi:[1,0,0]
  v_pk_fma_f32 v[84:85], v[166:167], v[134:135], v[84:85] op_sel_hi:[1,0,1] neg_lo:[1,0,0] neg_hi:[1,0,0]
  v_pk_mul_f32 v[82:83], v[82:83], v[168:169]
  v_pk_mul_f32 v[84:85], v[84:85], v[170:171]
  v_cvt_pk_bf16_f32 v158, v82, v83
  v_cvt_pk_bf16_f32 v159, v84, v85
  v_pk_fma_f32 v[42:43], v[18:19], v[126:127], v[42:43] op_sel_hi:[0,1,1] neg_lo:[1,0,0] neg_hi:[1,0,0]
  v_pk_fma_f32 v[44:45], v[18:19], v[128:129], v[44:45] op_sel_hi:[0,1,1] neg_lo:[1,0,0] neg_hi:[1,0,0]
  v_cvt_pk_bf16_f32 v64, v42, v43
  v_cvt_pk_bf16_f32 v65, v44, v45
  v_pk_fma_f32 v[58:59], v[150:151], v[130:131], v[58:59] op_sel_hi:[0,1,1] neg_lo:[1,0,0] neg_hi:[1,0,0]
  v_pk_fma_f32 v[60:61], v[150:151], v[132:133], v[60:61] op_sel_hi:[0,1,1] neg_lo:[1,0,0] neg_hi:[1,0,0]
  v_pk_mul_f32 v[58:59], v[150:151], v[58:59] op_sel:[1,0]
  v_pk_mul_f32 v[60:61], v[150:151], v[60:61] op_sel:[1,0]
  v_cvt_pk_bf16_f32 v58, v58, v59
  v_cvt_pk_bf16_f32 v59, v60, v61
  s_waitcnt lgkmcnt(0)
  v_pk_fma_f32 v[78:79], v[172:173], v[134:135], v[78:79] op_sel_hi:[1,0,1] neg_lo:[1,0,0] neg_hi:[1,0,0]
  v_pk_fma_f32 v[80:81], v[174:175], v[134:135], v[80:81] op_sel_hi:[1,0,1] neg_lo:[1,0,0] neg_hi:[1,0,0]
  v_pk_mul_f32 v[78:79], v[78:79], v[26:27]
  v_pk_mul_f32 v[80:81], v[80:81], v[28:29]
  v_cvt_pk_bf16_f32 v156, v78, v79
  v_cvt_pk_bf16_f32 v157, v80, v81
  v_pk_fma_f32 v[38:39], v[150:151], v[126:127], v[38:39] op_sel_hi:[0,1,1] neg_lo:[1,0,0] neg_hi:[1,0,0]
  v_pk_fma_f32 v[40:41], v[150:151], v[128:129], v[40:41] op_sel_hi:[0,1,1] neg_lo:[1,0,0] neg_hi:[1,0,0]
  v_cvt_pk_bf16_f32 v60, v38, v39
  v_cvt_pk_bf16_f32 v61, v40, v41
  v_mfma_f32_16x16x16_bf16 v[50:53], v[70:71], v[72:73], 0
  v_bfe_i32 v172, v1, 0, 1
  v_and_b32_e64 v175, 14, v1
  v_mfma_f32_16x16x16_bf16 v[90:93], v[66:67], v[72:73], 0
  v_lshrrev_b32 v3, 2, v31
  v_sub_u32 v175, v175, v3
  v_mfma_f32_16x16x16_bf16 v[46:49], v[66:67], v[68:69], 0
  v_not_b32_e64 v173, v175
  v_mfma_f32_16x16x16_bf16 v[86:89], v[62:63], v[68:69], 0
  v_ashrrev_i32 v173, 31, v173
  v_sub_u32 v174, 1, v175
  v_mfma_f32_16x16x16_bf16 v[42:45], v[62:63], v[64:65], 0
  v_ashrrev_i32_e64 v174, 31, v174
  v_xor_b32 v175, 0xffff, v172
  v_mfma_f32_16x16x16_bf16 v[82:85], v[58:59], v[64:65], 0
  v_and_b32_e64 v28, v175, v173
  v_mfma_f32_16x16x16_bf16 v[38:41], v[58:59], v[60:61], 0
  v_and_b32 v29, v175, v174
  v_xor_b32 v26, v175, v28
  v_mfma_f32_16x16x16_bf16 v[78:81], v[54:55], v[60:61], 0
  v_xor_b32_e64 v27, v175, v29
  v_bitop3_b32 v50, v172, v51, v50 bitop3:0xca
  v_bitop3_b32 v51, v172, v53, v52 bitop3:0xca
  v_bitop3_b32 v90, v172, v91, v90 bitop3:0xca
  v_bitop3_b32 v91, v172, v93, v92 bitop3:0xca
  v_bitop3_b32 v50, v173, v50, v90 bitop3:0xca
  v_bitop3_b32 v51, v174, v51, v91 bitop3:0xca
  v_max_f32_e64 v52, v50, v51
  v_bitop3_b32 v46, v172, v47, v46 bitop3:0xca
  v_bitop3_b32 v47, v172, v49, v48 bitop3:0xca
  v_bitop3_b32 v86, v172, v87, v86 bitop3:0xca
  v_bitop3_b32 v87, v172, v89, v88 bitop3:0xca
  v_bitop3_b32 v46, v173, v46, v86 bitop3:0xca
  v_bitop3_b32 v47, v174, v47, v87 bitop3:0xca
  v_max_f32_e64 v48, v46, v47
  v_bitop3_b32 v42, v172, v43, v42 bitop3:0xca
  v_bitop3_b32 v43, v172, v45, v44 bitop3:0xca
  v_bitop3_b32 v82, v172, v83, v82 bitop3:0xca
  v_bitop3_b32 v83, v172, v85, v84 bitop3:0xca
  v_bitop3_b32 v42, v173, v42, v82 bitop3:0xca
  v_bitop3_b32 v43, v174, v43, v83 bitop3:0xca
  v_max_f32_e64 v44, v42, v43
  v_bitop3_b32 v38, v172, v39, v38 bitop3:0xca
  v_bitop3_b32 v39, v172, v41, v40 bitop3:0xca
  v_bitop3_b32 v78, v172, v79, v78 bitop3:0xca
  v_bitop3_b32 v79, v172, v81, v80 bitop3:0xca
  v_bitop3_b32 v38, v173, v38, v78 bitop3:0xca
  v_bitop3_b32 v39, v174, v39, v79 bitop3:0xca
  v_max_f32 v40, v38, v39
  v_permlane16_swap_b32 v48, v52
  v_mul_f32 v41, 0xbe800000, v152
  v_permlane16_swap_b32 v40, v44
  v_max_f32 v48, v48, v52
  v_max_f32_e64 v40, v40, v44
  v_mul_f32 v45, 0xbe800000, v20
  v_mul_f32 v49, 0xbe800000, v24
  v_permlane32_swap_b32 v40, v48
  v_max_f32 v40, v40, v48
  v_mov_b32_e64 v48, v40
  v_mul_f32 v53, 0xbe800000, v182
  s_nop 0
  v_permlane32_swap_b32 v40, v48
  v_mov_b32 v44, v40
  v_mov_b32 v52, v48
  s_nop 0
  v_permlane16_swap_b32 v40, v44
  v_permlane16_swap_b32_e64 v48, v52
  v_pk_add_f32 v[38:39], v[38:39], v[40:41] op_sel_hi:[1,0] neg_lo:[0,1] neg_hi:[0,1]
  v_pk_mul_f32 v[38:39], v[40:41], v[38:39] op_sel:[1,0]
  v_exp_f32 v38, v38
  v_exp_f32 v39, v39
  v_pk_add_f32 v[42:43], v[42:43], v[44:45] op_sel_hi:[1,0] neg_lo:[0,1] neg_hi:[0,1]
  v_pk_mul_f32 v[42:43], v[44:45], v[42:43] op_sel:[1,0]
  v_exp_f32 v42, v42
  v_exp_f32 v43, v43
  v_pk_add_f32 v[46:47], v[46:47], v[48:49] op_sel_hi:[1,0] neg_lo:[0,1] neg_hi:[0,1]
  v_pk_mul_f32 v[46:47], v[48:49], v[46:47] op_sel:[1,0]
  v_exp_f32 v46, v46
  v_exp_f32 v47, v47
  v_pk_add_f32 v[50:51], v[50:51], v[52:53] op_sel_hi:[1,0] neg_lo:[0,1] neg_hi:[0,1]
  v_pk_mul_f32 v[50:51], v[52:53], v[50:51] op_sel:[1,0]
  v_exp_f32 v50, v50
  v_exp_f32 v51, v51
  v_cvt_pk_bf16_f32 v38, v38, v38
  v_cvt_pk_bf16_f32 v39, v39, v39
  v_and_b32 v58, v38, v26
  v_and_b32 v59, v39, v27
  v_and_b32 v60, v38, v28
  v_and_b32 v61, v39, v29
  v_cvt_pk_bf16_f32 v42, v42, v42
  v_cvt_pk_bf16_f32 v43, v43, v43
  v_mfma_f32_16x16x32_bf16 v[78:81], v[34:37], v[58:61], 0
  v_and_b32 v62, v42, v26
  v_and_b32 v63, v43, v27
  v_mfma_f32_16x16x32_bf16 v[38:41], v[154:157], v[58:61], 0
  v_and_b32 v64, v42, v28
  v_and_b32 v65, v43, v29
  v_cvt_pk_bf16_f32 v46, v46, v46
  v_cvt_pk_bf16_f32 v47, v47, v47
  v_mfma_f32_16x16x32_bf16 v[82:85], v[34:37], v[62:65], 0
  v_and_b32 v66, v46, v26
  v_and_b32 v67, v47, v27
  v_mfma_f32_16x16x32_bf16 v[42:45], v[156:159], v[62:65], 0
  v_and_b32 v68, v46, v28
  v_and_b32 v69, v47, v29
  v_cvt_pk_bf16_f32 v50, v50, v50
  v_cvt_pk_bf16_f32 v51, v51, v51
  v_mfma_f32_16x16x32_bf16 v[86:89], v[34:37], v[66:69], 0
  v_and_b32 v70, v50, v26
  v_and_b32 v71, v51, v27
  v_mfma_f32_16x16x32_bf16 v[46:49], v[158:161], v[66:69], 0
  v_and_b32 v72, v50, v28
  v_and_b32_e64 v73, v51, v29
  s_nop 1
  v_mfma_f32_16x16x32_bf16 v[90:93], v[34:37], v[70:73], 0
  v_mfma_f32_16x16x32_bf16 v[50:53], v[160:163], v[70:73], 0
  v_pk_fma_f32 v[94:95], v[150:151], v[138:139], v[94:95] op_sel_hi:[0,1,1] neg_lo:[1,0,0] neg_hi:[1,0,0]
  v_pk_fma_f32 v[96:97], v[150:151], v[140:141], v[96:97] op_sel_hi:[0,1,1] neg_lo:[1,0,0] neg_hi:[1,0,0]
  v_pk_fma_f32 v[110:111], v[150:151], v[142:143], v[110:111] op_sel_hi:[0,1,1] neg_lo:[1,0,0] neg_hi:[1,0,0]
  v_pk_fma_f32 v[112:113], v[150:151], v[144:145], v[112:113] op_sel_hi:[0,1,1] neg_lo:[1,0,0] neg_hi:[1,0,0]
  v_pk_mul_f32 v[146:147], v[94:95], v[152:153] op_sel_hi:[1,0]
  v_pk_mul_f32 v[148:149], v[96:97], v[152:153] op_sel_hi:[1,0]
  v_exp_f32 v146, v146
  v_exp_f32 v147, v147
  v_exp_f32 v148, v148
  v_exp_f32 v149, v149
  v_pk_mul_f32 v[94:95], v[94:95], v[110:111]
  v_pk_mul_f32 v[96:97], v[96:97], v[112:113]
  v_pk_fma_f32 v[146:147], v[152:153], v[146:147], v[152:153] op_sel:[1,0,1]
  v_pk_fma_f32 v[148:149], v[152:153], v[148:149], v[152:153] op_sel:[1,0,1]
  v_rcp_f32 v146, v146
  v_rcp_f32 v147, v147
  v_rcp_f32 v148, v148
  v_rcp_f32 v149, v149
  v_pk_mul_f32 v[94:95], v[94:95], v[146:147]
  v_pk_mul_f32 v[96:97], v[96:97], v[148:149]
  v_cvt_pk_bf16_f32 v110, v94, v95
  v_cvt_pk_bf16_f32 v111, v96, v97
  v_pk_fma_f32 v[98:99], v[18:19], v[138:139], v[98:99] op_sel_hi:[0,1,1] neg_lo:[1,0,0] neg_hi:[1,0,0]
  v_pk_fma_f32 v[100:101], v[18:19], v[140:141], v[100:101] op_sel_hi:[0,1,1] neg_lo:[1,0,0] neg_hi:[1,0,0]
  v_pk_fma_f32 v[114:115], v[18:19], v[142:143], v[114:115] op_sel_hi:[0,1,1] neg_lo:[1,0,0] neg_hi:[1,0,0]
  v_pk_fma_f32 v[116:117], v[18:19], v[144:145], v[116:117] op_sel_hi:[0,1,1] neg_lo:[1,0,0] neg_hi:[1,0,0]
  v_pk_mul_f32 v[146:147], v[98:99], v[20:21] op_sel_hi:[1,0]
  v_pk_mul_f32 v[148:149], v[100:101], v[20:21] op_sel_hi:[1,0]
  v_exp_f32 v146, v146
  v_exp_f32 v147, v147
  v_exp_f32 v148, v148
  v_exp_f32 v149, v149
  v_pk_mul_f32 v[98:99], v[98:99], v[114:115]
  v_pk_mul_f32 v[100:101], v[100:101], v[116:117]
  v_pk_fma_f32 v[146:147], v[20:21], v[146:147], v[20:21] op_sel:[1,0,1]
  v_pk_fma_f32 v[148:149], v[20:21], v[148:149], v[20:21] op_sel:[1,0,1]
  v_rcp_f32 v146, v146
  v_rcp_f32 v147, v147
  v_rcp_f32 v148, v148
  v_rcp_f32 v149, v149
  v_pk_mul_f32 v[98:99], v[98:99], v[146:147]
  v_pk_mul_f32 v[100:101], v[100:101], v[148:149]
  v_cvt_pk_bf16_f32 v112, v98, v99
  v_cvt_pk_bf16_f32 v113, v100, v101
  s_nop 0
  v_permlane16_swap_b32 v110, v112
  v_permlane16_swap_b32_e64 v111, v113
  buffer_store_dwordx4 v[110:113], v2, s[40:43], s55 offen sc1
  v_pk_fma_f32 v[102:103], v[22:23], v[138:139], v[102:103] op_sel_hi:[0,1,1] neg_lo:[1,0,0] neg_hi:[1,0,0]
  v_pk_fma_f32 v[104:105], v[22:23], v[140:141], v[104:105] op_sel_hi:[0,1,1] neg_lo:[1,0,0] neg_hi:[1,0,0]
  v_pk_fma_f32 v[118:119], v[22:23], v[142:143], v[118:119] op_sel_hi:[0,1,1] neg_lo:[1,0,0] neg_hi:[1,0,0]
  v_pk_fma_f32 v[120:121], v[22:23], v[144:145], v[120:121] op_sel_hi:[0,1,1] neg_lo:[1,0,0] neg_hi:[1,0,0]
  v_pk_mul_f32 v[146:147], v[102:103], v[24:25] op_sel_hi:[1,0]
  v_pk_mul_f32 v[148:149], v[104:105], v[24:25] op_sel_hi:[1,0]
  v_exp_f32 v146, v146
  v_exp_f32 v147, v147
  v_exp_f32 v148, v148
  v_exp_f32 v149, v149
  v_pk_mul_f32 v[102:103], v[102:103], v[118:119]
  v_pk_mul_f32 v[104:105], v[104:105], v[120:121]
  v_pk_fma_f32 v[146:147], v[24:25], v[146:147], v[24:25] op_sel:[1,0,1]
  v_pk_fma_f32 v[148:149], v[24:25], v[148:149], v[24:25] op_sel:[1,0,1]
  v_rcp_f32 v146, v146
  v_rcp_f32 v147, v147
  v_rcp_f32 v148, v148
  v_rcp_f32 v149, v149
  v_pk_mul_f32 v[102:103], v[102:103], v[146:147]
  v_pk_mul_f32 v[104:105], v[104:105], v[148:149]
  v_cvt_pk_bf16_f32 v118, v102, v103
  v_cvt_pk_bf16_f32 v119, v104, v105
  v_pk_fma_f32 v[106:107], v[180:181], v[138:139], v[106:107] op_sel_hi:[0,1,1] neg_lo:[1,0,0] neg_hi:[1,0,0]
  v_pk_fma_f32 v[108:109], v[180:181], v[140:141], v[108:109] op_sel_hi:[0,1,1] neg_lo:[1,0,0] neg_hi:[1,0,0]
  v_pk_fma_f32 v[122:123], v[180:181], v[142:143], v[122:123] op_sel_hi:[0,1,1] neg_lo:[1,0,0] neg_hi:[1,0,0]
  v_pk_fma_f32 v[124:125], v[180:181], v[144:145], v[124:125] op_sel_hi:[0,1,1] neg_lo:[1,0,0] neg_hi:[1,0,0]
  v_pk_mul_f32 v[146:147], v[106:107], v[182:183] op_sel_hi:[1,0]
  v_pk_mul_f32 v[148:149], v[108:109], v[182:183] op_sel_hi:[1,0]
  v_exp_f32 v146, v146
  v_exp_f32 v147, v147
  v_exp_f32 v148, v148
  v_exp_f32 v149, v149
  v_pk_mul_f32 v[106:107], v[106:107], v[122:123]
  v_pk_mul_f32 v[108:109], v[108:109], v[124:125]
  v_pk_fma_f32 v[146:147], v[182:183], v[146:147], v[182:183] op_sel:[1,0,1]
  v_pk_fma_f32 v[148:149], v[182:183], v[148:149], v[182:183] op_sel:[1,0,1]
  v_rcp_f32 v146, v146
  v_rcp_f32 v147, v147
  v_rcp_f32 v148, v148
  v_rcp_f32 v149, v149
  v_pk_mul_f32 v[106:107], v[106:107], v[146:147]
  v_pk_mul_f32 v[108:109], v[108:109], v[148:149]
  v_cvt_pk_bf16_f32 v120, v106, v107
  v_cvt_pk_bf16_f32 v121, v108, v109
  s_nop 0
  v_permlane16_swap_b32 v118, v120
  v_permlane16_swap_b32_e64 v119, v121
  buffer_store_dwordx4 v[118:121], v2, s[40:43], s56 offen sc1
  v_rcp_f32 v78, v78
  v_rcp_f32 v82, v82
  v_rcp_f32 v86, v86
  v_rcp_f32 v90, v90
  v_pk_mul_f32 v[38:39], v[38:39], v[78:79] op_sel_hi:[1,0]
  v_pk_mul_f32 v[40:41], v[40:41], v[78:79] op_sel_hi:[1,0]
  v_cvt_pk_bf16_f32 v164, v38, v39
  v_cvt_pk_bf16_f32 v165, v40, v41
  v_pk_mul_f32 v[42:43], v[42:43], v[82:83] op_sel_hi:[1,0]
  v_pk_mul_f32 v[44:45], v[44:45], v[82:83] op_sel_hi:[1,0]
  v_cvt_pk_bf16_f32 v166, v42, v43
  v_cvt_pk_bf16_f32 v167, v44, v45
  s_nop 0
  v_permlane16_swap_b32 v164, v166
  v_permlane16_swap_b32_e64 v165, v167
  buffer_store_dwordx4 v[164:167], v2, s[40:43], s57 offen sc1
  v_pk_mul_f32 v[46:47], v[46:47], v[86:87] op_sel_hi:[1,0]
  v_pk_mul_f32 v[48:49], v[48:49], v[86:87] op_sel_hi:[1,0]
  v_cvt_pk_bf16_f32 v168, v46, v47
  v_cvt_pk_bf16_f32 v169, v48, v49
  v_pk_mul_f32 v[50:51], v[50:51], v[90:91] op_sel_hi:[1,0]
  v_pk_mul_f32 v[52:53], v[52:53], v[90:91] op_sel_hi:[1,0]
  v_cvt_pk_bf16_f32 v170, v50, v51
  v_cvt_pk_bf16_f32 v171, v52, v53
  s_nop 0
  v_permlane16_swap_b32 v168, v170
  v_permlane16_swap_b32_e64 v169, v171
  buffer_store_dwordx4 v[168:171], v2, s[40:43], s58 offen sc1
  s_waitcnt vmcnt(4)
  ds_read_b64_tr_b16 v[104:105], v12 offset:43008
  ds_read_b64_tr_b16 v[108:109], v13 offset:43008
  ds_read_b64_tr_b16 v[112:113], v14 offset:43008
  ds_read_b64_tr_b16 v[116:117], v15 offset:43008
  ds_read_b64_tr_b16 v[106:107], v212 offset:0
  ds_read_b64_tr_b16 v[110:111], v213 offset:0
  ds_read_b64_tr_b16 v[114:115], v214 offset:0
  ds_read_b64_tr_b16 v[118:119], v215 offset:0
  ds_read_b64_tr_b16 v[120:121], v212 offset:16384
  ds_read_b64_tr_b16 v[124:125], v213 offset:16384
  ds_read_b64_tr_b16 v[128:129], v214 offset:16384
  ds_read_b64_tr_b16 v[132:133], v215 offset:16384
  ds_read_b64_tr_b16 v[122:123], v12 offset:6144
  ds_read_b64_tr_b16 v[126:127], v13 offset:6144
  ds_read_b64_tr_b16 v[130:131], v14 offset:6144
  ds_read_b64_tr_b16 v[134:135], v15 offset:6144
  ds_read_b64_tr_b16 v[136:137], v212 offset:32768
  ds_read_b64_tr_b16 v[140:141], v213 offset:32768
  ds_read_b64_tr_b16 v[144:145], v214 offset:32768
  ds_read_b64_tr_b16 v[148:149], v215 offset:32768
  ds_read_b64_tr_b16 v[138:139], v212 offset:49152
  ds_read_b64_tr_b16 v[142:143], v213 offset:49152
  ds_read_b64_tr_b16 v[146:147], v214 offset:49152
  ds_read_b64_tr_b16 v[150:151], v215 offset:49152
  ds_read_b64_tr_b16 v[152:153], v12 offset:22528
  ds_read_b64_tr_b16 v[156:157], v13 offset:22528
  ds_read_b64_tr_b16 v[160:161], v14 offset:22528
  ds_read_b64_tr_b16 v[164:165], v15 offset:22528
  ds_read_b64_tr_b16 v[154:155], v12 offset:59392
  ds_read_b64_tr_b16 v[158:159], v13 offset:59392
  ds_read_b64_tr_b16 v[162:163], v14 offset:59392
  ds_read_b64_tr_b16 v[166:167], v15 offset:59392
  buffer_load_dwordx2 v[20:21], v8, s[20:23], 0 offen
  buffer_load_dwordx2 v[22:23], v11, s[20:23], 0 offen
  s_buffer_load_dwordx4 s[28:31], s[40:43], s65 offset:0 glc
  s_waitcnt vmcnt(2)
  s_mov_b64 exec, 1
  ds_add_rtn_u32 v3, v1, v6 offset:5892
  s_waitcnt lgkmcnt(0)
  v_readfirstlane_b32 s66, v3
  s_mov_b64 exec, -1
  s_xor_b32 s66, s66, 3
  s_lshl_b32 s66, s66, 24
  v_add_u32_e64 v3, s66, v33
  buffer_store_dword v6, v3, s[40:43], 0 offen sc1
  s_setprio 1
  s_branch L_P1
.p2align 12
L_B0:
  s_setprio 1
  s_mov_b32 s48, 0
  s_mov_b32 s49, 0
  v_lshlrev_b32 v2, 4, v1
  s_cmp_eq_u32 s45, 0
  s_cselect_b64 s[6:7], s[6:7], s[12:13]
  s_cmp_eq_u32 s45, 2
  s_cselect_b64 s[6:7], s[14:15], s[6:7]
  s_or_b32 s67, s2, 0
  s_cmp_eq_u32 s45, 0
  s_cselect_b32 s66, 6, 7
  s_mul_i32 s67, s67, 2
  s_add_u32 s67, s67, 256
  s_mul_i32 s67, s67, s66
  s_mul_i32 s66, s66, 2
  s_sub_u32 s66, s66, 1
  s_cmp_eq_u32 s45, 3
  s_cselect_b32 s66, 0, s66
  v_min_u32 v208, s66, v1
  v_add_lshl_u32 v208, v208, s67, 7
  v_and_b32 v11, 15, v1
  v_lshrrev_b32 v4, 4, v1
  v_bfe_u32 v190, v1, 1, 3
  v_xor_b32 v190, v190, v4
  v_lshlrev_b32 v190, 4, v190
  v_lshl_add_u32 v23, v11, 7, v190
  v_xor_b32_e64 v24, 64, v23
  v_bfe_u32 v190, v1, 3, 2
  v_xor_b32 v190, s45, v190
  v_lshlrev_b32 v190, 5, v190
  v_lshl_add_u32 v190, v4, 10, v190
  v_bfe_u32 v191, v1, 2, 2
  v_lshl_add_u32 v190, v191, 7, v190
  v_and_b32_e64 v3, 3, v1
  s_add_u32 m0, s52, 77824
  s_mov_b32 s48, 0
  buffer_load_dwordx4 v21, s[28:31], s48 offen lds
  v_lshl_add_u32 v190, v3, 3, v190
  v_add_u32 v25, 61440, v190
  v_add_u32 v26, 122880, v190
  v_bfe_u32 v190, v1, 4, 1
  v_and_b32 v3, 2, v1
  v_or_b32 v5, v190, v3
  v_xor_b32 v5, s45, v5
  v_lshlrev_b32_e64 v5, 4, v5
  v_lshl_add_u32 v5, v3, 9, v5
  v_lshl_add_u32 v5, v190, 9, v5
  v_lshl_add_u32 v5, v191, 6, v5
  v_lshrrev_b32_e64 v190, 5, v1
  v_lshl_add_u32 v5, v190, 11, v5
  v_and_b32_e64 v190, 1, v1
  v_lshl_add_u32 v5, v190, 3, v5
  v_add_u32 v27, 61440, v5
  v_add_u32 v28, 122880, v5
  v_mov_b32 v34, 0x3f803f80
  v_mov_b32 v35, 0x3f803f80
  v_mov_b32 v36, 0x3f803f80
  v_mov_b32 v37, 0x3f803f80
  v_mov_b32 v118, 0
  v_mov_b32 v119, 0
  v_mov_b32 v120, 0
  v_mov_b32 v121, 0
  v_mov_b32 v122, 0
  v_mov_b32 v123, 0
  s_add_u32 m0, s52, 81920
  s_mov_b32 s48, 114688
  buffer_load_dwordx4 v21, s[28:31], s48 offen lds
  v_mov_b32 v124, 0
  v_mov_b32 v125, 0
  v_mov_b32 v126, 0
  v_mov_b32 v127, 0
  v_mov_b32 v128, 0
  v_mov_b32 v129, 0
  v_mov_b32 v130, 0
  v_mov_b32 v131, 0
  v_mov_b32 v132, 0
  v_mov_b32 v133, 0
  v_mov_b32 v134, 0
  v_mov_b32 v135, 0
  v_mov_b32 v136, 0
  v_mov_b32 v137, 0
  v_bfe_i32 v32, v1, 0, 1
  v_and_b32 v32, 0xaaaaaaaa, v32
  v_or_b32 v32, 0x44444444, v32
  s_add_u32 s40, s38, 0
  s_addc_u32 s41, s39, 0
  s_mov_b64 s[12:13], s[18:19]
  s_mov_b32 s42, 0x970000
  s_mov_b32 s43, 0x20000
  s_mov_b32 s38, 0x100
  s_mov_b32 s39, 0x20000
  s_mov_b32 s10, 0x80000
  s_mov_b32 s11, 0x20000
  s_mov_b32 s18, 0x1c0000
  s_mov_b32 s19, 0x20000
  global_load_dword v177, v208, s[6:7]
  s_mov_b32 s14, 0x200000
  s_mov_b32 s15, 0x20000
  s_and_b32 s66, s2, 7
  s_bfe_u32 s67, s2, 0x20003
  s_lshl2_add_u32 s66, s66, s67
  s_lshr_b32 s60, s2, 5
  s_and_b32 s67, s66, 30
  s_add_u32 s61, s66, s67
  s_lshl3_add_u32 s66, s66, s60
  s_lshl_b32 s66, s66, 9
  s_add_u32 s64, s66, 9437184
  s_lshl_b32 s66, s45, 28
  v_lshl_add_u32 v3, v1, 2, s66
  v_mov_b32 v188, 0
  v_mov_b32_e64 v189, 0
  buffer_store_dword v188, v3, s[40:43], s64 offen sc1
  ds_write_b32 v188, v188 offset:5888
  v_mov_b32 v6, 1
  s_mov_b64 exec, 0
  s_branch L_P0wB
L_B0r:
  s_mov_b64 exec, -1
  s_waitcnt vmcnt(4)
  v_lshlrev_b32 v200, 16, v184
  v_and_b32 v201, 0xffff0000, v184
  v_lshlrev_b32_e64 v202, 16, v185
  v_and_b32 v203, 0xffff0000, v185
  v_lshlrev_b32_e64 v204, 16, v186
  v_and_b32 v205, 0xffff0000, v186
  v_lshlrev_b32_e64 v206, 16, v187
  v_and_b32 v207, 0xffff0000, v187
  s_add_u32 m0, s53, 26496
  s_nop 0
  buffer_load_dwordx4 v18, s[20:23], s50 offen offset:128 lds
  v_pk_add_f32 v[184:185], v[200:201], v[202:203]
  v_pk_add_f32 v[186:187], v[204:205], v[206:207]
  v_pk_add_f32 v[184:185], v[184:185], v[186:187]
  v_add_f32 v188, v184, v185
  s_add_u32 s63, s63, s53
  s_lshr_b32 s63, s63, 6
  v_add_f32_dpp v188, v188, v188 row_ror:8 row_mask:0xf bank_mask:0xf
  s_nop 1
  v_add_f32_dpp v188, v188, v188 row_ror:4 row_mask:0xf bank_mask:0xf
  s_nop 1
  v_add_f32_dpp v188, v188, v188 row_ror:2 row_mask:0xf bank_mask:0xf
  s_nop 1
  v_add_f32_dpp v188, v188, v188 row_ror:1 row_mask:0xf bank_mask:0xf
  v_mov_b32 v191, v188
  s_nop 1
  v_permlane16_swap_b32 v188, v191
  v_add_f32 v188, v188, v191
  v_mov_b32 v191, v188
  s_nop 1
  v_permlane32_swap_b32 v188, v191
  v_add_f32_e64 v188, v188, v191
  v_mul_f32 v188, 0x3b000000, v188
  v_pk_add_f32 v[200:201], v[200:201], v[188:189] op_sel_hi:[1,0] neg_lo:[0,1] neg_hi:[0,1]
  v_pk_add_f32 v[202:203], v[202:203], v[188:189] op_sel_hi:[1,0] neg_lo:[0,1] neg_hi:[0,1]
  v_pk_add_f32 v[204:205], v[204:205], v[188:189] op_sel_hi:[1,0] neg_lo:[0,1] neg_hi:[0,1]
  v_pk_add_f32 v[206:207], v[206:207], v[188:189] op_sel_hi:[1,0] neg_lo:[0,1] neg_hi:[0,1]
  v_pk_mul_f32 v[184:185], v[200:201], v[200:201]
  v_pk_fma_f32 v[184:185], v[202:203], v[202:203], v[184:185]
  v_pk_fma_f32 v[184:185], v[204:205], v[204:205], v[184:185]
  v_pk_fma_f32 v[184:185], v[206:207], v[206:207], v[184:185]
  v_add_f32_e64 v189, v184, v185
  s_add_u32 s63, s63, 9568256
  s_add_u32 m0, s53, 34688
  s_nop 0
  buffer_load_dwordx4 v18, s[20:23], s51 offen offset:128 lds
  v_lshlrev_b32 v190, 24, v1
  v_add_f32_dpp v189, v189, v189 row_ror:8 row_mask:0xf bank_mask:0xf
  s_nop 1
  v_add_f32_dpp v189, v189, v189 row_ror:4 row_mask:0xf bank_mask:0xf
  s_nop 1
  v_add_f32_dpp v189, v189, v189 row_ror:2 row_mask:0xf bank_mask:0xf
  s_nop 1
  v_add_f32_dpp v189, v189, v189 row_ror:1 row_mask:0xf bank_mask:0xf
  v_mov_b32 v191, v189
  s_nop 1
  v_permlane16_swap_b32 v189, v191
  v_add_f32 v189, v189, v191
  v_mov_b32 v191, v189
  s_nop 1
  v_permlane32_swap_b32 v189, v191
  v_add_f32_e64 v189, v189, v191
  v_mul_f32 v189, 0x3b000000, v189
  v_cvt_pk_bf16_f32 v184, v188, v188
  v_and_b32 v184, 0xffff0000, v184
  v_cvt_pk_bf16_f32 v189, v189, v189
  v_and_b32 v189, 0xffff0000, v189
  v_add_f32 v189, 0x3727c5ac, v189
  v_cvt_pk_bf16_f32 v189, v189, v189
  v_and_b32 v189, 0xffff0000, v189
  v_sqrt_f32 v189, v189
  s_nop 0
  v_cvt_pk_bf16_f32 v189, v189, v189
  v_and_b32 v189, 0xffff0000, v189
  v_rcp_f32 v185, v189
  v_mul_f32 v187, v189, v189
  v_mul_f32 v186, 0xbfb8aa3b, v185
  buffer_store_dwordx4 v[184:187], v190, s[40:43], s63 offen sc1
  s_waitcnt lgkmcnt(0)
  s_barrier
  ds_read_b64_tr_b16 v[232:233], v25 offset:0
  ds_read_b64_tr_b16 v[234:235], v25 offset:512
  ds_read_b64_tr_b16 v[236:237], v25 offset:4096
  ds_read_b64_tr_b16 v[238:239], v25 offset:4608
  ds_read_b128 v[170:173], v23 offset:14336
  ds_read_b128 v[228:231], v24 offset:14336
  ds_read_b128 v[166:169], v23 offset:12288
  ds_read_b128 v[224:227], v24 offset:12288
  ds_read_b128 v[162:165], v23 offset:10240
  ds_read_b128 v[220:223], v24 offset:10240
  ds_read_b128 v[158:161], v23 offset:8192
  ds_read_b128 v[216:219], v24 offset:8192
  ds_read_b64_tr_b16 v[240:241], v25 offset:8192
  ds_read_b64_tr_b16 v[242:243], v25 offset:8704
  ds_read_b64_tr_b16 v[244:245], v25 offset:12288
  ds_read_b64_tr_b16 v[246:247], v25 offset:12800
  s_waitcnt lgkmcnt(11)
  v_mfma_f32_16x16x32_bf16 v[50:53], v[232:235], v[170:173], 0
  s_waitcnt lgkmcnt(10)
  v_mfma_f32_16x16x32_bf16 v[50:53], v[236:239], v[228:231], v[50:53]
  s_waitcnt lgkmcnt(8)
  v_mfma_f32_16x16x32_bf16 v[46:49], v[236:239], v[224:227], 0
  v_mfma_f32_16x16x32_bf16 v[46:49], v[232:235], v[166:169], v[46:49]
  s_waitcnt lgkmcnt(7)
  v_mfma_f32_16x16x32_bf16 v[42:45], v[232:235], v[162:165], 0
  s_waitcnt lgkmcnt(6)
  v_mfma_f32_16x16x32_bf16 v[42:45], v[236:239], v[220:223], v[42:45]
  s_waitcnt lgkmcnt(4)
  v_mfma_f32_16x16x32_bf16 v[38:41], v[236:239], v[216:219], 0
  s_add_u32 m0, s52, 102400
  s_mov_b32 s48, 229376
  buffer_load_dwordx4 v20, s[24:27], s48 offen lds
  v_mfma_f32_16x16x32_bf16 v[38:41], v[232:235], v[158:161], v[38:41]
  v_smfmac_f32_16x16x64_bf16 v[118:121], v[34:37], v[232:239], v32
  s_waitcnt lgkmcnt(2)
  v_mfma_f32_16x16x32_bf16 v[70:73], v[240:243], v[158:161], 0
  s_waitcnt lgkmcnt(0)
  v_mfma_f32_16x16x32_bf16 v[70:73], v[244:247], v[216:219], v[70:73]
  s_add_u32 m0, s52, 106496
  s_mov_b32 s48, 344064
  buffer_load_dwordx4 v20, s[24:27], s48 offen lds
  v_mfma_f32_16x16x32_bf16 v[74:77], v[244:247], v[220:223], 0
  v_mfma_f32_16x16x32_bf16 v[74:77], v[240:243], v[162:165], v[74:77]
  v_mfma_f32_16x16x32_bf16 v[78:81], v[240:243], v[166:169], 0
  v_mfma_f32_16x16x32_bf16 v[78:81], v[244:247], v[224:227], v[78:81]
  s_add_u32 m0, s52, 118784
  s_mov_b32 s48, 229376
  buffer_load_dwordx4 v21, s[28:31], s48 offen lds
  v_mfma_f32_16x16x32_bf16 v[82:85], v[244:247], v[228:231], 0
  v_mfma_f32_16x16x32_bf16 v[82:85], v[240:243], v[170:173], v[82:85]
  v_smfmac_f32_16x16x64_bf16 v[126:129], v[34:37], v[240:247], v32
  s_waitcnt vmcnt(8)
  s_barrier
  ds_read_b64_tr_b16 v[232:233], v25 offset:16384
  ds_read_b64_tr_b16 v[234:235], v25 offset:16896
  s_add_u32 m0, s52, 122880
  s_mov_b32 s48, 344064
  buffer_load_dwordx4 v21, s[28:31], s48 offen lds
  ds_read_b64_tr_b16 v[236:237], v25 offset:20480
  ds_read_b64_tr_b16 v[238:239], v25 offset:20992
  ds_read_b64_tr_b16 v[240:241], v25 offset:24576
  ds_read_b64_tr_b16 v[242:243], v25 offset:25088
  ds_read_b64_tr_b16 v[244:245], v25 offset:28672
  s_add_u32 m0, s53, 44800
  ds_read_b64_tr_b16 v[246:247], v25 offset:29184
  buffer_load_dwordx4 v18, s[20:23], s50 offen offset:256 lds
  ds_read_b64_tr_b16 v[248:249], v27 offset:32768
  ds_read_b64_tr_b16 v[250:251], v27 offset:33024
  ds_read_b64_tr_b16 v[252:253], v27 offset:36864
  ds_read_b64_tr_b16 v[254:255], v27 offset:37120
  s_waitcnt lgkmcnt(10)
  v_mfma_f32_16x16x32_bf16 v[66:69], v[232:235], v[170:173], 0
  s_waitcnt lgkmcnt(8)
  v_mfma_f32_16x16x32_bf16 v[66:69], v[236:239], v[228:231], v[66:69]
  v_mfma_f32_16x16x32_bf16 v[62:65], v[236:239], v[224:227], 0
  v_mfma_f32_16x16x32_bf16 v[62:65], v[232:235], v[166:169], v[62:65]
  v_mfma_f32_16x16x32_bf16 v[58:61], v[232:235], v[162:165], 0
  v_mfma_f32_16x16x32_bf16 v[58:61], v[236:239], v[220:223], v[58:61]
  v_mfma_f32_16x16x32_bf16 v[54:57], v[236:239], v[216:219], 0
  v_mfma_f32_16x16x32_bf16 v[54:57], v[232:235], v[158:161], v[54:57]
  v_smfmac_f32_16x16x64_bf16 v[122:125], v[34:37], v[232:239], v32
  s_waitcnt lgkmcnt(6)
  v_mfma_f32_16x16x32_bf16 v[86:89], v[240:243], v[158:161], 0
  s_waitcnt lgkmcnt(4)
  v_mfma_f32_16x16x32_bf16 v[86:89], v[244:247], v[216:219], v[86:89]
  v_mfma_f32_16x16x32_bf16 v[90:93], v[244:247], v[220:223], 0
  v_mfma_f32_16x16x32_bf16 v[90:93], v[240:243], v[162:165], v[90:93]
  v_mfma_f32_16x16x32_bf16 v[94:97], v[240:243], v[166:169], 0
  v_mfma_f32_16x16x32_bf16 v[94:97], v[244:247], v[224:227], v[94:97]
  v_mfma_f32_16x16x32_bf16 v[98:101], v[244:247], v[228:231], 0
  v_mfma_f32_16x16x32_bf16 v[98:101], v[240:243], v[170:173], v[98:101]
  v_smfmac_f32_16x16x64_bf16 v[130:133], v[34:37], v[240:247], v32
  s_waitcnt lgkmcnt(2)
  v_mfma_f32_16x16x32_bf16 v[114:117], v[248:251], v[170:173], 0
  s_waitcnt lgkmcnt(0)
  v_mfma_f32_16x16x32_bf16 v[114:117], v[252:255], v[228:231], v[114:117]
  v_mfma_f32_16x16x32_bf16 v[110:113], v[252:255], v[224:227], 0
  v_mfma_f32_16x16x32_bf16 v[110:113], v[248:251], v[166:169], v[110:113]
  v_mfma_f32_16x16x32_bf16 v[106:109], v[248:251], v[162:165], 0
  v_mfma_f32_16x16x32_bf16 v[106:109], v[252:255], v[220:223], v[106:109]
  v_mfma_f32_16x16x32_bf16 v[102:105], v[252:255], v[216:219], 0
  v_mfma_f32_16x16x32_bf16 v[102:105], v[248:251], v[158:161], v[102:105]
  v_smfmac_f32_16x16x64_bf16 v[134:137], v[34:37], v[248:255], v32
  s_waitcnt vmcnt(3)
  s_barrier
  ds_read_b64_tr_b16 v[232:233], v25 offset:40960
  ds_read_b64_tr_b16 v[234:235], v25 offset:41472
  s_add_u32 m0, s53, 52992
  ds_read_b64_tr_b16 v[236:237], v25 offset:45056
  buffer_load_dwordx4 v18, s[20:23], s51 offen offset:256 lds
  ds_read_b64_tr_b16 v[238:239], v25 offset:45568
  ds_read_b128 v[170:173], v23 offset:32768
  s_add_u32 m0, s52, 143360
  s_mov_b32 s48, 458752
  buffer_load_dwordx4 v20, s[24:27], s48 offen lds
  ds_read_b128 v[228:231], v24 offset:32768
  ds_read_b128 v[166:169], v23 offset:30720
  ds_read_b128 v[224:227], v24 offset:30720
  ds_read_b128 v[162:165], v23 offset:28672
  s_add_u32 m0, s52, 147456
  s_mov_b32 s48, 573440
  buffer_load_dwordx4 v20, s[24:27], s48 offen lds
  ds_read_b128 v[220:223], v24 offset:28672
  ds_read_b128 v[158:161], v23 offset:26624
  ds_read_b128 v[216:219], v24 offset:26624
  s_add_u32 m0, s52, 159744
  s_mov_b32 s48, 458752
  buffer_load_dwordx4 v21, s[28:31], s48 offen lds
  ds_read_b64_tr_b16 v[240:241], v25 offset:49152
  ds_read_b64_tr_b16 v[242:243], v25 offset:49664
  ds_read_b64_tr_b16 v[244:245], v25 offset:53248
  ds_read_b64_tr_b16 v[246:247], v25 offset:53760
  s_waitcnt lgkmcnt(11)
  v_mfma_f32_16x16x32_bf16 v[50:53], v[232:235], v[170:173], v[50:53]
  s_waitcnt lgkmcnt(10)
  v_mfma_f32_16x16x32_bf16 v[50:53], v[236:239], v[228:231], v[50:53]
  s_waitcnt lgkmcnt(8)
  v_mfma_f32_16x16x32_bf16 v[46:49], v[236:239], v[224:227], v[46:49]
  v_mfma_f32_16x16x32_bf16 v[46:49], v[232:235], v[166:169], v[46:49]
  s_waitcnt lgkmcnt(7)
  v_mfma_f32_16x16x32_bf16 v[42:45], v[232:235], v[162:165], v[42:45]
  s_waitcnt lgkmcnt(6)
  v_mfma_f32_16x16x32_bf16 v[42:45], v[236:239], v[220:223], v[42:45]
  s_waitcnt lgkmcnt(4)
  v_mfma_f32_16x16x32_bf16 v[38:41], v[236:239], v[216:219], v[38:41]
  v_mfma_f32_16x16x32_bf16 v[38:41], v[232:235], v[158:161], v[38:41]
  v_smfmac_f32_16x16x64_bf16 v[118:121], v[34:37], v[232:239], v32
  s_waitcnt lgkmcnt(2)
  v_mfma_f32_16x16x32_bf16 v[70:73], v[240:243], v[158:161], v[70:73]
  s_waitcnt lgkmcnt(0)
  v_mfma_f32_16x16x32_bf16 v[70:73], v[244:247], v[216:219], v[70:73]
  v_mfma_f32_16x16x32_bf16 v[74:77], v[244:247], v[220:223], v[74:77]
  v_mfma_f32_16x16x32_bf16 v[74:77], v[240:243], v[162:165], v[74:77]
  v_mfma_f32_16x16x32_bf16 v[78:81], v[240:243], v[166:169], v[78:81]
  v_mfma_f32_16x16x32_bf16 v[78:81], v[244:247], v[224:227], v[78:81]
  v_mfma_f32_16x16x32_bf16 v[82:85], v[244:247], v[228:231], v[82:85]
  v_mfma_f32_16x16x32_bf16 v[82:85], v[240:243], v[170:173], v[82:85]
  v_smfmac_f32_16x16x64_bf16 v[126:129], v[34:37], v[240:247], v32
  s_or_b32 s67, s2, 0
  s_cmp_eq_u32 s45, 0
  s_cselect_b32 s66, 6, 7
  s_mul_i32 s67, s67, 2
  s_add_u32 s67, s67, 1536
  s_mul_i32 s67, s67, s66
  s_mul_i32 s66, s66, 2
  s_sub_u32 s66, s66, 1
  s_cmp_eq_u32 s45, 3
  s_cselect_b32 s66, 0, s66
  v_min_u32 v210, s66, v1
  v_add_lshl_u32 v210, v210, s67, 7
  s_lshl_b32 s66, s46, 13
  s_lshl2_add_u32 s66, s47, s66
  s_add_u32 s66, s66, 9437184
  v_lshl_add_u32 v33, v11, 9, s66
  v_lshrrev_b32_e64 v3, 4, v1
  v_lshl_add_u32 v33, v3, 28, v33
  s_mul_i32 s66, s46, 589824
  s_mul_i32 s67, s47, 10240
  s_add_u32 s66, s66, s67
  s_add_u32 s66, s66, 0x8000
  s_bitcmp1_b32 s47, 0
  s_cselect_b32 s67, 2048, 0
  s_cselect_b32 s68, 0, 8192
  s_add_u32 s55, s66, s67
  s_add_u32 s55, s55, s52
  s_add_u32 s57, s55, 4096
  s_add_u32 s66, s66, s68
  s_lshl_b32 s67, s45, 9
  s_add_u32 s59, s66, s67
  s_add_u32 s56, s55, 147456
  s_add_u32 s58, s57, 147456
  s_mul_i32 s69, s45, 20
  s_add_u32 s68, s69, 32
  s_lshl3_add_u32 s65, s45, s64
  s_lshr_b32 s67, 255, s60
  s_and_b32 s67, s67, s61
  s_bitcmp1_b32 s67, 0
  s_cselect_b32 s66, 10, 0
  s_cselect_b32 s5, -10, 10
  s_add_u32 s69, s69, s66
  s_add_u32 s68, s68, s66
  s_lshl_b32 s5, s5, 2
  s_mul_i32 s66, s61, 144
  s_add_u32 s66, s66, s68
  s_lshl_b32 s66, s66, 10
  v_and_b32 v3, 0x300, v2
  v_add3_u32 v9, v3, v2, s66
  v_lshrrev_b32 v4, 3, v1
  v_and_b32_e64 v3, 6, v4
  v_bitop3_b32 v3, v3, v1, 7 bitop3:0x28
  v_lshlrev_b32 v3, 4, v3
  v_and_b32 v5, 4, v4
  v_add_u32_e64 v4, v4, v5
  s_lshl_b32 s60, s60, 7
  s_lshl_b32 s69, s69, 14
  s_add_u32 s69, s69, s60
  s_lshl_b32 s68, s68, 11
  s_add_u32 s68, s68, 9601024
  s_cmp_eq_u32 s60, 384
  s_cselect_b32 s69, s68, s69
  s_cselect_b32 s64, 9, 12
  s_cselect_b32 s67, 7, 10
  v_lshl_add_u32 v3, v4, s67, v3
  v_add_u32 v7, s69, v3
  v_lshrrev_b32 v3, 4, v0
  v_lshlrev_b32 v4, 3, v11
  v_lshl_add_u32 v3, v3, 10, v4
  s_lshl_b32 s66, s61, 15
  s_add_u32 s66, s66, s60
  v_add_u32 v8, s66, v3
  v_lshrrev_b32 v3, 5, v1
  v_lshl_add_u32 v3, v3, 13, s53
  v_bfe_u32 v4, v1, 2, 3
  v_lshl_add_u32 v3, v4, 7, v3
  v_bfe_u32 v4, v1, 3, 2
  v_lshl_add_u32 v3, v4, 5, v3
  v_and_b32_e64 v4, 3, v1
  v_lshl_add_u32 v12, v4, 3, v3
  v_xor_b32 v13, 32, v12
  v_xor_b32 v14, 64, v12
  v_xor_b32 v15, 96, v12
  v_add_u32 v212, 81920, v12
  v_add_u32 v213, 81920, v13
  v_add_u32 v214, 81920, v14
  v_add_u32 v215, 81920, v15
  v_add_u32 v196, 147456, v12
  v_add_u32 v197, 147456, v13
  v_add_u32 v198, 147456, v14
  v_add_u32 v199, 147456, v15
  s_lshl_b32 s66, s45, 6
  v_lshlrev_b32 v30, 4, v11
  v_lshl_add_u32 v5, v11, 2, s66
  v_and_b32 v31, 0x30, v1
  v_add_u32 v3, s66, v31
  v_and_b32 v4, 0x200, v2
  v_add_u32 v4, v4, v30
  v_lshrrev_b32 v10, 5, v1
  v_mul_u32_u24 v10, 146944, v10
  v_add_u32 v10, v10, v2
  v_lshrrev_b32 v182, 3, v1
  v_and_b32 v182, 6, v182
  s_movk_i32 s66, 0x9c
  v_lshrrev_b32 v182, v182, s66
  v_lshrrev_b32_e64 v183, 2, v1
  v_bitop3_b32 v16, v182, v183, 3 bitop3:0x28
  v_lshrrev_b32 v183, 4, v0
  v_lshlrev_b32 v182, 2, v16
  v_sub_u32 v182, v182, v183
  s_add_u32 s66, s45, 64
  v_add_u32_e64 v182, s66, v182
  v_lshl_add_u32 v11, v182, 10, v8
  s_waitcnt vmcnt(5)
  s_barrier
  ds_read_b64_tr_b16 v[232:233], v25 offset:57344
  ds_read_b64_tr_b16 v[234:235], v25 offset:57856
  s_add_u32 m0, s52, 61440
  s_mov_b32 s48, 573440
  buffer_load_dwordx4 v21, s[28:31], s48 offen lds
  ds_read_b64_tr_b16 v[236:237], v26 offset:0
  ds_read_b64_tr_b16 v[238:239], v26 offset:512
  ds_read_b64_tr_b16 v[240:241], v26 offset:4096
  s_add_u32 m0, s53, 7808
  ds_read_b64_tr_b16 v[242:243], v26 offset:4608
  buffer_load_dwordx4 v18, s[20:23], s50 offen offset:384 lds
  ds_read_b64_tr_b16 v[244:245], v26 offset:8192
  ds_read_b64_tr_b16 v[246:247], v26 offset:8704
  s_add_u32 m0, s53, 16000
  ds_read_b64_tr_b16 v[248:249], v28 offset:12288
  buffer_load_dwordx4 v18, s[20:23], s51 offen offset:384 lds
  ds_read_b64_tr_b16 v[250:251], v28 offset:12544
  ds_read_b64_tr_b16 v[252:253], v28 offset:16384
  ds_read_b64_tr_b16 v[254:255], v28 offset:16640
  s_waitcnt lgkmcnt(10)
  v_mfma_f32_16x16x32_bf16 v[66:69], v[232:235], v[170:173], v[66:69]
  s_waitcnt lgkmcnt(8)
  v_mfma_f32_16x16x32_bf16 v[66:69], v[236:239], v[228:231], v[66:69]
  v_mfma_f32_16x16x32_bf16 v[62:65], v[236:239], v[224:227], v[62:65]
  v_mfma_f32_16x16x32_bf16 v[62:65], v[232:235], v[166:169], v[62:65]
  v_mfma_f32_16x16x32_bf16 v[58:61], v[232:235], v[162:165], v[58:61]
  v_mfma_f32_16x16x32_bf16 v[58:61], v[236:239], v[220:223], v[58:61]
  v_mfma_f32_16x16x32_bf16 v[54:57], v[236:239], v[216:219], v[54:57]
  v_mfma_f32_16x16x32_bf16 v[54:57], v[232:235], v[158:161], v[54:57]
  v_smfmac_f32_16x16x64_bf16 v[122:125], v[34:37], v[232:239], v32
  s_waitcnt lgkmcnt(6)
  v_mfma_f32_16x16x32_bf16 v[86:89], v[240:243], v[158:161], v[86:89]
  s_waitcnt lgkmcnt(4)
  v_mfma_f32_16x16x32_bf16 v[86:89], v[244:247], v[216:219], v[86:89]
  v_mfma_f32_16x16x32_bf16 v[90:93], v[244:247], v[220:223], v[90:93]
  v_mfma_f32_16x16x32_bf16 v[90:93], v[240:243], v[162:165], v[90:93]
  v_mfma_f32_16x16x32_bf16 v[94:97], v[240:243], v[166:169], v[94:97]
  v_mfma_f32_16x16x32_bf16 v[94:97], v[244:247], v[224:227], v[94:97]
  v_mfma_f32_16x16x32_bf16 v[98:101], v[244:247], v[228:231], v[98:101]
  v_mfma_f32_16x16x32_bf16 v[98:101], v[240:243], v[170:173], v[98:101]
  v_smfmac_f32_16x16x64_bf16 v[130:133], v[34:37], v[240:247], v32
  s_waitcnt lgkmcnt(2)
  v_mfma_f32_16x16x32_bf16 v[114:117], v[248:251], v[170:173], v[114:117]
  s_waitcnt lgkmcnt(0)
  v_mfma_f32_16x16x32_bf16 v[114:117], v[252:255], v[228:231], v[114:117]
  v_mfma_f32_16x16x32_bf16 v[110:113], v[252:255], v[224:227], v[110:113]
  v_mfma_f32_16x16x32_bf16 v[110:113], v[248:251], v[166:169], v[110:113]
  v_mfma_f32_16x16x32_bf16 v[106:109], v[248:251], v[162:165], v[106:109]
  v_mfma_f32_16x16x32_bf16 v[106:109], v[252:255], v[220:223], v[106:109]
  v_mfma_f32_16x16x32_bf16 v[102:105], v[252:255], v[216:219], v[102:105]
  v_mfma_f32_16x16x32_bf16 v[102:105], v[248:251], v[158:161], v[102:105]
  v_smfmac_f32_16x16x64_bf16 v[134:137], v[34:37], v[248:255], v32
  s_waitcnt vmcnt(4)
  s_barrier
  ds_read_b64_tr_b16 v[232:233], v26 offset:20480
  ds_read_b64_tr_b16 v[234:235], v26 offset:20992
  s_add_u32 m0, s52, 81920
  s_mov_b32 s48, 688128
  buffer_load_dwordx4 v20, s[24:27], s48 offen lds
  ds_read_b64_tr_b16 v[236:237], v26 offset:24576
  ds_read_b64_tr_b16 v[238:239], v26 offset:25088
  ds_read_b128 v[170:173], v23 offset:51200
  s_add_u32 m0, s52, 86016
  s_mov_b32 s48, 802816
  buffer_load_dwordx4 v20, s[24:27], s48 offen lds
  ds_read_b128 v[228:231], v24 offset:51200
  ds_read_b128 v[166:169], v23 offset:49152
  ds_read_b128 v[224:227], v24 offset:49152
  ds_read_b128 v[162:165], v23 offset:47104
  s_add_u32 m0, s52, 98304
  s_mov_b32 s48, 688128
  buffer_load_dwordx4 v21, s[28:31], s48 offen lds
  ds_read_b128 v[220:223], v24 offset:47104
  ds_read_b128 v[158:161], v23 offset:45056
  ds_read_b128 v[216:219], v24 offset:45056
  s_add_u32 m0, s52, 102400
  s_mov_b32 s48, 802816
  buffer_load_dwordx4 v21, s[28:31], s48 offen lds
  ds_read_b64_tr_b16 v[240:241], v26 offset:28672
  ds_read_b64_tr_b16 v[242:243], v26 offset:29184
  ds_read_b64_tr_b16 v[244:245], v26 offset:32768
  ds_read_b64_tr_b16 v[246:247], v26 offset:33280
  s_waitcnt lgkmcnt(11)
  v_mfma_f32_16x16x32_bf16 v[50:53], v[232:235], v[170:173], v[50:53]
  s_waitcnt lgkmcnt(10)
  v_mfma_f32_16x16x32_bf16 v[50:53], v[236:239], v[228:231], v[50:53]
  s_waitcnt lgkmcnt(8)
  v_mfma_f32_16x16x32_bf16 v[46:49], v[236:239], v[224:227], v[46:49]
  v_mfma_f32_16x16x32_bf16 v[46:49], v[232:235], v[166:169], v[46:49]
  s_waitcnt lgkmcnt(7)
  v_mfma_f32_16x16x32_bf16 v[42:45], v[232:235], v[162:165], v[42:45]
  s_waitcnt lgkmcnt(6)
  v_mfma_f32_16x16x32_bf16 v[42:45], v[236:239], v[220:223], v[42:45]
  s_waitcnt lgkmcnt(4)
  v_mfma_f32_16x16x32_bf16 v[38:41], v[236:239], v[216:219], v[38:41]
  v_mfma_f32_16x16x32_bf16 v[38:41], v[232:235], v[158:161], v[38:41]
  v_smfmac_f32_16x16x64_bf16 v[118:121], v[34:37], v[232:239], v32
  s_waitcnt lgkmcnt(2)
  v_mfma_f32_16x16x32_bf16 v[70:73], v[240:243], v[158:161], v[70:73]
  s_waitcnt lgkmcnt(0)
  v_mfma_f32_16x16x32_bf16 v[70:73], v[244:247], v[216:219], v[70:73]
  v_mfma_f32_16x16x32_bf16 v[74:77], v[244:247], v[220:223], v[74:77]
  v_mfma_f32_16x16x32_bf16 v[74:77], v[240:243], v[162:165], v[74:77]
  v_mfma_f32_16x16x32_bf16 v[78:81], v[240:243], v[166:169], v[78:81]
  v_mfma_f32_16x16x32_bf16 v[78:81], v[244:247], v[224:227], v[78:81]
  v_mfma_f32_16x16x32_bf16 v[82:85], v[244:247], v[228:231], v[82:85]
  v_mfma_f32_16x16x32_bf16 v[82:85], v[240:243], v[170:173], v[82:85]
  v_smfmac_f32_16x16x64_bf16 v[126:129], v[34:37], v[240:247], v32
  s_waitcnt vmcnt(6)
  s_barrier
  ds_read_b64_tr_b16 v[232:233], v26 offset:36864
  ds_read_b64_tr_b16 v[234:235], v26 offset:37376
  s_add_u32 m0, s53, 26112
  ds_read_b64_tr_b16 v[236:237], v25 offset:0
  buffer_load_dwordx4 v18, s[20:23], s50 offen offset:512 lds
  ds_read_b64_tr_b16 v[238:239], v25 offset:512
  s_add_u32 m0, s53, 34304
  ds_read_b64_tr_b16 v[240:241], v25 offset:4096
  buffer_load_dwordx4 v18, s[20:23], s51 offen offset:512 lds
  ds_read_b64_tr_b16 v[242:243], v25 offset:4608
  ds_read_b64_tr_b16 v[244:245], v25 offset:8192
  s_add_u32 m0, s52, 122880
  s_mov_b32 s48, 917504
  buffer_load_dwordx4 v20, s[24:27], s48 offen lds
  ds_read_b64_tr_b16 v[246:247], v25 offset:8704
  ds_read_b64_tr_b16 v[248:249], v27 offset:12288
  global_load_dword v177, v210, s[6:7]
  ds_read_b64_tr_b16 v[250:251], v27 offset:12544
  ds_read_b64_tr_b16 v[252:253], v27 offset:16384
  ds_read_b64_tr_b16 v[254:255], v27 offset:16640
  s_waitcnt lgkmcnt(10)
  v_mfma_f32_16x16x32_bf16 v[66:69], v[232:235], v[170:173], v[66:69]
  s_waitcnt lgkmcnt(8)
  v_mfma_f32_16x16x32_bf16 v[66:69], v[236:239], v[228:231], v[66:69]
  v_mfma_f32_16x16x32_bf16 v[62:65], v[236:239], v[224:227], v[62:65]
  v_mfma_f32_16x16x32_bf16 v[62:65], v[232:235], v[166:169], v[62:65]
  v_mfma_f32_16x16x32_bf16 v[58:61], v[232:235], v[162:165], v[58:61]
  v_mfma_f32_16x16x32_bf16 v[58:61], v[236:239], v[220:223], v[58:61]
  v_mfma_f32_16x16x32_bf16 v[54:57], v[236:239], v[216:219], v[54:57]
  v_mfma_f32_16x16x32_bf16 v[54:57], v[232:235], v[158:161], v[54:57]
  v_smfmac_f32_16x16x64_bf16 v[122:125], v[34:37], v[232:239], v32
  s_waitcnt lgkmcnt(6)
  v_mfma_f32_16x16x32_bf16 v[86:89], v[240:243], v[158:161], v[86:89]
  s_waitcnt lgkmcnt(4)
  v_mfma_f32_16x16x32_bf16 v[86:89], v[244:247], v[216:219], v[86:89]
  v_mfma_f32_16x16x32_bf16 v[90:93], v[244:247], v[220:223], v[90:93]
  v_mfma_f32_16x16x32_bf16 v[90:93], v[240:243], v[162:165], v[90:93]
L_B0w0:
  s_cbranch_execz L_B0w1
  s_nop 0
  v_mfma_f32_16x16x32_bf16 v[94:97], v[240:243], v[166:169], v[94:97]
  v_mfma_f32_16x16x32_bf16 v[94:97], v[244:247], v[224:227], v[94:97]
  v_mfma_f32_16x16x32_bf16 v[98:101], v[244:247], v[228:231], v[98:101]
  v_mfma_f32_16x16x32_bf16 v[98:101], v[240:243], v[170:173], v[98:101]
  v_smfmac_f32_16x16x64_bf16 v[130:133], v[34:37], v[240:247], v32
  s_waitcnt lgkmcnt(2)
  v_mfma_f32_16x16x32_bf16 v[114:117], v[248:251], v[170:173], v[114:117]
  s_waitcnt lgkmcnt(0)
  v_mfma_f32_16x16x32_bf16 v[114:117], v[252:255], v[228:231], v[114:117]
  v_mfma_f32_16x16x32_bf16 v[110:113], v[252:255], v[224:227], v[110:113]
  v_mfma_f32_16x16x32_bf16 v[110:113], v[248:251], v[166:169], v[110:113]
  v_mfma_f32_16x16x32_bf16 v[106:109], v[248:251], v[162:165], v[106:109]
  v_mfma_f32_16x16x32_bf16 v[106:109], v[252:255], v[220:223], v[106:109]
  v_mfma_f32_16x16x32_bf16 v[102:105], v[252:255], v[216:219], v[102:105]
  v_mfma_f32_16x16x32_bf16 v[102:105], v[248:251], v[158:161], v[102:105]
  v_smfmac_f32_16x16x64_bf16 v[134:137], v[34:37], v[248:255], v32
  s_waitcnt vmcnt(6)
  s_barrier
  ds_read_b64_tr_b16 v[232:233], v25 offset:20480
  ds_read_b64_tr_b16 v[234:235], v25 offset:20992
  s_add_u32 m0, s52, 126976
  s_mov_b32 s48, 1032192
  buffer_load_dwordx4 v20, s[24:27], s48 offen lds
  ds_read_b64_tr_b16 v[236:237], v25 offset:24576
  ds_read_b64_tr_b16 v[238:239], v25 offset:25088
  ds_read_b128 v[170:173], v23 offset:14336
  s_add_u32 m0, s52, 139264
  s_mov_b32 s48, 917504
  buffer_load_dwordx4 v21, s[28:31], s48 offen lds
  ds_read_b128 v[228:231], v24 offset:14336
  ds_read_b128 v[166:169], v23 offset:12288
  ds_read_b128 v[224:227], v24 offset:12288
  ds_read_b128 v[162:165], v23 offset:10240
  s_add_u32 m0, s52, 143360
  s_mov_b32 s48, 1032192
  buffer_load_dwordx4 v21, s[28:31], s48 offen lds
  ds_read_b128 v[220:223], v24 offset:10240
  ds_read_b128 v[158:161], v23 offset:8192
  ds_read_b128 v[216:219], v24 offset:8192
  s_add_u32 m0, s53, 44416
  ds_read_b64_tr_b16 v[240:241], v25 offset:28672
  buffer_load_dwordx4 v18, s[20:23], s50 offen offset:640 lds
  ds_read_b64_tr_b16 v[242:243], v25 offset:29184
  ds_read_b64_tr_b16 v[244:245], v25 offset:32768
  ds_read_b64_tr_b16 v[246:247], v25 offset:33280
  s_waitcnt lgkmcnt(11)
  v_mfma_f32_16x16x32_bf16 v[50:53], v[232:235], v[170:173], v[50:53]
  s_waitcnt lgkmcnt(10)
  v_mfma_f32_16x16x32_bf16 v[50:53], v[236:239], v[228:231], v[50:53]
  s_waitcnt lgkmcnt(8)
  v_mfma_f32_16x16x32_bf16 v[46:49], v[236:239], v[224:227], v[46:49]
  v_mfma_f32_16x16x32_bf16 v[46:49], v[232:235], v[166:169], v[46:49]
  s_waitcnt lgkmcnt(7)
  v_mfma_f32_16x16x32_bf16 v[42:45], v[232:235], v[162:165], v[42:45]
  s_waitcnt lgkmcnt(6)
  v_mfma_f32_16x16x32_bf16 v[42:45], v[236:239], v[220:223], v[42:45]
  s_waitcnt lgkmcnt(4)
  v_mfma_f32_16x16x32_bf16 v[38:41], v[236:239], v[216:219], v[38:41]
  v_mfma_f32_16x16x32_bf16 v[38:41], v[232:235], v[158:161], v[38:41]
  v_smfmac_f32_16x16x64_bf16 v[118:121], v[34:37], v[232:239], v32
  s_waitcnt lgkmcnt(2)
  v_mfma_f32_16x16x32_bf16 v[70:73], v[240:243], v[158:161], v[70:73]
  s_waitcnt lgkmcnt(0)
  v_mfma_f32_16x16x32_bf16 v[70:73], v[244:247], v[216:219], v[70:73]
  v_mfma_f32_16x16x32_bf16 v[74:77], v[244:247], v[220:223], v[74:77]
  v_mfma_f32_16x16x32_bf16 v[74:77], v[240:243], v[162:165], v[74:77]
  v_mfma_f32_16x16x32_bf16 v[78:81], v[240:243], v[166:169], v[78:81]
  v_mfma_f32_16x16x32_bf16 v[78:81], v[244:247], v[224:227], v[78:81]
  v_mfma_f32_16x16x32_bf16 v[82:85], v[244:247], v[228:231], v[82:85]
  v_mfma_f32_16x16x32_bf16 v[82:85], v[240:243], v[170:173], v[82:85]
  v_smfmac_f32_16x16x64_bf16 v[126:129], v[34:37], v[240:247], v32
  s_waitcnt vmcnt(8)
  s_barrier
  ds_read_b64_tr_b16 v[232:233], v25 offset:36864
  ds_read_b64_tr_b16 v[234:235], v25 offset:37376
  s_add_u32 m0, s53, 52608
  ds_read_b64_tr_b16 v[236:237], v25 offset:40960
  buffer_load_dwordx4 v18, s[20:23], s51 offen offset:640 lds
  ds_read_b64_tr_b16 v[238:239], v25 offset:41472
  ds_read_b64_tr_b16 v[240:241], v25 offset:45056
  s_add_u32 m0, s52, 61440
  s_mov_b32 s48, 1146880
  buffer_load_dwordx4 v20, s[24:27], s48 offen lds
  ds_read_b64_tr_b16 v[242:243], v25 offset:45568
  ds_read_b64_tr_b16 v[244:245], v25 offset:49152
  ds_read_b64_tr_b16 v[246:247], v25 offset:49664
  s_add_u32 m0, s52, 65536
  s_mov_b32 s48, 1261568
  buffer_load_dwordx4 v20, s[24:27], s48 offen lds
  ds_read_b64_tr_b16 v[248:249], v27 offset:53248
  ds_read_b64_tr_b16 v[250:251], v27 offset:53504
  ds_read_b64_tr_b16 v[252:253], v27 offset:57344
  ds_read_b64_tr_b16 v[254:255], v27 offset:57600
  s_waitcnt lgkmcnt(10)
  v_mfma_f32_16x16x32_bf16 v[66:69], v[232:235], v[170:173], v[66:69]
  s_waitcnt lgkmcnt(8)
  v_mfma_f32_16x16x32_bf16 v[66:69], v[236:239], v[228:231], v[66:69]
  v_mfma_f32_16x16x32_bf16 v[62:65], v[236:239], v[224:227], v[62:65]
  v_mfma_f32_16x16x32_bf16 v[62:65], v[232:235], v[166:169], v[62:65]
  v_mfma_f32_16x16x32_bf16 v[58:61], v[232:235], v[162:165], v[58:61]
  v_mfma_f32_16x16x32_bf16 v[58:61], v[236:239], v[220:223], v[58:61]
  v_mfma_f32_16x16x32_bf16 v[54:57], v[236:239], v[216:219], v[54:57]
  v_mfma_f32_16x16x32_bf16 v[54:57], v[232:235], v[158:161], v[54:57]
  v_smfmac_f32_16x16x64_bf16 v[122:125], v[34:37], v[232:239], v32
  s_waitcnt lgkmcnt(6)
  v_mfma_f32_16x16x32_bf16 v[86:89], v[240:243], v[158:161], v[86:89]
  s_waitcnt lgkmcnt(4)
  v_mfma_f32_16x16x32_bf16 v[86:89], v[244:247], v[216:219], v[86:89]
  v_mfma_f32_16x16x32_bf16 v[90:93], v[244:247], v[220:223], v[90:93]
  v_mfma_f32_16x16x32_bf16 v[90:93], v[240:243], v[162:165], v[90:93]
  v_mfma_f32_16x16x32_bf16 v[94:97], v[240:243], v[166:169], v[94:97]
  v_mfma_f32_16x16x32_bf16 v[94:97], v[244:247], v[224:227], v[94:97]
  v_mfma_f32_16x16x32_bf16 v[98:101], v[244:247], v[228:231], v[98:101]
  v_mfma_f32_16x16x32_bf16 v[98:101], v[240:243], v[170:173], v[98:101]
  v_smfmac_f32_16x16x64_bf16 v[130:133], v[34:37], v[240:247], v32
  s_waitcnt lgkmcnt(2)
  v_mfma_f32_16x16x32_bf16 v[114:117], v[248:251], v[170:173], v[114:117]
  s_waitcnt lgkmcnt(0)
  v_mfma_f32_16x16x32_bf16 v[114:117], v[252:255], v[228:231], v[114:117]
  v_mfma_f32_16x16x32_bf16 v[110:113], v[252:255], v[224:227], v[110:113]
  v_mfma_f32_16x16x32_bf16 v[110:113], v[248:251], v[166:169], v[110:113]
  v_mfma_f32_16x16x32_bf16 v[106:109], v[248:251], v[162:165], v[106:109]
  v_mfma_f32_16x16x32_bf16 v[106:109], v[252:255], v[220:223], v[106:109]
  v_mfma_f32_16x16x32_bf16 v[102:105], v[252:255], v[216:219], v[102:105]
  v_mfma_f32_16x16x32_bf16 v[102:105], v[248:251], v[158:161], v[102:105]
  v_smfmac_f32_16x16x64_bf16 v[134:137], v[34:37], v[248:255], v32
  s_waitcnt vmcnt(6)
  s_barrier
  ds_read_b64_tr_b16 v[232:233], v26 offset:0
  ds_read_b64_tr_b16 v[234:235], v26 offset:512
  s_add_u32 m0, s52, 77824
  s_mov_b32 s48, 1146880
  buffer_load_dwordx4 v21, s[28:31], s48 offen lds
  ds_read_b64_tr_b16 v[236:237], v26 offset:4096
  ds_read_b64_tr_b16 v[238:239], v26 offset:4608
  ds_read_b128 v[170:173], v23 offset:32768
  s_add_u32 m0, s52, 81920
  s_mov_b32 s48, 1261568
  buffer_load_dwordx4 v21, s[28:31], s48 offen lds
  ds_read_b128 v[228:231], v24 offset:32768
  ds_read_b128 v[166:169], v23 offset:30720
  ds_read_b128 v[224:227], v24 offset:30720
  ds_read_b128 v[162:165], v23 offset:28672
  s_add_u32 m0, s53, 7424
  ds_read_b128 v[220:223], v24 offset:28672
  buffer_load_dwordx4 v18, s[20:23], s50 offen offset:768 lds
  ds_read_b128 v[158:161], v23 offset:26624
  ds_read_b128 v[216:219], v24 offset:26624
  s_add_u32 m0, s53, 15616
  ds_read_b64_tr_b16 v[240:241], v26 offset:8192
  buffer_load_dwordx4 v18, s[20:23], s51 offen offset:768 lds
  ds_read_b64_tr_b16 v[242:243], v26 offset:8704
  ds_read_b64_tr_b16 v[244:245], v26 offset:12288
  ds_read_b64_tr_b16 v[246:247], v26 offset:12800
  s_waitcnt lgkmcnt(11)
  v_mfma_f32_16x16x32_bf16 v[50:53], v[232:235], v[170:173], v[50:53]
  s_waitcnt lgkmcnt(10)
  v_mfma_f32_16x16x32_bf16 v[50:53], v[236:239], v[228:231], v[50:53]
  s_waitcnt lgkmcnt(8)
  v_mfma_f32_16x16x32_bf16 v[46:49], v[236:239], v[224:227], v[46:49]
  v_mfma_f32_16x16x32_bf16 v[46:49], v[232:235], v[166:169], v[46:49]
  s_waitcnt lgkmcnt(7)
  v_mfma_f32_16x16x32_bf16 v[42:45], v[232:235], v[162:165], v[42:45]
  s_waitcnt lgkmcnt(6)
  v_mfma_f32_16x16x32_bf16 v[42:45], v[236:239], v[220:223], v[42:45]
  s_waitcnt lgkmcnt(4)
  v_mfma_f32_16x16x32_bf16 v[38:41], v[236:239], v[216:219], v[38:41]
  v_mfma_f32_16x16x32_bf16 v[38:41], v[232:235], v[158:161], v[38:41]
  v_smfmac_f32_16x16x64_bf16 v[118:121], v[34:37], v[232:239], v32
  s_waitcnt lgkmcnt(2)
  v_mfma_f32_16x16x32_bf16 v[70:73], v[240:243], v[158:161], v[70:73]
  s_waitcnt lgkmcnt(0)
  v_mfma_f32_16x16x32_bf16 v[70:73], v[244:247], v[216:219], v[70:73]
  v_mfma_f32_16x16x32_bf16 v[74:77], v[244:247], v[220:223], v[74:77]
  v_mfma_f32_16x16x32_bf16 v[74:77], v[240:243], v[162:165], v[74:77]
  v_mfma_f32_16x16x32_bf16 v[78:81], v[240:243], v[166:169], v[78:81]
  v_mfma_f32_16x16x32_bf16 v[78:81], v[244:247], v[224:227], v[78:81]
  v_mfma_f32_16x16x32_bf16 v[82:85], v[244:247], v[228:231], v[82:85]
  v_mfma_f32_16x16x32_bf16 v[82:85], v[240:243], v[170:173], v[82:85]
  v_smfmac_f32_16x16x64_bf16 v[126:129], v[34:37], v[240:247], v32
  s_waitcnt vmcnt(8)
  s_barrier
  ds_read_b64_tr_b16 v[232:233], v26 offset:16384
  ds_read_b64_tr_b16 v[234:235], v26 offset:16896
  s_add_u32 m0, s52, 102400
  s_mov_b32 s48, 1376256
  buffer_load_dwordx4 v20, s[24:27], s48 offen lds
  ds_read_b64_tr_b16 v[236:237], v26 offset:20480
  ds_read_b64_tr_b16 v[238:239], v26 offset:20992
  ds_read_b64_tr_b16 v[240:241], v26 offset:24576
  s_add_u32 m0, s52, 106496
  s_mov_b32 s48, 1490944
  buffer_load_dwordx4 v20, s[24:27], s48 offen lds
  ds_read_b64_tr_b16 v[242:243], v26 offset:25088
  ds_read_b64_tr_b16 v[244:245], v26 offset:28672
  ds_read_b64_tr_b16 v[246:247], v26 offset:29184
  s_add_u32 m0, s52, 118784
  s_mov_b32 s48, 1376256
  buffer_load_dwordx4 v21, s[28:31], s48 offen lds
  ds_read_b64_tr_b16 v[248:249], v28 offset:32768
  ds_read_b64_tr_b16 v[250:251], v28 offset:33024
  ds_read_b64_tr_b16 v[252:253], v28 offset:36864
  ds_read_b64_tr_b16 v[254:255], v28 offset:37120
  s_waitcnt lgkmcnt(10)
  v_mfma_f32_16x16x32_bf16 v[66:69], v[232:235], v[170:173], v[66:69]
  s_waitcnt lgkmcnt(8)
  v_mfma_f32_16x16x32_bf16 v[66:69], v[236:239], v[228:231], v[66:69]
  v_mfma_f32_16x16x32_bf16 v[62:65], v[236:239], v[224:227], v[62:65]
  v_mfma_f32_16x16x32_bf16 v[62:65], v[232:235], v[166:169], v[62:65]
  v_mfma_f32_16x16x32_bf16 v[58:61], v[232:235], v[162:165], v[58:61]
  v_mfma_f32_16x16x32_bf16 v[58:61], v[236:239], v[220:223], v[58:61]
  v_mfma_f32_16x16x32_bf16 v[54:57], v[236:239], v[216:219], v[54:57]
  v_mfma_f32_16x16x32_bf16 v[54:57], v[232:235], v[158:161], v[54:57]
  v_smfmac_f32_16x16x64_bf16 v[122:125], v[34:37], v[232:239], v32
  s_waitcnt lgkmcnt(6)
  v_mfma_f32_16x16x32_bf16 v[86:89], v[240:243], v[158:161], v[86:89]
  s_waitcnt lgkmcnt(4)
  v_mfma_f32_16x16x32_bf16 v[86:89], v[244:247], v[216:219], v[86:89]
  v_mfma_f32_16x16x32_bf16 v[90:93], v[244:247], v[220:223], v[90:93]
  v_mfma_f32_16x16x32_bf16 v[90:93], v[240:243], v[162:165], v[90:93]
  v_mfma_f32_16x16x32_bf16 v[94:97], v[240:243], v[166:169], v[94:97]
  v_mfma_f32_16x16x32_bf16 v[94:97], v[244:247], v[224:227], v[94:97]
  v_mfma_f32_16x16x32_bf16 v[98:101], v[244:247], v[228:231], v[98:101]
  v_mfma_f32_16x16x32_bf16 v[98:101], v[240:243], v[170:173], v[98:101]
  v_smfmac_f32_16x16x64_bf16 v[130:133], v[34:37], v[240:247], v32
  s_waitcnt lgkmcnt(2)
  v_mfma_f32_16x16x32_bf16 v[114:117], v[248:251], v[170:173], v[114:117]
  s_waitcnt lgkmcnt(0)
  v_mfma_f32_16x16x32_bf16 v[114:117], v[252:255], v[228:231], v[114:117]
  v_mfma_f32_16x16x32_bf16 v[110:113], v[252:255], v[224:227], v[110:113]
  v_mfma_f32_16x16x32_bf16 v[110:113], v[248:251], v[166:169], v[110:113]
  v_mfma_f32_16x16x32_bf16 v[106:109], v[248:251], v[162:165], v[106:109]
  v_mfma_f32_16x16x32_bf16 v[106:109], v[252:255], v[220:223], v[106:109]
  v_mfma_f32_16x16x32_bf16 v[102:105], v[252:255], v[216:219], v[102:105]
  v_mfma_f32_16x16x32_bf16 v[102:105], v[248:251], v[158:161], v[102:105]
  v_smfmac_f32_16x16x64_bf16 v[134:137], v[34:37], v[248:255], v32
  s_waitcnt vmcnt(7)
  s_barrier
  ds_read_b64_tr_b16 v[232:233], v25 offset:0
  ds_read_b64_tr_b16 v[234:235], v25 offset:512
  s_add_u32 m0, s52, 122880
  s_mov_b32 s48, 1490944
  buffer_load_dwordx4 v21, s[28:31], s48 offen lds
  ds_read_b64_tr_b16 v[236:237], v25 offset:4096
  ds_read_b64_tr_b16 v[238:239], v25 offset:4608
  ds_read_b128 v[170:173], v23 offset:51200
  s_add_u32 m0, s53, 25728
  ds_read_b128 v[228:231], v24 offset:51200
  buffer_load_dwordx4 v18, s[20:23], s50 offen offset:896 lds
  ds_read_b128 v[166:169], v23 offset:49152
  ds_read_b128 v[224:227], v24 offset:49152
  ds_read_b128 v[162:165], v23 offset:47104
  s_add_u32 m0, s53, 33920
  ds_read_b128 v[220:223], v24 offset:47104
  buffer_load_dwordx4 v18, s[20:23], s51 offen offset:896 lds
  ds_read_b128 v[158:161], v23 offset:45056
  ds_read_b128 v[216:219], v24 offset:45056
  s_add_u32 m0, s52, 143360
  s_mov_b32 s48, 1605632
  buffer_load_dwordx4 v20, s[24:27], s48 offen lds
  ds_read_b64_tr_b16 v[240:241], v25 offset:8192
  ds_read_b64_tr_b16 v[242:243], v25 offset:8704
  ds_read_b64_tr_b16 v[244:245], v25 offset:12288
  ds_read_b64_tr_b16 v[246:247], v25 offset:12800
  s_waitcnt lgkmcnt(11)
  v_mfma_f32_16x16x32_bf16 v[50:53], v[232:235], v[170:173], v[50:53]
  s_waitcnt lgkmcnt(10)
  v_mfma_f32_16x16x32_bf16 v[50:53], v[236:239], v[228:231], v[50:53]
  s_waitcnt lgkmcnt(8)
  v_mfma_f32_16x16x32_bf16 v[46:49], v[236:239], v[224:227], v[46:49]
  v_mfma_f32_16x16x32_bf16 v[46:49], v[232:235], v[166:169], v[46:49]
  s_waitcnt lgkmcnt(7)
  v_mfma_f32_16x16x32_bf16 v[42:45], v[232:235], v[162:165], v[42:45]
  s_waitcnt lgkmcnt(6)
  v_mfma_f32_16x16x32_bf16 v[42:45], v[236:239], v[220:223], v[42:45]
  s_waitcnt lgkmcnt(4)
  v_mfma_f32_16x16x32_bf16 v[38:41], v[236:239], v[216:219], v[38:41]
  v_mfma_f32_16x16x32_bf16 v[38:41], v[232:235], v[158:161], v[38:41]
  v_smfmac_f32_16x16x64_bf16 v[118:121], v[34:37], v[232:239], v32
  s_waitcnt lgkmcnt(2)
  v_mfma_f32_16x16x32_bf16 v[70:73], v[240:243], v[158:161], v[70:73]
  s_waitcnt lgkmcnt(0)
  v_mfma_f32_16x16x32_bf16 v[70:73], v[244:247], v[216:219], v[70:73]
  v_mfma_f32_16x16x32_bf16 v[74:77], v[244:247], v[220:223], v[74:77]
  v_mfma_f32_16x16x32_bf16 v[74:77], v[240:243], v[162:165], v[74:77]
  v_mfma_f32_16x16x32_bf16 v[78:81], v[240:243], v[166:169], v[78:81]
  v_mfma_f32_16x16x32_bf16 v[78:81], v[244:247], v[224:227], v[78:81]
  v_mfma_f32_16x16x32_bf16 v[82:85], v[244:247], v[228:231], v[82:85]
  v_mfma_f32_16x16x32_bf16 v[82:85], v[240:243], v[170:173], v[82:85]
  v_smfmac_f32_16x16x64_bf16 v[126:129], v[34:37], v[240:247], v32
  s_waitcnt vmcnt(9)
  s_barrier
  ds_read_b64_tr_b16 v[232:233], v25 offset:16384
  ds_read_b64_tr_b16 v[234:235], v25 offset:16896
  s_add_u32 m0, s52, 147456
  s_mov_b32 s48, 1720320
  buffer_load_dwordx4 v20, s[24:27], s48 offen lds
  ds_read_b64_tr_b16 v[236:237], v25 offset:20480
  ds_read_b64_tr_b16 v[238:239], v25 offset:20992
  ds_read_b64_tr_b16 v[240:241], v25 offset:24576
  s_add_u32 m0, s52, 159744
  s_mov_b32 s48, 1605632
  buffer_load_dwordx4 v21, s[28:31], s48 offen lds
  ds_read_b64_tr_b16 v[242:243], v25 offset:25088
  ds_read_b64_tr_b16 v[244:245], v25 offset:28672
  ds_read_b64_tr_b16 v[246:247], v25 offset:29184
  s_add_u32 m0, s52, 61440
  s_mov_b32 s48, 1720320
  buffer_load_dwordx4 v21, s[28:31], s48 offen lds
  ds_read_b64_tr_b16 v[248:249], v27 offset:32768
  ds_read_b64_tr_b16 v[250:251], v27 offset:33024
  ds_read_b64_tr_b16 v[252:253], v27 offset:36864
  ds_read_b64_tr_b16 v[254:255], v27 offset:37120
  s_waitcnt lgkmcnt(10)
  v_mfma_f32_16x16x32_bf16 v[66:69], v[232:235], v[170:173], v[66:69]
  s_waitcnt lgkmcnt(8)
  v_mfma_f32_16x16x32_bf16 v[66:69], v[236:239], v[228:231], v[66:69]
  v_mfma_f32_16x16x32_bf16 v[62:65], v[236:239], v[224:227], v[62:65]
  v_mfma_f32_16x16x32_bf16 v[62:65], v[232:235], v[166:169], v[62:65]
  v_mfma_f32_16x16x32_bf16 v[58:61], v[232:235], v[162:165], v[58:61]
  v_mfma_f32_16x16x32_bf16 v[58:61], v[236:239], v[220:223], v[58:61]
  v_mfma_f32_16x16x32_bf16 v[54:57], v[236:239], v[216:219], v[54:57]
  v_mfma_f32_16x16x32_bf16 v[54:57], v[232:235], v[158:161], v[54:57]
  v_smfmac_f32_16x16x64_bf16 v[122:125], v[34:37], v[232:239], v32
  s_waitcnt lgkmcnt(6)
  v_mfma_f32_16x16x32_bf16 v[86:89], v[240:243], v[158:161], v[86:89]
  s_waitcnt lgkmcnt(4)
  v_mfma_f32_16x16x32_bf16 v[86:89], v[244:247], v[216:219], v[86:89]
  v_mfma_f32_16x16x32_bf16 v[90:93], v[244:247], v[220:223], v[90:93]
  v_mfma_f32_16x16x32_bf16 v[90:93], v[240:243], v[162:165], v[90:93]
  v_mfma_f32_16x16x32_bf16 v[94:97], v[240:243], v[166:169], v[94:97]
  v_mfma_f32_16x16x32_bf16 v[94:97], v[244:247], v[224:227], v[94:97]
  v_mfma_f32_16x16x32_bf16 v[98:101], v[244:247], v[228:231], v[98:101]
  v_mfma_f32_16x16x32_bf16 v[98:101], v[240:243], v[170:173], v[98:101]
  v_smfmac_f32_16x16x64_bf16 v[130:133], v[34:37], v[240:247], v32
  s_waitcnt lgkmcnt(2)
  v_mfma_f32_16x16x32_bf16 v[114:117], v[248:251], v[170:173], v[114:117]
  s_waitcnt lgkmcnt(0)
  v_mfma_f32_16x16x32_bf16 v[114:117], v[252:255], v[228:231], v[114:117]
  v_mfma_f32_16x16x32_bf16 v[110:113], v[252:255], v[224:227], v[110:113]
  v_mfma_f32_16x16x32_bf16 v[110:113], v[248:251], v[166:169], v[110:113]
  v_mfma_f32_16x16x32_bf16 v[106:109], v[248:251], v[162:165], v[106:109]
  v_mfma_f32_16x16x32_bf16 v[106:109], v[252:255], v[220:223], v[106:109]
  v_mfma_f32_16x16x32_bf16 v[102:105], v[252:255], v[216:219], v[102:105]
  v_mfma_f32_16x16x32_bf16 v[102:105], v[248:251], v[158:161], v[102:105]
  v_smfmac_f32_16x16x64_bf16 v[134:137], v[34:37], v[248:255], v32
  s_waitcnt vmcnt(8)
  s_barrier
  ds_read_b64_tr_b16 v[232:233], v25 offset:40960
  ds_read_b64_tr_b16 v[234:235], v25 offset:41472
  s_cmp_eq_u32 s64, 9
  s_cselect_b64 s[16:17], s[40:41], s[16:17]
  s_cselect_b32 s18, s42, s18
  s_add_u32 m0, s53, 43008
  s_lshl_b32 s60, 0, s64
  buffer_load_dwordx4 v7, s[16:19], s60 offen lds
  ds_read_b64_tr_b16 v[236:237], v25 offset:45056
  ds_read_b64_tr_b16 v[238:239], v25 offset:45568
  ds_read_b128 v[170:173], v23 offset:14336
  s_add_u32 m0, s53, 51200
  s_lshl_b32 s60, 4, s64
  buffer_load_dwordx4 v7, s[16:19], s60 offen lds
  ds_read_b128 v[228:231], v24 offset:14336
  ds_read_b128 v[166:169], v23 offset:12288
  ds_read_b128 v[224:227], v24 offset:12288
  ds_read_b128 v[162:165], v23 offset:10240
  s_add_u32 m0, s53, 81920
  s_lshl_b32 s60, 1, s64
  buffer_load_dwordx4 v7, s[16:19], s60 offen lds
  ds_read_b128 v[220:223], v24 offset:10240
  ds_read_b128 v[158:161], v23 offset:8192
  ds_read_b128 v[216:219], v24 offset:8192
  s_add_u32 m0, s53, 90112
  s_lshl_b32 s60, 5, s64
  buffer_load_dwordx4 v7, s[16:19], s60 offen lds
  ds_read_b64_tr_b16 v[240:241], v25 offset:49152
  ds_read_b64_tr_b16 v[242:243], v25 offset:49664
  ds_read_b64_tr_b16 v[244:245], v25 offset:53248
  ds_read_b64_tr_b16 v[246:247], v25 offset:53760
  s_waitcnt lgkmcnt(11)
  v_mfma_f32_16x16x32_bf16 v[50:53], v[232:235], v[170:173], v[50:53]
  s_waitcnt lgkmcnt(10)
  v_mfma_f32_16x16x32_bf16 v[50:53], v[236:239], v[228:231], v[50:53]
  s_waitcnt lgkmcnt(8)
  v_mfma_f32_16x16x32_bf16 v[46:49], v[236:239], v[224:227], v[46:49]
  v_mfma_f32_16x16x32_bf16 v[46:49], v[232:235], v[166:169], v[46:49]
  s_waitcnt lgkmcnt(7)
  v_mfma_f32_16x16x32_bf16 v[42:45], v[232:235], v[162:165], v[42:45]
  s_waitcnt lgkmcnt(6)
  v_mfma_f32_16x16x32_bf16 v[42:45], v[236:239], v[220:223], v[42:45]
  s_waitcnt lgkmcnt(4)
  v_mfma_f32_16x16x32_bf16 v[38:41], v[236:239], v[216:219], v[38:41]
  v_mfma_f32_16x16x32_bf16 v[38:41], v[232:235], v[158:161], v[38:41]
  v_smfmac_f32_16x16x64_bf16 v[118:121], v[34:37], v[232:239], v32
  s_waitcnt lgkmcnt(2)
  v_mfma_f32_16x16x32_bf16 v[70:73], v[240:243], v[158:161], v[70:73]
  s_waitcnt lgkmcnt(0)
  v_mfma_f32_16x16x32_bf16 v[70:73], v[244:247], v[216:219], v[70:73]
  v_mfma_f32_16x16x32_bf16 v[74:77], v[244:247], v[220:223], v[74:77]
  v_mfma_f32_16x16x32_bf16 v[74:77], v[240:243], v[162:165], v[74:77]
  v_mfma_f32_16x16x32_bf16 v[78:81], v[240:243], v[166:169], v[78:81]
  v_mfma_f32_16x16x32_bf16 v[78:81], v[244:247], v[224:227], v[78:81]
  v_mfma_f32_16x16x32_bf16 v[82:85], v[244:247], v[228:231], v[82:85]
  v_mfma_f32_16x16x32_bf16 v[82:85], v[240:243], v[170:173], v[82:85]
  v_smfmac_f32_16x16x64_bf16 v[126:129], v[34:37], v[240:247], v32
  s_waitcnt vmcnt(10)
  s_barrier
  ds_read_b64_tr_b16 v[232:233], v25 offset:57344
  ds_read_b64_tr_b16 v[234:235], v25 offset:57856
  s_add_u32 m0, s53, 98304
  s_lshl_b32 s60, 8, s64
  buffer_load_dwordx4 v7, s[16:19], s60 offen lds
  ds_read_b64_tr_b16 v[236:237], v26 offset:0
  ds_read_b64_tr_b16 v[238:239], v26 offset:512
  s_add_u32 m0, s53, 106496
  s_lshl_b32 s60, 12, s64
  buffer_load_dwordx4 v7, s[16:19], s60 offen lds
  ds_read_b64_tr_b16 v[240:241], v26 offset:4096
  ds_read_b64_tr_b16 v[242:243], v26 offset:4608
  ds_read_b64_tr_b16 v[244:245], v26 offset:8192
  s_add_u32 m0, s53, 6144
  s_lshl_b32 s60, 9, s64
  buffer_load_dwordx4 v7, s[16:19], s60 offen lds
  ds_read_b64_tr_b16 v[246:247], v26 offset:8704
  ds_read_b64_tr_b16 v[248:249], v28 offset:12288
  s_add_u32 m0, s53, 14336
  s_lshl_b32 s60, 13, s64
  buffer_load_dwordx4 v7, s[16:19], s60 offen lds
  ds_read_b64_tr_b16 v[250:251], v28 offset:12544
  ds_read_b64_tr_b16 v[252:253], v28 offset:16384
  ds_read_b64_tr_b16 v[254:255], v28 offset:16640
  s_waitcnt lgkmcnt(10)
  v_mfma_f32_16x16x32_bf16 v[66:69], v[232:235], v[170:173], v[66:69]
  s_waitcnt lgkmcnt(8)
  v_mfma_f32_16x16x32_bf16 v[66:69], v[236:239], v[228:231], v[66:69]
  v_mfma_f32_16x16x32_bf16 v[62:65], v[236:239], v[224:227], v[62:65]
  v_mfma_f32_16x16x32_bf16 v[62:65], v[232:235], v[166:169], v[62:65]
  v_mfma_f32_16x16x32_bf16 v[58:61], v[232:235], v[162:165], v[58:61]
  v_mfma_f32_16x16x32_bf16 v[58:61], v[236:239], v[220:223], v[58:61]
  v_mfma_f32_16x16x32_bf16 v[54:57], v[236:239], v[216:219], v[54:57]
  v_mfma_f32_16x16x32_bf16 v[54:57], v[232:235], v[158:161], v[54:57]
  v_smfmac_f32_16x16x64_bf16 v[122:125], v[34:37], v[232:239], v32
  s_waitcnt lgkmcnt(6)
  v_mfma_f32_16x16x32_bf16 v[86:89], v[240:243], v[158:161], v[86:89]
  s_waitcnt lgkmcnt(4)
  v_mfma_f32_16x16x32_bf16 v[86:89], v[244:247], v[216:219], v[86:89]
  v_mfma_f32_16x16x32_bf16 v[90:93], v[244:247], v[220:223], v[90:93]
  v_mfma_f32_16x16x32_bf16 v[90:93], v[240:243], v[162:165], v[90:93]
  v_mfma_f32_16x16x32_bf16 v[94:97], v[240:243], v[166:169], v[94:97]
  v_mfma_f32_16x16x32_bf16 v[94:97], v[244:247], v[224:227], v[94:97]
  v_mfma_f32_16x16x32_bf16 v[98:101], v[244:247], v[228:231], v[98:101]
  v_mfma_f32_16x16x32_bf16 v[98:101], v[240:243], v[170:173], v[98:101]
  v_smfmac_f32_16x16x64_bf16 v[130:133], v[34:37], v[240:247], v32
  s_waitcnt lgkmcnt(2)
  v_mfma_f32_16x16x32_bf16 v[114:117], v[248:251], v[170:173], v[114:117]
  s_waitcnt lgkmcnt(0)
  v_mfma_f32_16x16x32_bf16 v[114:117], v[252:255], v[228:231], v[114:117]
  v_mfma_f32_16x16x32_bf16 v[110:113], v[252:255], v[224:227], v[110:113]
  v_mfma_f32_16x16x32_bf16 v[110:113], v[248:251], v[166:169], v[110:113]
  v_mfma_f32_16x16x32_bf16 v[106:109], v[248:251], v[162:165], v[106:109]
  v_mfma_f32_16x16x32_bf16 v[106:109], v[252:255], v[220:223], v[106:109]
  v_mfma_f32_16x16x32_bf16 v[102:105], v[252:255], v[216:219], v[102:105]
  v_mfma_f32_16x16x32_bf16 v[102:105], v[248:251], v[158:161], v[102:105]
  v_smfmac_f32_16x16x64_bf16 v[134:137], v[34:37], v[248:255], v32
  s_waitcnt vmcnt(10)
  s_barrier
  ds_read_b64_tr_b16 v[232:233], v26 offset:20480
  ds_read_b64_tr_b16 v[234:235], v26 offset:20992
  s_add_u32 m0, s53, 114688
  s_lshl_b32 s60, 16, s64
  buffer_load_dwordx4 v7, s[16:19], s60 offen lds
  ds_read_b64_tr_b16 v[236:237], v26 offset:24576
  ds_read_b64_tr_b16 v[238:239], v26 offset:25088
  ds_read_b128 v[170:173], v23 offset:32768
  ds_read_b128 v[228:231], v24 offset:32768
  s_add_u32 m0, s53, 122880
  s_lshl_b32 s60, 20, s64
  buffer_load_dwordx4 v7, s[16:19], s60 offen lds
  ds_read_b128 v[166:169], v23 offset:30720
  ds_read_b128 v[224:227], v24 offset:30720
  ds_read_b128 v[162:165], v23 offset:28672
  ds_read_b128 v[220:223], v24 offset:28672
  ds_read_b128 v[158:161], v23 offset:26624
  s_add_u32 m0, s53, 131072
  s_lshl_b32 s60, 17, s64
  buffer_load_dwordx4 v7, s[16:19], s60 offen lds
  ds_read_b128 v[216:219], v24 offset:26624
  ds_read_b64_tr_b16 v[240:241], v26 offset:28672
  ds_read_b64_tr_b16 v[242:243], v26 offset:29184
  ds_read_b64_tr_b16 v[244:245], v26 offset:32768
  ds_read_b64_tr_b16 v[246:247], v26 offset:33280
  s_waitcnt lgkmcnt(11)
  v_mfma_f32_16x16x32_bf16 v[50:53], v[232:235], v[170:173], v[50:53]
  s_waitcnt lgkmcnt(10)
  v_mfma_f32_16x16x32_bf16 v[50:53], v[236:239], v[228:231], v[50:53]
  s_waitcnt lgkmcnt(8)
  v_mfma_f32_16x16x32_bf16 v[46:49], v[236:239], v[224:227], v[46:49]
  v_mfma_f32_16x16x32_bf16 v[46:49], v[232:235], v[166:169], v[46:49]
  s_waitcnt lgkmcnt(7)
  v_mfma_f32_16x16x32_bf16 v[42:45], v[232:235], v[162:165], v[42:45]
  s_waitcnt lgkmcnt(6)
  v_mfma_f32_16x16x32_bf16 v[42:45], v[236:239], v[220:223], v[42:45]
  s_waitcnt lgkmcnt(4)
  v_mfma_f32_16x16x32_bf16 v[38:41], v[236:239], v[216:219], v[38:41]
  v_mfma_f32_16x16x32_bf16 v[38:41], v[232:235], v[158:161], v[38:41]
  v_smfmac_f32_16x16x64_bf16 v[118:121], v[34:37], v[232:239], v32
  s_waitcnt lgkmcnt(2)
  v_mfma_f32_16x16x32_bf16 v[70:73], v[240:243], v[158:161], v[70:73]
  s_waitcnt lgkmcnt(0)
  v_mfma_f32_16x16x32_bf16 v[70:73], v[244:247], v[216:219], v[70:73]
  v_mfma_f32_16x16x32_bf16 v[74:77], v[244:247], v[220:223], v[74:77]
  v_mfma_f32_16x16x32_bf16 v[74:77], v[240:243], v[162:165], v[74:77]
  v_mfma_f32_16x16x32_bf16 v[78:81], v[240:243], v[166:169], v[78:81]
  v_mfma_f32_16x16x32_bf16 v[78:81], v[244:247], v[224:227], v[78:81]
  v_mfma_f32_16x16x32_bf16 v[82:85], v[244:247], v[228:231], v[82:85]
  v_mfma_f32_16x16x32_bf16 v[82:85], v[240:243], v[170:173], v[82:85]
  v_smfmac_f32_16x16x64_bf16 v[126:129], v[34:37], v[240:247], v32
  s_waitcnt vmcnt(11)
  s_barrier
  ds_read_b64_tr_b16 v[232:233], v26 offset:36864
  ds_read_b64_tr_b16 v[234:235], v26 offset:37376
  s_add_u32 m0, s53, 139264
  s_lshl_b32 s60, 21, s64
  buffer_load_dwordx4 v7, s[16:19], s60 offen lds
  ds_read_b64_tr_b16 v[236:237], v25 offset:0
  ds_read_b64_tr_b16 v[238:239], v25 offset:512
  s_add_u32 m0, s53, 22528
  s_lshl_b32 s60, 24, s64
  buffer_load_dwordx4 v7, s[16:19], s60 offen lds
  ds_read_b64_tr_b16 v[240:241], v25 offset:4096
  ds_read_b64_tr_b16 v[242:243], v25 offset:4608
  ds_read_b64_tr_b16 v[244:245], v25 offset:8192
  s_add_u32 m0, s53, 30720
  s_lshl_b32 s60, 28, s64
  buffer_load_dwordx4 v7, s[16:19], s60 offen lds
  ds_read_b64_tr_b16 v[246:247], v25 offset:8704
  ds_read_b64_tr_b16 v[248:249], v27 offset:12288
  s_add_u32 m0, s53, 147456
  s_lshl_b32 s60, 25, s64
  buffer_load_dwordx4 v7, s[16:19], s60 offen lds
  ds_read_b64_tr_b16 v[250:251], v27 offset:12544
  ds_read_b64_tr_b16 v[252:253], v27 offset:16384
  ds_read_b64_tr_b16 v[254:255], v27 offset:16640
  s_waitcnt lgkmcnt(10)
  v_mfma_f32_16x16x32_bf16 v[66:69], v[232:235], v[170:173], v[66:69]
  s_waitcnt lgkmcnt(8)
  v_mfma_f32_16x16x32_bf16 v[66:69], v[236:239], v[228:231], v[66:69]
  v_mfma_f32_16x16x32_bf16 v[62:65], v[236:239], v[224:227], v[62:65]
  v_mfma_f32_16x16x32_bf16 v[62:65], v[232:235], v[166:169], v[62:65]
  v_mfma_f32_16x16x32_bf16 v[58:61], v[232:235], v[162:165], v[58:61]
  v_mfma_f32_16x16x32_bf16 v[58:61], v[236:239], v[220:223], v[58:61]
  v_mfma_f32_16x16x32_bf16 v[54:57], v[236:239], v[216:219], v[54:57]
  v_mfma_f32_16x16x32_bf16 v[54:57], v[232:235], v[158:161], v[54:57]
  v_smfmac_f32_16x16x64_bf16 v[122:125], v[34:37], v[232:239], v32
  s_waitcnt lgkmcnt(4)
  v_smfmac_f32_16x16x64_bf16 v[130:133], v[34:37], v[240:247], v32
  s_waitcnt lgkmcnt(0)
  v_smfmac_f32_16x16x64_bf16 v[134:137], v[34:37], v[248:255], v32
  v_mfma_f32_16x16x32_bf16 v[86:89], v[240:243], v[158:161], v[86:89]
  v_mfma_f32_16x16x32_bf16 v[86:89], v[244:247], v[216:219], v[86:89]
  v_mfma_f32_16x16x32_bf16 v[90:93], v[244:247], v[220:223], v[90:93]
  v_mfma_f32_16x16x32_bf16 v[90:93], v[240:243], v[162:165], v[90:93]
  v_mfma_f32_16x16x32_bf16 v[94:97], v[240:243], v[166:169], v[94:97]
  v_mfma_f32_16x16x32_bf16 v[94:97], v[244:247], v[224:227], v[94:97]
  v_mfma_f32_16x16x32_bf16 v[98:101], v[244:247], v[228:231], v[98:101]
L_B0w1:
  s_cbranch_execz L_B0r
  s_nop 0
  v_mfma_f32_16x16x32_bf16 v[98:101], v[240:243], v[170:173], v[98:101]
  v_mfma_f32_16x16x32_bf16 v[114:117], v[248:251], v[170:173], v[114:117]
  v_mfma_f32_16x16x32_bf16 v[114:117], v[252:255], v[228:231], v[114:117]
  v_mfma_f32_16x16x32_bf16 v[110:113], v[252:255], v[224:227], v[110:113]
  v_mfma_f32_16x16x32_bf16 v[110:113], v[248:251], v[166:169], v[110:113]
  v_mfma_f32_16x16x32_bf16 v[106:109], v[248:251], v[162:165], v[106:109]
  v_add_f32 v118, v118, v119
  v_add_f32 v122, v122, v123
  v_mfma_f32_16x16x32_bf16 v[106:109], v[252:255], v[220:223], v[106:109]
  v_add_f32 v126, v126, v127
  v_add_f32 v130, v130, v131
  v_mfma_f32_16x16x32_bf16 v[102:105], v[252:255], v[216:219], v[102:105]
  v_add_f32_e64 v134, v134, v135
  v_mfma_f32_16x16x32_bf16 v[102:105], v[248:251], v[158:161], v[102:105]
  s_barrier
  ds_write_b32 v5, v118 offset:4608
  ds_write_b32 v5, v122 offset:4864
  ds_write_b32 v5, v126 offset:5120
  ds_write_b32 v5, v130 offset:5376
  ds_write_b32 v5, v134 offset:5632
  ds_read_b128 v[118:121], v3 offset:4608
  ds_read_b128 v[126:129], v3 offset:5120
  s_add_u32 m0, s53, 155648
  s_lshl_b32 s60, 29, s64
  buffer_load_dwordx4 v7, s[16:19], s60 offen lds
  ds_read_b128 v[122:125], v3 offset:4864
  s_add_u32 m0, s53, 151552
  s_lshl_b32 s60, 32, s64
  buffer_load_dwordx4 v7, s[16:19], s60 offen lds
  ds_read_b128 v[130:133], v3 offset:5376
  ds_read_b128 v[134:137], v3 offset:5632
  s_add_u32 m0, s53, 159744
  s_lshl_b32 s60, 36, s64
  buffer_load_dwordx4 v7, s[16:19], s60 offen lds
  ds_read_b128 v[142:145], v30 offset:256
  ds_read_b128 v[18:21], v30 offset:512
  s_add_u32 m0, s53, 59392
  s_lshl_b32 s60, 33, s64
  buffer_load_dwordx4 v7, s[16:19], s60 offen lds
  ds_read_b128 v[22:25], v30 offset:768
  ds_read_b128 v[180:183], v30 offset:1024
  s_waitcnt lgkmcnt(4)
  s_barrier
  s_setprio 3
  ds_read_b128 v[172:175], v4 offset:256
  ds_read_b128 v[176:179], v4 offset:512
  s_waitcnt lgkmcnt(5)
  v_pk_fma_f32 v[38:39], v[142:143], v[118:119], v[38:39] op_sel_hi:[0,1,1] neg_lo:[1,0,0] neg_hi:[1,0,0]
  v_pk_fma_f32 v[40:41], v[142:143], v[120:121], v[40:41] op_sel_hi:[0,1,1] neg_lo:[1,0,0] neg_hi:[1,0,0]
  v_pk_fma_f32 v[70:71], v[142:143], v[126:127], v[70:71] op_sel_hi:[0,1,1] neg_lo:[1,0,0] neg_hi:[1,0,0]
  v_pk_fma_f32 v[72:73], v[142:143], v[128:129], v[72:73] op_sel_hi:[0,1,1] neg_lo:[1,0,0] neg_hi:[1,0,0]
  v_pk_mul_f32 v[138:139], v[38:39], v[144:145] op_sel_hi:[1,0]
  v_pk_mul_f32 v[140:141], v[40:41], v[144:145] op_sel_hi:[1,0]
  v_exp_f32 v138, v138
  v_exp_f32 v139, v139
  v_exp_f32 v140, v140
  v_exp_f32_e64 v141, v141
  v_pk_mul_f32 v[38:39], v[38:39], v[70:71]
  v_pk_mul_f32 v[40:41], v[40:41], v[72:73]
  v_pk_fma_f32 v[138:139], v[144:145], v[138:139], v[144:145] op_sel:[1,0,1]
  v_pk_fma_f32 v[140:141], v[144:145], v[140:141], v[144:145] op_sel:[1,0,1]
  v_rcp_f32 v138, v138
  v_rcp_f32 v139, v139
  v_rcp_f32 v140, v140
  v_rcp_f32 v141, v141
  v_pk_mul_f32 v[38:39], v[38:39], v[138:139]
  v_pk_mul_f32 v[40:41], v[40:41], v[140:141]
  v_cvt_pk_bf16_f32 v70, v38, v39
  v_cvt_pk_bf16_f32 v71, v40, v41
  s_waitcnt lgkmcnt(4)
  v_pk_fma_f32 v[42:43], v[18:19], v[118:119], v[42:43] op_sel_hi:[0,1,1] neg_lo:[1,0,0] neg_hi:[1,0,0]
  v_pk_fma_f32 v[44:45], v[18:19], v[120:121], v[44:45] op_sel_hi:[0,1,1] neg_lo:[1,0,0] neg_hi:[1,0,0]
  v_pk_fma_f32 v[74:75], v[18:19], v[126:127], v[74:75] op_sel_hi:[0,1,1] neg_lo:[1,0,0] neg_hi:[1,0,0]
  v_pk_fma_f32 v[76:77], v[18:19], v[128:129], v[76:77] op_sel_hi:[0,1,1] neg_lo:[1,0,0] neg_hi:[1,0,0]
  v_pk_mul_f32 v[138:139], v[42:43], v[20:21] op_sel_hi:[1,0]
  v_pk_mul_f32 v[140:141], v[44:45], v[20:21] op_sel_hi:[1,0]
  s_add_u32 m0, s53, 67584
  s_lshl_b32 s60, 37, s64
  buffer_load_dwordx4 v7, s[16:19], s60 offen lds
  v_exp_f32 v138, v138
  v_exp_f32 v139, v139
  v_exp_f32 v140, v140
  v_exp_f32 v141, v141
  v_pk_mul_f32 v[42:43], v[42:43], v[74:75]
  v_pk_mul_f32 v[44:45], v[44:45], v[76:77]
  v_pk_fma_f32 v[138:139], v[20:21], v[138:139], v[20:21] op_sel:[1,0,1]
  v_pk_fma_f32 v[140:141], v[20:21], v[140:141], v[20:21] op_sel:[1,0,1]
  v_rcp_f32 v138, v138
  v_rcp_f32 v139, v139
  v_rcp_f32 v140, v140
  v_rcp_f32 v141, v141
  v_pk_mul_f32 v[42:43], v[42:43], v[138:139]
  v_pk_mul_f32 v[44:45], v[44:45], v[140:141]
  v_cvt_pk_bf16_f32 v72, v42, v43
  v_cvt_pk_bf16_f32 v73, v44, v45
  s_nop 0
  v_permlane16_swap_b32 v70, v72
  v_permlane16_swap_b32_e64 v71, v73
  buffer_store_dwordx4 v[70:73], v2, s[40:43], s55 offen sc1
  s_waitcnt lgkmcnt(3)
  v_pk_fma_f32 v[46:47], v[22:23], v[118:119], v[46:47] op_sel_hi:[0,1,1] neg_lo:[1,0,0] neg_hi:[1,0,0]
  v_pk_fma_f32 v[48:49], v[22:23], v[120:121], v[48:49] op_sel_hi:[0,1,1] neg_lo:[1,0,0] neg_hi:[1,0,0]
  v_pk_fma_f32 v[78:79], v[22:23], v[126:127], v[78:79] op_sel_hi:[0,1,1] neg_lo:[1,0,0] neg_hi:[1,0,0]
  v_pk_fma_f32 v[80:81], v[22:23], v[128:129], v[80:81] op_sel_hi:[0,1,1] neg_lo:[1,0,0] neg_hi:[1,0,0]
  v_pk_mul_f32 v[138:139], v[46:47], v[24:25] op_sel_hi:[1,0]
  v_pk_mul_f32 v[140:141], v[48:49], v[24:25] op_sel_hi:[1,0]
  v_exp_f32 v138, v138
  v_exp_f32 v139, v139
  v_exp_f32 v140, v140
  v_exp_f32_e64 v141, v141
  v_pk_mul_f32 v[46:47], v[46:47], v[78:79]
  v_pk_mul_f32 v[48:49], v[48:49], v[80:81]
  v_pk_fma_f32 v[138:139], v[24:25], v[138:139], v[24:25] op_sel:[1,0,1]
  v_pk_fma_f32 v[140:141], v[24:25], v[140:141], v[24:25] op_sel:[1,0,1]
  v_rcp_f32 v138, v138
  v_rcp_f32 v139, v139
  v_rcp_f32 v140, v140
  v_rcp_f32 v141, v141
  v_pk_mul_f32 v[46:47], v[46:47], v[138:139]
  v_pk_mul_f32 v[48:49], v[48:49], v[140:141]
  v_cvt_pk_bf16_f32 v78, v46, v47
  v_cvt_pk_bf16_f32 v79, v48, v49
  s_waitcnt lgkmcnt(2)
  v_pk_fma_f32 v[50:51], v[180:181], v[118:119], v[50:51] op_sel_hi:[0,1,1] neg_lo:[1,0,0] neg_hi:[1,0,0]
  v_pk_fma_f32 v[52:53], v[180:181], v[120:121], v[52:53] op_sel_hi:[0,1,1] neg_lo:[1,0,0] neg_hi:[1,0,0]
  v_pk_fma_f32 v[82:83], v[180:181], v[126:127], v[82:83] op_sel_hi:[0,1,1] neg_lo:[1,0,0] neg_hi:[1,0,0]
  v_pk_fma_f32 v[84:85], v[180:181], v[128:129], v[84:85] op_sel_hi:[0,1,1] neg_lo:[1,0,0] neg_hi:[1,0,0]
  v_pk_mul_f32 v[138:139], v[50:51], v[182:183] op_sel_hi:[1,0]
  v_pk_mul_f32 v[140:141], v[52:53], v[182:183] op_sel_hi:[1,0]
  v_exp_f32 v138, v138
  v_exp_f32 v139, v139
  v_exp_f32 v140, v140
  v_exp_f32_e64 v141, v141
  v_pk_mul_f32 v[50:51], v[50:51], v[82:83]
  v_pk_mul_f32 v[52:53], v[52:53], v[84:85]
  v_pk_fma_f32 v[138:139], v[182:183], v[138:139], v[182:183] op_sel:[1,0,1]
  v_pk_fma_f32 v[140:141], v[182:183], v[140:141], v[182:183] op_sel:[1,0,1]
  v_rcp_f32 v138, v138
  v_rcp_f32 v139, v139
  v_rcp_f32 v140, v140
  v_rcp_f32 v141, v141
  v_pk_mul_f32 v[50:51], v[50:51], v[138:139]
  v_pk_mul_f32 v[52:53], v[52:53], v[140:141]
  v_cvt_pk_bf16_f32 v80, v50, v51
  v_cvt_pk_bf16_f32 v81, v52, v53
  s_nop 0
  v_permlane16_swap_b32 v78, v80
  v_permlane16_swap_b32_e64 v79, v81
  buffer_store_dwordx4 v[78:81], v2, s[40:43], s56 offen sc1
  v_pk_fma_f32 v[54:55], v[142:143], v[122:123], v[54:55] op_sel_hi:[0,1,1] neg_lo:[1,0,0] neg_hi:[1,0,0]
  v_pk_fma_f32 v[56:57], v[142:143], v[124:125], v[56:57] op_sel_hi:[0,1,1] neg_lo:[1,0,0] neg_hi:[1,0,0]
  v_pk_fma_f32 v[86:87], v[142:143], v[130:131], v[86:87] op_sel_hi:[0,1,1] neg_lo:[1,0,0] neg_hi:[1,0,0]
  v_pk_fma_f32 v[88:89], v[142:143], v[132:133], v[88:89] op_sel_hi:[0,1,1] neg_lo:[1,0,0] neg_hi:[1,0,0]
  v_pk_mul_f32 v[138:139], v[54:55], v[144:145] op_sel_hi:[1,0]
  v_pk_mul_f32 v[140:141], v[56:57], v[144:145] op_sel_hi:[1,0]
  v_exp_f32 v138, v138
  v_exp_f32 v139, v139
  v_exp_f32 v140, v140
  v_exp_f32 v141, v141
  v_pk_mul_f32 v[54:55], v[54:55], v[86:87]
  v_pk_mul_f32 v[56:57], v[56:57], v[88:89]
  v_pk_fma_f32 v[138:139], v[144:145], v[138:139], v[144:145] op_sel:[1,0,1]
  v_pk_fma_f32 v[140:141], v[144:145], v[140:141], v[144:145] op_sel:[1,0,1]
  v_rcp_f32 v138, v138
  v_rcp_f32 v139, v139
  v_rcp_f32 v140, v140
  v_rcp_f32 v141, v141
  v_pk_mul_f32 v[54:55], v[54:55], v[138:139]
  v_pk_mul_f32 v[56:57], v[56:57], v[140:141]
  v_cvt_pk_bf16_f32 v86, v54, v55
  v_cvt_pk_bf16_f32 v87, v56, v57
  v_pk_fma_f32 v[58:59], v[18:19], v[122:123], v[58:59] op_sel_hi:[0,1,1] neg_lo:[1,0,0] neg_hi:[1,0,0]
  v_pk_fma_f32 v[60:61], v[18:19], v[124:125], v[60:61] op_sel_hi:[0,1,1] neg_lo:[1,0,0] neg_hi:[1,0,0]
  v_pk_fma_f32 v[90:91], v[18:19], v[130:131], v[90:91] op_sel_hi:[0,1,1] neg_lo:[1,0,0] neg_hi:[1,0,0]
  v_pk_fma_f32 v[92:93], v[18:19], v[132:133], v[92:93] op_sel_hi:[0,1,1] neg_lo:[1,0,0] neg_hi:[1,0,0]
  v_pk_mul_f32 v[138:139], v[58:59], v[20:21] op_sel_hi:[1,0]
  v_pk_mul_f32 v[140:141], v[60:61], v[20:21] op_sel_hi:[1,0]
  v_exp_f32 v138, v138
  v_exp_f32 v139, v139
  v_exp_f32 v140, v140
  v_exp_f32 v141, v141
  v_pk_mul_f32 v[58:59], v[58:59], v[90:91]
  v_pk_mul_f32 v[60:61], v[60:61], v[92:93]
  v_pk_fma_f32 v[138:139], v[20:21], v[138:139], v[20:21] op_sel:[1,0,1]
  v_pk_fma_f32 v[140:141], v[20:21], v[140:141], v[20:21] op_sel:[1,0,1]
  v_rcp_f32 v138, v138
  v_rcp_f32 v139, v139
  v_rcp_f32 v140, v140
  v_rcp_f32 v141, v141
  v_pk_mul_f32 v[58:59], v[58:59], v[138:139]
  v_pk_mul_f32 v[60:61], v[60:61], v[140:141]
  v_cvt_pk_bf16_f32 v88, v58, v59
  v_cvt_pk_bf16_f32 v89, v60, v61
  s_nop 0
  v_permlane16_swap_b32 v86, v88
  v_permlane16_swap_b32_e64 v87, v89
  buffer_store_dwordx4 v[86:89], v2, s[40:43], s57 offen sc1
  v_pk_fma_f32 v[62:63], v[22:23], v[122:123], v[62:63] op_sel_hi:[0,1,1] neg_lo:[1,0,0] neg_hi:[1,0,0]
  v_pk_fma_f32 v[64:65], v[22:23], v[124:125], v[64:65] op_sel_hi:[0,1,1] neg_lo:[1,0,0] neg_hi:[1,0,0]
  v_pk_fma_f32 v[94:95], v[22:23], v[130:131], v[94:95] op_sel_hi:[0,1,1] neg_lo:[1,0,0] neg_hi:[1,0,0]
  v_pk_fma_f32 v[96:97], v[22:23], v[132:133], v[96:97] op_sel_hi:[0,1,1] neg_lo:[1,0,0] neg_hi:[1,0,0]
  v_pk_mul_f32 v[138:139], v[62:63], v[24:25] op_sel_hi:[1,0]
  v_pk_mul_f32 v[140:141], v[64:65], v[24:25] op_sel_hi:[1,0]
  v_exp_f32 v138, v138
  v_exp_f32 v139, v139
  v_exp_f32 v140, v140
  v_exp_f32 v141, v141
  v_pk_mul_f32 v[62:63], v[62:63], v[94:95]
  v_pk_mul_f32 v[64:65], v[64:65], v[96:97]
  v_pk_fma_f32 v[138:139], v[24:25], v[138:139], v[24:25] op_sel:[1,0,1]
  v_pk_fma_f32 v[140:141], v[24:25], v[140:141], v[24:25] op_sel:[1,0,1]
  v_rcp_f32 v138, v138
  v_rcp_f32 v139, v139
  v_rcp_f32 v140, v140
  v_rcp_f32 v141, v141
  v_pk_mul_f32 v[62:63], v[62:63], v[138:139]
  v_pk_mul_f32 v[64:65], v[64:65], v[140:141]
  v_cvt_pk_bf16_f32 v94, v62, v63
  v_cvt_pk_bf16_f32 v95, v64, v65
  v_pk_fma_f32 v[66:67], v[180:181], v[122:123], v[66:67] op_sel_hi:[0,1,1] neg_lo:[1,0,0] neg_hi:[1,0,0]
  v_pk_fma_f32 v[68:69], v[180:181], v[124:125], v[68:69] op_sel_hi:[0,1,1] neg_lo:[1,0,0] neg_hi:[1,0,0]
  v_pk_fma_f32 v[98:99], v[180:181], v[130:131], v[98:99] op_sel_hi:[0,1,1] neg_lo:[1,0,0] neg_hi:[1,0,0]
  v_pk_fma_f32 v[100:101], v[180:181], v[132:133], v[100:101] op_sel_hi:[0,1,1] neg_lo:[1,0,0] neg_hi:[1,0,0]
  v_pk_mul_f32 v[138:139], v[66:67], v[182:183] op_sel_hi:[1,0]
  v_pk_mul_f32 v[140:141], v[68:69], v[182:183] op_sel_hi:[1,0]
  v_exp_f32 v138, v138
  v_exp_f32 v139, v139
  v_exp_f32 v140, v140
  v_exp_f32 v141, v141
  v_pk_mul_f32 v[66:67], v[66:67], v[98:99]
  v_pk_mul_f32 v[68:69], v[68:69], v[100:101]
  v_pk_fma_f32 v[138:139], v[182:183], v[138:139], v[182:183] op_sel:[1,0,1]
  v_pk_fma_f32 v[140:141], v[182:183], v[140:141], v[182:183] op_sel:[1,0,1]
  v_rcp_f32 v138, v138
  v_rcp_f32 v139, v139
  v_rcp_f32 v140, v140
  v_rcp_f32 v141, v141
  v_pk_mul_f32 v[66:67], v[66:67], v[138:139]
  v_pk_mul_f32 v[68:69], v[68:69], v[140:141]
  v_cvt_pk_bf16_f32 v96, v66, v67
  v_cvt_pk_bf16_f32 v97, v68, v69
  s_nop 0
  v_permlane16_swap_b32 v94, v96
  v_permlane16_swap_b32_e64 v95, v97
  buffer_store_dwordx4 v[94:97], v2, s[40:43], s58 offen sc1
  v_pk_fma_f32 v[102:103], v[142:143], v[134:135], v[102:103] op_sel_hi:[0,1,1] neg_lo:[1,0,0] neg_hi:[1,0,0]
  v_pk_fma_f32 v[104:105], v[142:143], v[136:137], v[104:105] op_sel_hi:[0,1,1] neg_lo:[1,0,0] neg_hi:[1,0,0]
  v_pk_fma_f32 v[106:107], v[18:19], v[134:135], v[106:107] op_sel_hi:[0,1,1] neg_lo:[1,0,0] neg_hi:[1,0,0]
  v_pk_fma_f32 v[108:109], v[18:19], v[136:137], v[108:109] op_sel_hi:[0,1,1] neg_lo:[1,0,0] neg_hi:[1,0,0]
  v_pk_fma_f32 v[110:111], v[22:23], v[134:135], v[110:111] op_sel_hi:[0,1,1] neg_lo:[1,0,0] neg_hi:[1,0,0]
  v_pk_fma_f32 v[112:113], v[22:23], v[136:137], v[112:113] op_sel_hi:[0,1,1] neg_lo:[1,0,0] neg_hi:[1,0,0]
  v_pk_fma_f32 v[114:115], v[180:181], v[134:135], v[114:115] op_sel_hi:[0,1,1] neg_lo:[1,0,0] neg_hi:[1,0,0]
  v_pk_fma_f32 v[116:117], v[180:181], v[136:137], v[116:117] op_sel_hi:[0,1,1] neg_lo:[1,0,0] neg_hi:[1,0,0]
  v_permlane32_swap_b32 v102, v110
  v_permlane32_swap_b32 v103, v111
  v_permlane32_swap_b32 v104, v112
  v_permlane32_swap_b32 v105, v113
  v_permlane32_swap_b32 v106, v114
  v_permlane32_swap_b32 v107, v115
  v_permlane32_swap_b32 v108, v116
  v_permlane32_swap_b32_e64 v109, v117
  s_waitcnt lgkmcnt(1)
  v_pk_mul_f32 v[138:139], v[102:103], v[174:175] op_sel_hi:[1,0]
  v_pk_mul_f32 v[140:141], v[104:105], v[174:175] op_sel_hi:[1,0]
  v_exp_f32 v138, v138
  v_exp_f32 v139, v139
  v_exp_f32 v140, v140
  v_exp_f32 v141, v141
  v_pk_mul_f32 v[102:103], v[102:103], v[110:111]
  v_pk_mul_f32 v[104:105], v[104:105], v[112:113]
  v_pk_fma_f32 v[138:139], v[174:175], v[138:139], v[174:175] op_sel:[1,0,1]
  v_pk_fma_f32 v[140:141], v[174:175], v[140:141], v[174:175] op_sel:[1,0,1]
  v_rcp_f32 v138, v138
  v_rcp_f32 v139, v139
  v_rcp_f32 v140, v140
  v_rcp_f32 v141, v141
  v_pk_mul_f32 v[102:103], v[102:103], v[138:139]
  v_pk_mul_f32 v[104:105], v[104:105], v[140:141]
  v_cvt_pk_bf16_f32 v164, v102, v103
  v_cvt_pk_bf16_f32 v165, v104, v105
  s_waitcnt lgkmcnt(0)
  v_pk_mul_f32 v[138:139], v[106:107], v[178:179] op_sel_hi:[1,0]
  v_pk_mul_f32 v[140:141], v[108:109], v[178:179] op_sel_hi:[1,0]
  v_exp_f32 v138, v138
  v_exp_f32 v139, v139
  v_exp_f32 v140, v140
  v_exp_f32_e64 v141, v141
  v_pk_mul_f32 v[106:107], v[106:107], v[114:115]
  v_pk_mul_f32 v[108:109], v[108:109], v[116:117]
  v_pk_fma_f32 v[138:139], v[178:179], v[138:139], v[178:179] op_sel:[1,0,1]
  v_pk_fma_f32 v[140:141], v[178:179], v[140:141], v[178:179] op_sel:[1,0,1]
  v_rcp_f32 v138, v138
  v_rcp_f32 v139, v139
  v_rcp_f32 v140, v140
  v_rcp_f32 v141, v141
  v_pk_mul_f32 v[106:107], v[106:107], v[138:139]
  v_pk_mul_f32 v[108:109], v[108:109], v[140:141]
  v_cvt_pk_bf16_f32 v166, v106, v107
  v_cvt_pk_bf16_f32 v167, v108, v109
  s_nop 0
  v_permlane16_swap_b32 v164, v166
  v_permlane16_swap_b32_e64 v165, v167
  buffer_store_dwordx4 v[164:167], v10, s[40:43], s59 offen sc1
  s_waitcnt vmcnt(23)
  ds_read_b64_tr_b16 v[216:217], v12 offset:43008
  ds_read_b64_tr_b16 v[220:221], v13 offset:43008
  ds_read_b64_tr_b16 v[224:225], v14 offset:43008
  ds_read_b64_tr_b16 v[228:229], v15 offset:43008
  s_waitcnt vmcnt(21)
  ds_read_b64_tr_b16 v[218:219], v212 offset:0
  ds_read_b64_tr_b16 v[222:223], v213 offset:0
  ds_read_b64_tr_b16 v[226:227], v214 offset:0
  ds_read_b64_tr_b16 v[230:231], v215 offset:0
  s_waitcnt vmcnt(19)
  ds_read_b64_tr_b16 v[232:233], v212 offset:16384
  ds_read_b64_tr_b16 v[236:237], v213 offset:16384
  ds_read_b64_tr_b16 v[240:241], v214 offset:16384
  ds_read_b64_tr_b16 v[244:245], v215 offset:16384
  s_waitcnt vmcnt(17)
  ds_read_b64_tr_b16 v[234:235], v12 offset:6144
  ds_read_b64_tr_b16 v[238:239], v13 offset:6144
  ds_read_b64_tr_b16 v[242:243], v14 offset:6144
  ds_read_b64_tr_b16 v[246:247], v15 offset:6144
  s_waitcnt vmcnt(15)
  ds_read_b64_tr_b16 v[248:249], v212 offset:32768
  ds_read_b64_tr_b16 v[252:253], v213 offset:32768
  ds_read_b64_tr_b16 v[200:201], v214 offset:32768
  ds_read_b64_tr_b16 v[204:205], v215 offset:32768
  s_waitcnt vmcnt(13)
  ds_read_b64_tr_b16 v[250:251], v212 offset:49152
  ds_read_b64_tr_b16 v[254:255], v213 offset:49152
  ds_read_b64_tr_b16 v[202:203], v214 offset:49152
  ds_read_b64_tr_b16 v[206:207], v215 offset:49152
  s_waitcnt vmcnt(11)
  ds_read_b64_tr_b16 v[208:209], v12 offset:22528
  ds_read_b64_tr_b16 v[192:193], v13 offset:22528
  ds_read_b64_tr_b16 v[188:189], v14 offset:22528
  ds_read_b64_tr_b16 v[184:185], v15 offset:22528
  s_waitcnt vmcnt(9)
  ds_read_b64_tr_b16 v[210:211], v196 offset:0
  ds_read_b64_tr_b16 v[194:195], v197 offset:0
  ds_read_b64_tr_b16 v[190:191], v198 offset:0
  ds_read_b64_tr_b16 v[186:187], v199 offset:0
  s_waitcnt vmcnt(7)
  ds_read_b64_tr_b16 v[180:181], v196 offset:4096
  ds_read_b64_tr_b16 v[176:177], v197 offset:4096
  ds_read_b64_tr_b16 v[172:173], v198 offset:4096
  ds_read_b64_tr_b16 v[168:169], v199 offset:4096
  s_waitcnt vmcnt(5)
  ds_read_b64_tr_b16 v[182:183], v12 offset:59392
  ds_read_b64_tr_b16 v[178:179], v13 offset:59392
  ds_read_b64_tr_b16 v[174:175], v14 offset:59392
  ds_read_b64_tr_b16 v[170:171], v15 offset:59392
  buffer_load_dwordx2 v[20:21], v8, s[20:23], 0 offen
  buffer_load_dwordx2 v[22:23], v11, s[20:23], 0 offen
  s_waitcnt lgkmcnt(14)
  s_lshl_b32 s60, s5, s64
  v_add_u32_e64 v7, s60, v7
  s_add_u32 m0, s53, 43008
  s_lshl_b32 s60, 0, s64
  buffer_load_dwordx4 v7, s[16:19], s60 offen lds
  s_add_u32 m0, s53, 51200
  s_lshl_b32 s60, 4, s64
  buffer_load_dwordx4 v7, s[16:19], s60 offen lds
  s_add_u32 m0, s53, 81920
  s_lshl_b32 s60, 1, s64
  buffer_load_dwordx4 v7, s[16:19], s60 offen lds
  s_add_u32 m0, s53, 90112
  s_lshl_b32 s60, 5, s64
  buffer_load_dwordx4 v7, s[16:19], s60 offen lds
  s_add_u32 m0, s53, 98304
  s_lshl_b32 s60, 8, s64
  buffer_load_dwordx4 v7, s[16:19], s60 offen lds
  s_add_u32 m0, s53, 106496
  s_lshl_b32 s60, 12, s64
  buffer_load_dwordx4 v7, s[16:19], s60 offen lds
  s_waitcnt vmcnt(8)
  s_mov_b64 exec, 1
  ds_add_rtn_u32 v3, v1, v6 offset:5888
  s_waitcnt lgkmcnt(0)
  v_readfirstlane_b32 s66, v3
  s_mov_b64 exec, -1
  s_xor_b32 s66, s66, 3
  s_lshl_b32 s66, s66, 24
  v_add_u32 v3, s66, v33
  buffer_store_dword v6, v3, s[40:43], 0 offen sc1
  s_setprio 0
  s_add_u32 m0, s53, 6144
  s_lshl_b32 s60, 9, s64
  buffer_load_dwordx4 v7, s[16:19], s60 offen lds
  s_add_u32 m0, s53, 14336
  s_lshl_b32 s60, 13, s64
  buffer_load_dwordx4 v7, s[16:19], s60 offen lds
  s_add_u32 m0, s53, 114688
  s_lshl_b32 s60, 16, s64
  buffer_load_dwordx4 v7, s[16:19], s60 offen lds
  s_add_u32 m0, s53, 122880
  s_lshl_b32 s60, 20, s64
  buffer_load_dwordx4 v7, s[16:19], s60 offen lds
  s_add_u32 m0, s53, 131072
  s_lshl_b32 s60, 17, s64
  buffer_load_dwordx4 v7, s[16:19], s60 offen lds
  s_add_u32 m0, s53, 139264
  s_lshl_b32 s60, 21, s64
  buffer_load_dwordx4 v7, s[16:19], s60 offen lds
  s_add_u32 m0, s53, 22528
  s_lshl_b32 s60, 24, s64
  buffer_load_dwordx4 v7, s[16:19], s60 offen lds
  s_add_u32 m0, s53, 30720
  s_lshl_b32 s60, 28, s64
  buffer_load_dwordx4 v7, s[16:19], s60 offen lds
  s_add_u32 m0, s53, 147456
  s_lshl_b32 s60, 25, s64
  buffer_load_dwordx4 v7, s[16:19], s60 offen lds
  s_add_u32 m0, s53, 155648
  s_lshl_b32 s60, 29, s64
  buffer_load_dwordx4 v7, s[16:19], s60 offen lds
  s_buffer_load_dwordx2 s[28:29], s[40:43], s65 offset:0 glc
  s_add_u32 m0, s53, 151552
  s_lshl_b32 s60, 32, s64
  buffer_load_dwordx4 v7, s[16:19], s60 offen lds
  s_add_u32 m0, s53, 159744
  s_lshl_b32 s60, 36, s64
  buffer_load_dwordx4 v7, s[16:19], s60 offen lds
  s_add_u32 m0, s53, 59392
  s_lshl_b32 s60, 33, s64
  buffer_load_dwordx4 v7, s[16:19], s60 offen lds
  s_add_u32 m0, s53, 67584
  s_lshl_b32 s60, 37, s64
  buffer_load_dwordx4 v7, s[16:19], s60 offen lds
  s_branch L_P0
.p2align 12
L_B1:
  s_mov_b32 s34, 0x1c0000
  s_mov_b32 s35, 0x20000
  v_bitop3_b32 v5, v5, v0, 3 bitop3:0x28
  v_lshl_add_u32 v5, v5, 4, s59
  v_bfe_u32 v4, v0, 2, 4
  v_and_or_b32 v4, v190, 16, v4
  v_mad_u32_u24 v22, v4, s68, v5
  s_bitcmp1_b32 s45, 0
  s_cselect_b64 s[32:33], s[14:15], s[12:13]
  s_setprio 2
  s_mov_b32 s48, 0
  s_mov_b32 s49, 0
  v_lshlrev_b32 v2, 4, v1
  s_cmp_eq_u32 s45, 0
  s_cselect_b64 s[6:7], s[6:7], s[12:13]
  s_cmp_eq_u32 s45, 2
  s_cselect_b64 s[6:7], s[14:15], s[6:7]
  s_add_u32 m0, s52, 86016
  s_mov_b32 s48, 0
  buffer_load_dwordx4 v21, s[28:31], s48 offen lds
  v_and_b32 v11, 15, v1
  v_lshrrev_b32_e64 v4, 4, v1
  v_bfe_u32 v190, v1, 1, 3
  v_xor_b32 v190, v190, v4
  v_lshlrev_b32 v190, 4, v190
  v_lshl_add_u32 v23, v11, 7, v190
  v_xor_b32_e64 v24, 64, v23
  v_bfe_u32 v190, v1, 3, 2
  v_xor_b32 v190, s45, v190
  v_lshlrev_b32 v190, 5, v190
  v_lshl_add_u32 v190, v4, 10, v190
  v_bfe_u32 v191, v1, 2, 2
  v_lshl_add_u32 v190, v191, 7, v190
  v_and_b32_e64 v3, 3, v1
  v_lshl_add_u32 v190, v3, 3, v190
  v_add_u32 v25, 61440, v190
  v_add_u32 v26, 122880, v190
  v_bfe_u32 v190, v1, 4, 1
  v_and_b32 v3, 2, v1
  v_or_b32 v5, v190, v3
  v_xor_b32 v5, s45, v5
  v_lshlrev_b32 v5, 4, v5
  v_lshl_add_u32 v5, v3, 9, v5
  v_lshl_add_u32 v5, v190, 9, v5
  v_lshl_add_u32 v5, v191, 6, v5
  v_lshrrev_b32_e64 v190, 5, v1
  s_add_u32 m0, s52, 90112
  s_mov_b32 s48, 114688
  buffer_load_dwordx4 v21, s[28:31], s48 offen lds
  v_lshl_add_u32 v5, v190, 11, v5
  v_and_b32_e64 v190, 1, v1
  v_lshl_add_u32 v5, v190, 3, v5
  v_add_u32 v27, 61440, v5
  v_add_u32 v28, 122880, v5
  v_mov_b32 v34, 0x3f803f80
  v_mov_b32 v35, 0x3f803f80
  v_mov_b32 v36, 0x3f803f80
  v_mov_b32 v37, 0x3f803f80
  s_add_u32 s40, s38, 0
  s_addc_u32 s41, s39, 0
  s_mov_b64 s[12:13], s[18:19]
  s_mov_b32 s42, 0x970000
  s_mov_b32 s43, 0x20000
  s_mov_b32 s38, 0x100
  s_mov_b32 s39, 0x20000
  s_mov_b32 s10, 0x80000
  s_mov_b32 s11, 0x20000
  s_mov_b32 s18, 0x1c0000
  s_mov_b32 s19, 0x20000
  s_mov_b32 s14, 0x200000
  s_mov_b32 s15, 0x20000
  s_and_b32 s66, s2, 7
  s_bfe_u32 s67, s2, 0x20003
  s_lshl2_add_u32 s66, s66, s67
  s_lshr_b32 s60, s2, 5
  s_and_b32 s67, s66, 30
  s_add_u32 m0, s52, 94208
  s_mov_b32 s48, 0
  buffer_load_dwordx4 v22, s[32:35], s48 offen lds
  s_add_u32 s61, s66, s67
  s_lshl3_add_u32 s66, s66, s60
  s_lshl_b32 s66, s66, 9
  s_add_u32 s64, s66, 9437440
  s_lshl_b32 s66, s45, 28
  v_lshl_add_u32 v3, v1, 2, s66
  v_mov_b32 v188, 0
  v_mov_b32 v189, 0
  buffer_store_dword v188, v3, s[40:43], s64 offen sc1
  ds_write_b32 v188, v188 offset:5892
  ds_write_b32 v188, v188 offset:5896
  s_bitcmp1_b32 s45, 1
  s_cselect_b64 s[8:9], s[16:17], s[8:9]
  s_cselect_b32 s10, s18, s10
  s_cselect_b32 s67, 7, 2
  s_cselect_b32 s5, 512, 0
  v_lshrrev_b32 v3, 3, v1
  v_cmp_gt_u32 vcc, s67, v3
  s_mul_i32 s67, s67, s2
  v_add_u32 v3, s67, v3
  v_and_b32 v4, 0x70, v2
  v_lshl_add_u32 v178, v3, 10, v4
  v_add_u32_e64 v3, s5, v3
  v_lshl_add_u32 v179, v3, 7, v4
  s_bitcmp1_b32 s45, 0
  s_cselect_b64 vcc, 0, vcc
  v_mov_b32_e64 v4, 1073741824
  v_add_u32 v179, 9601024, v179
  v_cndmask_b32 v178, v4, v178, vcc
  v_cndmask_b32 v179, v4, v179, vcc
  s_and_b32 s67, s47, 3
  s_add_u32 m0, s52, 98304
  s_mov_b32 s48, 114688
  buffer_load_dwordx4 v22, s[32:35], s48 offen lds
  s_lshl_b32 s67, s67, 6
  s_add_u32 s67, s67, 256
  v_subrev_u32 v176, s67, v0
  s_lshl_b32 s67, s46, 4
  v_lshl_add_u32 v176, v176, 22, s67
  v_mov_b32_e64 v6, 1
  s_or_b32 s67, s2, 0
  s_cmp_eq_u32 s45, 0
  s_cselect_b32 s66, 6, 7
  s_mul_i32 s67, s67, 3
  s_add_u32 s67, s67, 768
  s_mul_i32 s67, s67, s66
  s_mul_i32 s66, s66, 3
  s_sub_u32 s66, s66, 1
  s_cmp_eq_u32 s45, 3
  s_cselect_b32 s66, 0, s66
  v_min_u32 v209, s66, v1
  v_add_lshl_u32 v209, v209, s67, 7
  s_mov_b64 exec, 0
  s_branch L_P1wB
L_B1r:
  s_mov_b64 exec, -1
  s_waitcnt vmcnt(5)
  v_lshlrev_b32_e64 v200, 16, v184
  v_and_b32 v201, 0xffff0000, v184
  v_lshlrev_b32_e64 v202, 16, v185
  v_and_b32 v203, 0xffff0000, v185
  v_lshlrev_b32_e64 v204, 16, v186
  v_and_b32 v205, 0xffff0000, v186
  v_lshlrev_b32_e64 v206, 16, v187
  v_and_b32 v207, 0xffff0000, v187
  v_pk_add_f32 v[184:185], v[200:201], v[202:203]
  s_add_u32 m0, s53, 26496
  s_nop 0
  buffer_load_dwordx4 v18, s[20:23], s50 offen offset:128 lds
  v_pk_add_f32 v[186:187], v[204:205], v[206:207]
  v_pk_add_f32 v[184:185], v[184:185], v[186:187]
  v_add_f32 v188, v184, v185
  s_add_u32 s63, s63, s53
  s_lshr_b32 s63, s63, 6
  v_add_f32_dpp v188, v188, v188 row_ror:8 row_mask:0xf bank_mask:0xf
  s_nop 1
  v_add_f32_dpp v188, v188, v188 row_ror:4 row_mask:0xf bank_mask:0xf
  s_nop 1
  v_add_f32_dpp v188, v188, v188 row_ror:2 row_mask:0xf bank_mask:0xf
  s_nop 1
  v_add_f32_dpp v188, v188, v188 row_ror:1 row_mask:0xf bank_mask:0xf
  v_mov_b32 v191, v188
  s_nop 1
  v_permlane16_swap_b32 v188, v191
  v_add_f32 v188, v188, v191
  v_mov_b32 v191, v188
  s_nop 1
  v_permlane32_swap_b32 v188, v191
  v_add_f32_e64 v188, v188, v191
  v_mul_f32 v188, 0x3b000000, v188
  v_pk_add_f32 v[200:201], v[200:201], v[188:189] op_sel_hi:[1,0] neg_lo:[0,1] neg_hi:[0,1]
  v_pk_add_f32 v[202:203], v[202:203], v[188:189] op_sel_hi:[1,0] neg_lo:[0,1] neg_hi:[0,1]
  v_pk_add_f32 v[204:205], v[204:205], v[188:189] op_sel_hi:[1,0] neg_lo:[0,1] neg_hi:[0,1]
  v_pk_add_f32 v[206:207], v[206:207], v[188:189] op_sel_hi:[1,0] neg_lo:[0,1] neg_hi:[0,1]
  v_pk_mul_f32 v[184:185], v[200:201], v[200:201]
  v_pk_fma_f32 v[184:185], v[202:203], v[202:203], v[184:185]
  v_pk_fma_f32 v[184:185], v[204:205], v[204:205], v[184:185]
  v_pk_fma_f32 v[184:185], v[206:207], v[206:207], v[184:185]
  v_add_f32_e64 v189, v184, v185
  s_add_u32 s63, s63, 9568256
  s_add_u32 m0, s53, 34688
  s_nop 0
  buffer_load_dwordx4 v18, s[20:23], s51 offen offset:128 lds
  v_lshlrev_b32 v190, 24, v1
  v_add_f32_dpp v189, v189, v189 row_ror:8 row_mask:0xf bank_mask:0xf
  s_nop 1
  v_add_f32_dpp v189, v189, v189 row_ror:4 row_mask:0xf bank_mask:0xf
  s_nop 1
  v_add_f32_dpp v189, v189, v189 row_ror:2 row_mask:0xf bank_mask:0xf
  s_nop 1
  v_add_f32_dpp v189, v189, v189 row_ror:1 row_mask:0xf bank_mask:0xf
  v_mov_b32 v191, v189
  s_nop 1
  v_permlane16_swap_b32 v189, v191
  v_add_f32 v189, v189, v191
  v_mov_b32 v191, v189
  s_nop 1
  v_permlane32_swap_b32 v189, v191
  v_add_f32_e64 v189, v189, v191
  v_mul_f32 v189, 0x3b000000, v189
  v_cvt_pk_bf16_f32 v184, v188, v188
  v_and_b32 v184, 0xffff0000, v184
  v_cvt_pk_bf16_f32 v189, v189, v189
  v_and_b32 v189, 0xffff0000, v189
  v_add_f32 v189, 0x3727c5ac, v189
  v_cvt_pk_bf16_f32 v189, v189, v189
  v_and_b32 v189, 0xffff0000, v189
  v_sqrt_f32 v189, v189
  s_nop 0
  v_cvt_pk_bf16_f32 v189, v189, v189
  v_and_b32 v189, 0xffff0000, v189
  v_rcp_f32 v185, v189
  v_mul_f32 v187, v189, v189
  v_mul_f32 v186, 0xbfb8aa3b, v185
  buffer_store_dwordx4 v[184:187], v190, s[40:43], s63 offen sc1
  s_waitcnt lgkmcnt(0)
  s_barrier
  s_add_u32 m0, s52, 110592
  s_mov_b32 s48, 229376
  buffer_load_dwordx4 v20, s[24:27], s48 offen lds
  s_add_u32 m0, s52, 114688
  s_mov_b32 s48, 344064
  buffer_load_dwordx4 v20, s[24:27], s48 offen lds
  s_add_u32 m0, s52, 126976
  s_mov_b32 s48, 229376
  buffer_load_dwordx4 v21, s[28:31], s48 offen lds
  s_add_u32 m0, s52, 131072
  s_mov_b32 s48, 344064
  buffer_load_dwordx4 v21, s[28:31], s48 offen lds
  buffer_load_dwordx4 v[192:195], v178, s[8:11], 0 offen offset:384
  ds_read_b64_tr_b16 v[232:233], v25 offset:0
  ds_read_b64_tr_b16 v[234:235], v25 offset:512
  ds_read_b64_tr_b16 v[236:237], v25 offset:4096
  ds_read_b64_tr_b16 v[238:239], v25 offset:4608
  ds_read_b128 v[170:173], v23 offset:22528
  ds_read_b128 v[228:231], v24 offset:22528
  ds_read_b128 v[166:169], v23 offset:20480
  ds_read_b128 v[224:227], v24 offset:20480
  ds_read_b128 v[162:165], v23 offset:18432
  ds_read_b128 v[220:223], v24 offset:18432
  ds_read_b128 v[158:161], v23 offset:16384
  ds_read_b128 v[216:219], v24 offset:16384
  ds_read_b64_tr_b16 v[240:241], v25 offset:8192
  ds_read_b64_tr_b16 v[242:243], v25 offset:8704
  ds_read_b64_tr_b16 v[244:245], v25 offset:12288
  ds_read_b64_tr_b16 v[246:247], v25 offset:12800
  s_waitcnt lgkmcnt(0) vmcnt(8)
  s_barrier
  v_mfma_f32_16x16x32_bf16 v[50:53], v[232:235], v[170:173], 0
  v_mfma_f32_16x16x32_bf16 v[50:53], v[236:239], v[228:231], v[50:53]
  v_mfma_f32_16x16x32_bf16 v[46:49], v[236:239], v[224:227], 0
  v_mfma_f32_16x16x32_bf16 v[46:49], v[232:235], v[166:169], v[46:49]
  v_mfma_f32_16x16x32_bf16 v[42:45], v[232:235], v[162:165], 0
  v_mfma_f32_16x16x32_bf16 v[42:45], v[236:239], v[220:223], v[42:45]
  v_mfma_f32_16x16x32_bf16 v[38:41], v[236:239], v[216:219], 0
  v_mfma_f32_16x16x32_bf16 v[38:41], v[232:235], v[158:161], v[38:41]
  v_mfma_f32_16x16x32_bf16 v[70:73], v[240:243], v[158:161], 0
  v_mfma_f32_16x16x32_bf16 v[70:73], v[244:247], v[216:219], v[70:73]
  v_mfma_f32_16x16x32_bf16 v[74:77], v[244:247], v[220:223], 0
  v_mfma_f32_16x16x32_bf16 v[74:77], v[240:243], v[162:165], v[74:77]
  v_mfma_f32_16x16x32_bf16 v[78:81], v[240:243], v[166:169], 0
  v_mfma_f32_16x16x32_bf16 v[78:81], v[244:247], v[224:227], v[78:81]
  v_mfma_f32_16x16x32_bf16 v[82:85], v[244:247], v[228:231], 0
  v_mfma_f32_16x16x32_bf16 v[82:85], v[240:243], v[170:173], v[82:85]
  s_add_u32 m0, s52, 135168
  s_mov_b32 s48, 229376
  buffer_load_dwordx4 v22, s[32:35], s48 offen lds
  ds_read_b64_tr_b16 v[232:233], v25 offset:16384
  ds_read_b64_tr_b16 v[234:235], v25 offset:16896
  s_add_u32 m0, s52, 139264
  s_mov_b32 s48, 344064
  buffer_load_dwordx4 v22, s[32:35], s48 offen lds
  ds_read_b64_tr_b16 v[236:237], v25 offset:20480
  ds_read_b64_tr_b16 v[238:239], v25 offset:20992
  s_add_u32 m0, s53, 44800
  ds_read_b64_tr_b16 v[240:241], v25 offset:24576
  buffer_load_dwordx4 v18, s[20:23], s50 offen offset:256 lds
  ds_read_b64_tr_b16 v[242:243], v25 offset:25088
  ds_read_b64_tr_b16 v[244:245], v25 offset:28672
  s_add_u32 m0, s53, 52992
  ds_read_b64_tr_b16 v[246:247], v25 offset:29184
  buffer_load_dwordx4 v18, s[20:23], s51 offen offset:256 lds
  ds_read_b64_tr_b16 v[248:249], v27 offset:32768
  s_add_u32 m0, s52, 151552
  s_mov_b32 s48, 458752
  buffer_load_dwordx4 v20, s[24:27], s48 offen lds
  ds_read_b64_tr_b16 v[250:251], v27 offset:33024
  ds_read_b64_tr_b16 v[252:253], v27 offset:36864
  ds_read_b64_tr_b16 v[254:255], v27 offset:37120
  s_waitcnt lgkmcnt(0) vmcnt(8)
  s_barrier
  v_mfma_f32_16x16x32_bf16 v[66:69], v[232:235], v[170:173], 0
  v_mfma_f32_16x16x32_bf16 v[66:69], v[236:239], v[228:231], v[66:69]
  v_mfma_f32_16x16x32_bf16 v[62:65], v[236:239], v[224:227], 0
  v_mfma_f32_16x16x32_bf16 v[62:65], v[232:235], v[166:169], v[62:65]
  v_mfma_f32_16x16x32_bf16 v[58:61], v[232:235], v[162:165], 0
  v_mfma_f32_16x16x32_bf16 v[58:61], v[236:239], v[220:223], v[58:61]
  v_mfma_f32_16x16x32_bf16 v[54:57], v[236:239], v[216:219], 0
  v_mfma_f32_16x16x32_bf16 v[54:57], v[232:235], v[158:161], v[54:57]
  v_mfma_f32_16x16x32_bf16 v[86:89], v[240:243], v[158:161], 0
  v_mfma_f32_16x16x32_bf16 v[86:89], v[244:247], v[216:219], v[86:89]
  v_mfma_f32_16x16x32_bf16 v[90:93], v[244:247], v[220:223], 0
  v_mfma_f32_16x16x32_bf16 v[90:93], v[240:243], v[162:165], v[90:93]
  v_mfma_f32_16x16x32_bf16 v[94:97], v[240:243], v[166:169], 0
  v_mfma_f32_16x16x32_bf16 v[94:97], v[244:247], v[224:227], v[94:97]
  v_mfma_f32_16x16x32_bf16 v[98:101], v[244:247], v[228:231], 0
  v_mfma_f32_16x16x32_bf16 v[98:101], v[240:243], v[170:173], v[98:101]
  v_mfma_f32_16x16x32_bf16 v[114:117], v[248:251], v[170:173], 0
  v_mfma_f32_16x16x32_bf16 v[114:117], v[252:255], v[228:231], v[114:117]
  v_mfma_f32_16x16x32_bf16 v[110:113], v[252:255], v[224:227], 0
  v_mfma_f32_16x16x32_bf16 v[110:113], v[248:251], v[166:169], v[110:113]
  v_mfma_f32_16x16x32_bf16 v[106:109], v[248:251], v[162:165], 0
  v_mfma_f32_16x16x32_bf16 v[106:109], v[252:255], v[220:223], v[106:109]
  v_mfma_f32_16x16x32_bf16 v[102:105], v[252:255], v[216:219], 0
  v_mfma_f32_16x16x32_bf16 v[102:105], v[248:251], v[158:161], v[102:105]
  s_add_u32 m0, s52, 155648
  s_mov_b32 s48, 573440
  buffer_load_dwordx4 v20, s[24:27], s48 offen lds
  ds_read_b64_tr_b16 v[232:233], v25 offset:40960
  ds_read_b64_tr_b16 v[234:235], v25 offset:41472
  s_add_u32 m0, s52, 65536
  s_mov_b32 s48, 458752
  buffer_load_dwordx4 v21, s[28:31], s48 offen lds
  ds_read_b64_tr_b16 v[236:237], v25 offset:45056
  ds_read_b64_tr_b16 v[238:239], v25 offset:45568
  ds_read_b128 v[170:173], v23 offset:40960
  s_add_u32 m0, s52, 69632
  s_mov_b32 s48, 573440
  buffer_load_dwordx4 v21, s[28:31], s48 offen lds
  ds_read_b128 v[228:231], v24 offset:40960
  ds_read_b128 v[166:169], v23 offset:38912
  ds_read_b128 v[224:227], v24 offset:38912
  s_add_u32 m0, s52, 73728
  s_mov_b32 s48, 458752
  buffer_load_dwordx4 v22, s[32:35], s48 offen lds
  ds_read_b128 v[162:165], v23 offset:36864
  ds_read_b128 v[220:223], v24 offset:36864
  global_load_dword v177, v209, s[6:7]
  ds_read_b128 v[158:161], v23 offset:34816
  ds_read_b128 v[216:219], v24 offset:34816
  ds_read_b64_tr_b16 v[240:241], v25 offset:49152
  s_waitcnt vmcnt(10)
  buffer_store_dwordx4 v[192:195], v179, s[40:43], 0 offen sc1
  ds_read_b64_tr_b16 v[242:243], v25 offset:49664
  ds_read_b64_tr_b16 v[244:245], v25 offset:53248
  ds_read_b64_tr_b16 v[246:247], v25 offset:53760
  s_or_b32 s67, s2, 0
  s_sub_u32 s69, s45, 1
  s_cselect_b64 s[0:1], s[8:9], s[16:17]
  s_cselect_b32 s68, 16, 56
  s_cselect_b32 s69, 0, s69
  s_mul_i32 s69, s69, 19
  v_min_u32 v211, 18, v1
  v_add_u32 v211, s69, v211
  s_sub_u32 s69, s68, 1
  v_min_u32 v211, s69, v211
  s_mul_i32 s68, s68, s67
  v_and_b32 v3, 7, v211
  v_cmp_eq_u32 vcc, 3, v3
  v_add_lshl_u32 v211, v211, s68, 7
  v_xor_b32 v3, 128, v211
  v_cndmask_b32 v211, v211, v3, vcc
  s_lshl_b32 s66, s46, 13
  s_lshl2_add_u32 s66, s47, s66
  s_add_u32 s66, s66, 9437312
  v_lshl_add_u32 v33, v11, 9, s66
  v_lshrrev_b32 v3, 4, v1
  v_lshl_add_u32 v33, v3, 28, v33
  s_mul_i32 s66, s46, 589824
  s_add_u32 s66, s66, 294912
  s_mul_i32 s67, s47, 10240
  s_add_u32 s66, s66, s67
  s_add_u32 s66, s66, 0x8000
  s_bitcmp1_b32 s47, 0
  s_cselect_b32 s67, 2048, 0
  s_cselect_b32 s68, 0, 8192
  s_add_u32 s55, s66, s67
  s_add_u32 s55, s55, s52
  s_add_u32 s57, s55, 4096
  s_add_u32 s66, s66, s68
  s_lshl_b32 s67, s45, 9
  s_add_u32 s59, s66, s67
  s_add_u32 s56, s55, 147456
  s_add_u32 s58, s57, 147456
  s_and_b32 s67, s45, 1
  s_lshl4_add_u32 s65, s67, s64
  s_bitcmp1_b32 s45, 1
  s_cselect_b32 s67, 48, 0
  s_cselect_b32 s68, 32, 0
  s_lshl4_add_u32 s69, s45, s67
  s_add_u32 s68, s68, s69
  s_lshr_b32 s67, 255, s60
  s_and_b32 s67, s67, s61
  s_bitcmp1_b32 s67, 0
  s_cselect_b32 s66, 8, 0
  s_cselect_b32 s5, -8, 8
  s_add_u32 s69, s69, s66
  s_add_u32 s68, s68, s66
  s_lshl_b32 s5, s5, 2
  s_mul_i32 s66, s61, 144
  s_add_u32 s66, s66, s68
  s_lshl_b32 s66, s66, 10
  v_and_b32 v3, 0x300, v2
  v_add3_u32 v9, v3, v2, s66
  v_lshrrev_b32 v4, 3, v1
  v_and_b32_e64 v3, 6, v4
  v_bitop3_b32 v3, v3, v1, 7 bitop3:0x28
  v_lshlrev_b32 v3, 4, v3
  v_and_b32 v5, 4, v4
  v_add_u32_e64 v4, v4, v5
  s_lshl_b32 s60, s60, 7
  s_lshl_b32 s69, s69, 14
  s_add_u32 s69, s69, s60
  s_lshl_b32 s68, s68, 11
  s_add_u32 s68, s68, 9601024
  s_cmp_eq_u32 s60, 384
  s_cselect_b32 s69, s68, s69
  s_cselect_b32 s64, 9, 12
  s_cselect_b32 s67, 7, 10
  v_lshl_add_u32 v3, v4, s67, v3
  v_add_u32 v7, s69, v3
  v_lshrrev_b32 v3, 4, v0
  v_lshlrev_b32 v4, 3, v11
  v_lshl_add_u32 v3, v3, 10, v4
  s_lshl_b32 s66, s61, 15
  s_add_u32 s66, s66, s60
  v_add_u32 v8, s66, v3
  v_lshrrev_b32 v3, 5, v1
  v_lshl_add_u32 v3, v3, 13, s53
  v_bfe_u32 v4, v1, 2, 3
  v_lshl_add_u32 v3, v4, 7, v3
  v_bfe_u32 v4, v1, 3, 2
  v_lshl_add_u32 v3, v4, 5, v3
  v_and_b32_e64 v4, 3, v1
  v_lshl_add_u32 v12, v4, 3, v3
  v_xor_b32 v13, 32, v12
  v_xor_b32 v14, 64, v12
  v_xor_b32 v15, 96, v12
  v_add_u32 v212, 81920, v12
  v_add_u32 v213, 81920, v13
  v_add_u32 v214, 81920, v14
  v_add_u32 v215, 81920, v15
  s_lshl_b32 s66, s46, 11
  s_sub_u32 s66, s66, 256
  s_movk_i32 s67, 256
  s_add_u32 s66, s66, 9568256
  s_min_u32 s61, s52, 2048
  v_add_u32 v29, s61, v2
  v_subrev_u32 v3, s67, v29
  v_add_u32_e64 v29, s66, v29
  s_sub_u32 s67, 2304, s67
  v_cmp_gt_u32 vcc, s67, v3
  v_mov_b32 v4, 1073741824
  s_nop 0
  v_cndmask_b32 v29, v4, v29, vcc
  s_lshl_b32 s66, s45, 6
  v_lshlrev_b32 v30, 4, v11
  v_lshl_add_u32 v5, v11, 2, s66
  v_and_b32 v31, 0x30, v1
  v_add_u32 v3, s66, v31
  v_and_b32 v4, 0x200, v2
  v_add_u32 v4, v4, v30
  v_lshrrev_b32 v10, 5, v1
  v_mul_u32_u24 v10, 146944, v10
  v_add_u32 v10, v10, v2
  v_lshrrev_b32 v182, 3, v1
  v_and_b32 v182, 6, v182
  s_movk_i32 s66, 0x9c
  v_lshrrev_b32 v182, v182, s66
  v_lshrrev_b32_e64 v183, 2, v1
  v_bitop3_b32 v16, v182, v183, 3 bitop3:0x28
  v_lshrrev_b32 v183, 4, v0
  v_lshlrev_b32 v182, 2, v16
  v_sub_u32_e64 v182, v182, v183
  s_add_u32 s66, s45, 80
  v_add_u32_e64 v182, s66, v182
  v_lshl_add_u32 v11, v182, 10, v8
  s_waitcnt lgkmcnt(0) vmcnt(9)
  s_barrier
  v_mfma_f32_16x16x32_bf16 v[50:53], v[232:235], v[170:173], v[50:53]
  v_mfma_f32_16x16x32_bf16 v[50:53], v[236:239], v[228:231], v[50:53]
  v_mfma_f32_16x16x32_bf16 v[46:49], v[236:239], v[224:227], v[46:49]
  v_mfma_f32_16x16x32_bf16 v[46:49], v[232:235], v[166:169], v[46:49]
  v_mfma_f32_16x16x32_bf16 v[42:45], v[232:235], v[162:165], v[42:45]
  v_mfma_f32_16x16x32_bf16 v[42:45], v[236:239], v[220:223], v[42:45]
  v_mfma_f32_16x16x32_bf16 v[38:41], v[236:239], v[216:219], v[38:41]
  v_mfma_f32_16x16x32_bf16 v[38:41], v[232:235], v[158:161], v[38:41]
  v_mfma_f32_16x16x32_bf16 v[70:73], v[240:243], v[158:161], v[70:73]
  v_mfma_f32_16x16x32_bf16 v[70:73], v[244:247], v[216:219], v[70:73]
  v_mfma_f32_16x16x32_bf16 v[74:77], v[244:247], v[220:223], v[74:77]
  v_mfma_f32_16x16x32_bf16 v[74:77], v[240:243], v[162:165], v[74:77]
  v_mfma_f32_16x16x32_bf16 v[78:81], v[240:243], v[166:169], v[78:81]
  v_mfma_f32_16x16x32_bf16 v[78:81], v[244:247], v[224:227], v[78:81]
  v_mfma_f32_16x16x32_bf16 v[82:85], v[244:247], v[228:231], v[82:85]
  v_mfma_f32_16x16x32_bf16 v[82:85], v[240:243], v[170:173], v[82:85]
  s_add_u32 m0, s52, 77824
  s_mov_b32 s48, 573440
  buffer_load_dwordx4 v22, s[32:35], s48 offen lds
  ds_read_b64_tr_b16 v[232:233], v25 offset:57344
  ds_read_b64_tr_b16 v[234:235], v25 offset:57856
  s_add_u32 m0, s53, 7808
  ds_read_b64_tr_b16 v[236:237], v26 offset:0
  buffer_load_dwordx4 v18, s[20:23], s50 offen offset:384 lds
  ds_read_b64_tr_b16 v[238:239], v26 offset:512
  s_add_u32 m0, s53, 16000
  ds_read_b64_tr_b16 v[240:241], v26 offset:4096
  buffer_load_dwordx4 v18, s[20:23], s51 offen offset:384 lds
  ds_read_b64_tr_b16 v[242:243], v26 offset:4608
  ds_read_b64_tr_b16 v[244:245], v26 offset:8192
  s_add_u32 m0, s52, 90112
  s_mov_b32 s48, 688128
  buffer_load_dwordx4 v20, s[24:27], s48 offen lds
  ds_read_b64_tr_b16 v[246:247], v26 offset:8704
  ds_read_b64_tr_b16 v[248:249], v28 offset:12288
  s_add_u32 m0, s52, 94208
  s_mov_b32 s48, 802816
  buffer_load_dwordx4 v20, s[24:27], s48 offen lds
  ds_read_b64_tr_b16 v[250:251], v28 offset:12544
  ds_read_b64_tr_b16 v[252:253], v28 offset:16384
  ds_read_b64_tr_b16 v[254:255], v28 offset:16640
  s_waitcnt lgkmcnt(0) vmcnt(5)
  s_barrier
  v_mfma_f32_16x16x32_bf16 v[66:69], v[232:235], v[170:173], v[66:69]
  v_mfma_f32_16x16x32_bf16 v[66:69], v[236:239], v[228:231], v[66:69]
  v_mfma_f32_16x16x32_bf16 v[62:65], v[236:239], v[224:227], v[62:65]
  v_mfma_f32_16x16x32_bf16 v[62:65], v[232:235], v[166:169], v[62:65]
  v_mfma_f32_16x16x32_bf16 v[58:61], v[232:235], v[162:165], v[58:61]
  v_mfma_f32_16x16x32_bf16 v[58:61], v[236:239], v[220:223], v[58:61]
  v_mfma_f32_16x16x32_bf16 v[54:57], v[236:239], v[216:219], v[54:57]
  v_mfma_f32_16x16x32_bf16 v[54:57], v[232:235], v[158:161], v[54:57]
  v_mfma_f32_16x16x32_bf16 v[86:89], v[240:243], v[158:161], v[86:89]
  v_mfma_f32_16x16x32_bf16 v[86:89], v[244:247], v[216:219], v[86:89]
  v_mfma_f32_16x16x32_bf16 v[90:93], v[244:247], v[220:223], v[90:93]
  v_mfma_f32_16x16x32_bf16 v[90:93], v[240:243], v[162:165], v[90:93]
  v_mfma_f32_16x16x32_bf16 v[94:97], v[240:243], v[166:169], v[94:97]
  v_mfma_f32_16x16x32_bf16 v[94:97], v[244:247], v[224:227], v[94:97]
  v_mfma_f32_16x16x32_bf16 v[98:101], v[244:247], v[228:231], v[98:101]
  v_mfma_f32_16x16x32_bf16 v[98:101], v[240:243], v[170:173], v[98:101]
  v_mfma_f32_16x16x32_bf16 v[114:117], v[248:251], v[170:173], v[114:117]
  v_mfma_f32_16x16x32_bf16 v[114:117], v[252:255], v[228:231], v[114:117]
  v_mfma_f32_16x16x32_bf16 v[110:113], v[252:255], v[224:227], v[110:113]
  v_mfma_f32_16x16x32_bf16 v[110:113], v[248:251], v[166:169], v[110:113]
  v_mfma_f32_16x16x32_bf16 v[106:109], v[248:251], v[162:165], v[106:109]
  v_mfma_f32_16x16x32_bf16 v[106:109], v[252:255], v[220:223], v[106:109]
  v_mfma_f32_16x16x32_bf16 v[102:105], v[252:255], v[216:219], v[102:105]
  v_mfma_f32_16x16x32_bf16 v[102:105], v[248:251], v[158:161], v[102:105]
  s_add_u32 m0, s52, 106496
  s_mov_b32 s48, 688128
  buffer_load_dwordx4 v21, s[28:31], s48 offen lds
  ds_read_b64_tr_b16 v[232:233], v26 offset:20480
  ds_read_b64_tr_b16 v[234:235], v26 offset:20992
  ds_read_b64_tr_b16 v[236:237], v26 offset:24576
  s_add_u32 m0, s52, 110592
  s_mov_b32 s48, 802816
  buffer_load_dwordx4 v21, s[28:31], s48 offen lds
  ds_read_b64_tr_b16 v[238:239], v26 offset:25088
  ds_read_b128 v[170:173], v23 offset:59392
  ds_read_b128 v[228:231], v24 offset:59392
  s_add_u32 m0, s52, 114688
  s_mov_b32 s48, 688128
  buffer_load_dwordx4 v22, s[32:35], s48 offen lds
  ds_read_b128 v[166:169], v23 offset:57344
  ds_read_b128 v[224:227], v24 offset:57344
  ds_read_b128 v[162:165], v23 offset:55296
  s_add_u32 m0, s52, 118784
  s_mov_b32 s48, 802816
  buffer_load_dwordx4 v22, s[32:35], s48 offen lds
  ds_read_b128 v[220:223], v24 offset:55296
  ds_read_b128 v[158:161], v23 offset:53248
  ds_read_b128 v[216:219], v24 offset:53248
  s_and_b32 s3, s45, 1
  s_cmp_eq_u32 s3, 0
  s_cbranch_scc0 L_Ba4
  buffer_atomic_add v6, v176, s[36:39], 0 offen sc1
L_Ba4:
  ds_read_b64_tr_b16 v[240:241], v26 offset:28672
  ds_read_b64_tr_b16 v[242:243], v26 offset:29184
  ds_read_b64_tr_b16 v[244:245], v26 offset:32768
  ds_read_b64_tr_b16 v[246:247], v26 offset:33280
  s_waitcnt lgkmcnt(0) vmcnt(8)
  s_barrier
  v_mfma_f32_16x16x32_bf16 v[50:53], v[232:235], v[170:173], v[50:53]
  v_mfma_f32_16x16x32_bf16 v[50:53], v[236:239], v[228:231], v[50:53]
  v_mfma_f32_16x16x32_bf16 v[46:49], v[236:239], v[224:227], v[46:49]
  v_mfma_f32_16x16x32_bf16 v[46:49], v[232:235], v[166:169], v[46:49]
  v_mfma_f32_16x16x32_bf16 v[42:45], v[232:235], v[162:165], v[42:45]
  v_mfma_f32_16x16x32_bf16 v[42:45], v[236:239], v[220:223], v[42:45]
  v_mfma_f32_16x16x32_bf16 v[38:41], v[236:239], v[216:219], v[38:41]
  v_mfma_f32_16x16x32_bf16 v[38:41], v[232:235], v[158:161], v[38:41]
  v_mfma_f32_16x16x32_bf16 v[70:73], v[240:243], v[158:161], v[70:73]
  v_mfma_f32_16x16x32_bf16 v[70:73], v[244:247], v[216:219], v[70:73]
  v_mfma_f32_16x16x32_bf16 v[74:77], v[244:247], v[220:223], v[74:77]
  v_mfma_f32_16x16x32_bf16 v[74:77], v[240:243], v[162:165], v[74:77]
  v_mfma_f32_16x16x32_bf16 v[78:81], v[240:243], v[166:169], v[78:81]
  v_mfma_f32_16x16x32_bf16 v[78:81], v[244:247], v[224:227], v[78:81]
  v_mfma_f32_16x16x32_bf16 v[82:85], v[244:247], v[228:231], v[82:85]
  v_mfma_f32_16x16x32_bf16 v[82:85], v[240:243], v[170:173], v[82:85]
  s_add_u32 m0, s53, 26112
  ds_read_b64_tr_b16 v[232:233], v26 offset:36864
  buffer_load_dwordx4 v18, s[20:23], s50 offen offset:512 lds
  s_add_u32 m0, s53, 34304
  ds_read_b64_tr_b16 v[234:235], v26 offset:37376
  buffer_load_dwordx4 v18, s[20:23], s51 offen offset:512 lds
  ds_read_b64_tr_b16 v[236:237], v25 offset:0
  s_add_u32 m0, s52, 131072
  s_mov_b32 s48, 917504
  buffer_load_dwordx4 v20, s[24:27], s48 offen lds
  ds_read_b64_tr_b16 v[238:239], v25 offset:512
  ds_read_b64_tr_b16 v[240:241], v25 offset:4096
  s_add_u32 m0, s52, 135168
L_B1w0:
  s_cbranch_execz L_B1w1
  s_nop 0
  s_mov_b32 s48, 1032192
  buffer_load_dwordx4 v20, s[24:27], s48 offen lds
  ds_read_b64_tr_b16 v[242:243], v25 offset:4608
  s_add_u32 m0, s52, 147456
  s_mov_b32 s48, 917504
  buffer_load_dwordx4 v21, s[28:31], s48 offen lds
  ds_read_b64_tr_b16 v[244:245], v25 offset:8192
  ds_read_b64_tr_b16 v[246:247], v25 offset:8704
  s_add_u32 m0, s52, 151552
  s_mov_b32 s48, 1032192
  buffer_load_dwordx4 v21, s[28:31], s48 offen lds
  ds_read_b64_tr_b16 v[248:249], v27 offset:12288
  ds_read_b64_tr_b16 v[250:251], v27 offset:12544
  s_and_b32 s3, s45, 1
  s_cmp_eq_u32 s3, 1
  s_cbranch_scc0 L_Ba5
  buffer_atomic_add v6, v176, s[36:39], 0 offen sc1
L_Ba5:
  ds_read_b64_tr_b16 v[252:253], v27 offset:16384
  ds_read_b64_tr_b16 v[254:255], v27 offset:16640
  s_waitcnt lgkmcnt(0) vmcnt(10)
  s_barrier
  v_mfma_f32_16x16x32_bf16 v[66:69], v[232:235], v[170:173], v[66:69]
  v_mfma_f32_16x16x32_bf16 v[66:69], v[236:239], v[228:231], v[66:69]
  v_mfma_f32_16x16x32_bf16 v[62:65], v[236:239], v[224:227], v[62:65]
  v_mfma_f32_16x16x32_bf16 v[62:65], v[232:235], v[166:169], v[62:65]
  v_mfma_f32_16x16x32_bf16 v[58:61], v[232:235], v[162:165], v[58:61]
  v_mfma_f32_16x16x32_bf16 v[58:61], v[236:239], v[220:223], v[58:61]
  v_mfma_f32_16x16x32_bf16 v[54:57], v[236:239], v[216:219], v[54:57]
  v_mfma_f32_16x16x32_bf16 v[54:57], v[232:235], v[158:161], v[54:57]
  v_mfma_f32_16x16x32_bf16 v[86:89], v[240:243], v[158:161], v[86:89]
  v_mfma_f32_16x16x32_bf16 v[86:89], v[244:247], v[216:219], v[86:89]
  v_mfma_f32_16x16x32_bf16 v[90:93], v[244:247], v[220:223], v[90:93]
  v_mfma_f32_16x16x32_bf16 v[90:93], v[240:243], v[162:165], v[90:93]
  v_mfma_f32_16x16x32_bf16 v[94:97], v[240:243], v[166:169], v[94:97]
  v_mfma_f32_16x16x32_bf16 v[94:97], v[244:247], v[224:227], v[94:97]
  v_mfma_f32_16x16x32_bf16 v[98:101], v[244:247], v[228:231], v[98:101]
  v_mfma_f32_16x16x32_bf16 v[98:101], v[240:243], v[170:173], v[98:101]
  v_mfma_f32_16x16x32_bf16 v[114:117], v[248:251], v[170:173], v[114:117]
  v_mfma_f32_16x16x32_bf16 v[114:117], v[252:255], v[228:231], v[114:117]
  v_mfma_f32_16x16x32_bf16 v[110:113], v[252:255], v[224:227], v[110:113]
  v_mfma_f32_16x16x32_bf16 v[110:113], v[248:251], v[166:169], v[110:113]
  v_mfma_f32_16x16x32_bf16 v[106:109], v[248:251], v[162:165], v[106:109]
  v_mfma_f32_16x16x32_bf16 v[106:109], v[252:255], v[220:223], v[106:109]
  v_mfma_f32_16x16x32_bf16 v[102:105], v[252:255], v[216:219], v[102:105]
  v_mfma_f32_16x16x32_bf16 v[102:105], v[248:251], v[158:161], v[102:105]
  s_add_u32 m0, s52, 155648
  s_mov_b32 s48, 917504
  buffer_load_dwordx4 v22, s[32:35], s48 offen lds
  ds_read_b64_tr_b16 v[232:233], v25 offset:20480
  ds_read_b64_tr_b16 v[234:235], v25 offset:20992
  ds_read_b64_tr_b16 v[236:237], v25 offset:24576
  ds_read_b64_tr_b16 v[238:239], v25 offset:25088
  s_add_u32 m0, s52, 159744
  s_mov_b32 s48, 1032192
  buffer_load_dwordx4 v22, s[32:35], s48 offen lds
  ds_read_b128 v[170:173], v23 offset:22528
  ds_read_b128 v[228:231], v24 offset:22528
  ds_read_b128 v[166:169], v23 offset:20480
  ds_read_b128 v[224:227], v24 offset:20480
  s_add_u32 m0, s53, 44416
  ds_read_b128 v[162:165], v23 offset:18432
  buffer_load_dwordx4 v18, s[20:23], s50 offen offset:640 lds
  ds_read_b128 v[220:223], v24 offset:18432
  ds_read_b128 v[158:161], v23 offset:16384
  ds_read_b128 v[216:219], v24 offset:16384
  s_add_u32 m0, s53, 52608
  ds_read_b64_tr_b16 v[240:241], v25 offset:28672
  buffer_load_dwordx4 v18, s[20:23], s51 offen offset:640 lds
  ds_read_b64_tr_b16 v[242:243], v25 offset:29184
  ds_read_b64_tr_b16 v[244:245], v25 offset:32768
  ds_read_b64_tr_b16 v[246:247], v25 offset:33280
  s_waitcnt lgkmcnt(0) vmcnt(10)
  s_barrier
  v_mfma_f32_16x16x32_bf16 v[50:53], v[232:235], v[170:173], v[50:53]
  v_mfma_f32_16x16x32_bf16 v[50:53], v[236:239], v[228:231], v[50:53]
  v_mfma_f32_16x16x32_bf16 v[46:49], v[236:239], v[224:227], v[46:49]
  v_mfma_f32_16x16x32_bf16 v[46:49], v[232:235], v[166:169], v[46:49]
  v_mfma_f32_16x16x32_bf16 v[42:45], v[232:235], v[162:165], v[42:45]
  v_mfma_f32_16x16x32_bf16 v[42:45], v[236:239], v[220:223], v[42:45]
  v_mfma_f32_16x16x32_bf16 v[38:41], v[236:239], v[216:219], v[38:41]
  v_mfma_f32_16x16x32_bf16 v[38:41], v[232:235], v[158:161], v[38:41]
  v_mfma_f32_16x16x32_bf16 v[70:73], v[240:243], v[158:161], v[70:73]
  v_mfma_f32_16x16x32_bf16 v[70:73], v[244:247], v[216:219], v[70:73]
  v_mfma_f32_16x16x32_bf16 v[74:77], v[244:247], v[220:223], v[74:77]
  v_mfma_f32_16x16x32_bf16 v[74:77], v[240:243], v[162:165], v[74:77]
  v_mfma_f32_16x16x32_bf16 v[78:81], v[240:243], v[166:169], v[78:81]
  v_mfma_f32_16x16x32_bf16 v[78:81], v[244:247], v[224:227], v[78:81]
  v_mfma_f32_16x16x32_bf16 v[82:85], v[244:247], v[228:231], v[82:85]
  v_mfma_f32_16x16x32_bf16 v[82:85], v[240:243], v[170:173], v[82:85]
  s_add_u32 m0, s52, 69632
  s_mov_b32 s48, 1146880
  buffer_load_dwordx4 v20, s[24:27], s48 offen lds
  ds_read_b64_tr_b16 v[232:233], v25 offset:36864
  ds_read_b64_tr_b16 v[234:235], v25 offset:37376
  s_add_u32 m0, s52, 73728
  s_mov_b32 s48, 1261568
  buffer_load_dwordx4 v20, s[24:27], s48 offen lds
  ds_read_b64_tr_b16 v[236:237], v25 offset:40960
  ds_read_b64_tr_b16 v[238:239], v25 offset:41472
  s_add_u32 m0, s52, 86016
  s_mov_b32 s48, 1146880
  buffer_load_dwordx4 v21, s[28:31], s48 offen lds
  ds_read_b64_tr_b16 v[240:241], v25 offset:45056
  ds_read_b64_tr_b16 v[242:243], v25 offset:45568
  ds_read_b64_tr_b16 v[244:245], v25 offset:49152
  s_add_u32 m0, s52, 90112
  s_mov_b32 s48, 1261568
  buffer_load_dwordx4 v21, s[28:31], s48 offen lds
  ds_read_b64_tr_b16 v[246:247], v25 offset:49664
  ds_read_b64_tr_b16 v[248:249], v27 offset:53248
  s_add_u32 m0, s52, 94208
  s_mov_b32 s48, 1146880
  buffer_load_dwordx4 v22, s[32:35], s48 offen lds
  ds_read_b64_tr_b16 v[250:251], v27 offset:53504
  ds_read_b64_tr_b16 v[252:253], v27 offset:57344
  ds_read_b64_tr_b16 v[254:255], v27 offset:57600
  s_waitcnt lgkmcnt(0) vmcnt(11)
  s_barrier
  v_mfma_f32_16x16x32_bf16 v[66:69], v[232:235], v[170:173], v[66:69]
  v_mfma_f32_16x16x32_bf16 v[66:69], v[236:239], v[228:231], v[66:69]
  v_mfma_f32_16x16x32_bf16 v[62:65], v[236:239], v[224:227], v[62:65]
  v_mfma_f32_16x16x32_bf16 v[62:65], v[232:235], v[166:169], v[62:65]
  v_mfma_f32_16x16x32_bf16 v[58:61], v[232:235], v[162:165], v[58:61]
  v_mfma_f32_16x16x32_bf16 v[58:61], v[236:239], v[220:223], v[58:61]
  v_mfma_f32_16x16x32_bf16 v[54:57], v[236:239], v[216:219], v[54:57]
  v_mfma_f32_16x16x32_bf16 v[54:57], v[232:235], v[158:161], v[54:57]
  v_mfma_f32_16x16x32_bf16 v[86:89], v[240:243], v[158:161], v[86:89]
  v_mfma_f32_16x16x32_bf16 v[86:89], v[244:247], v[216:219], v[86:89]
  v_mfma_f32_16x16x32_bf16 v[90:93], v[244:247], v[220:223], v[90:93]
  v_mfma_f32_16x16x32_bf16 v[90:93], v[240:243], v[162:165], v[90:93]
  v_mfma_f32_16x16x32_bf16 v[94:97], v[240:243], v[166:169], v[94:97]
  v_mfma_f32_16x16x32_bf16 v[94:97], v[244:247], v[224:227], v[94:97]
  v_mfma_f32_16x16x32_bf16 v[98:101], v[244:247], v[228:231], v[98:101]
  v_mfma_f32_16x16x32_bf16 v[98:101], v[240:243], v[170:173], v[98:101]
  v_mfma_f32_16x16x32_bf16 v[114:117], v[248:251], v[170:173], v[114:117]
  v_mfma_f32_16x16x32_bf16 v[114:117], v[252:255], v[228:231], v[114:117]
  v_mfma_f32_16x16x32_bf16 v[110:113], v[252:255], v[224:227], v[110:113]
  v_mfma_f32_16x16x32_bf16 v[110:113], v[248:251], v[166:169], v[110:113]
  v_mfma_f32_16x16x32_bf16 v[106:109], v[248:251], v[162:165], v[106:109]
  v_mfma_f32_16x16x32_bf16 v[106:109], v[252:255], v[220:223], v[106:109]
  v_mfma_f32_16x16x32_bf16 v[102:105], v[252:255], v[216:219], v[102:105]
  v_mfma_f32_16x16x32_bf16 v[102:105], v[248:251], v[158:161], v[102:105]
  s_add_u32 m0, s52, 98304
  s_mov_b32 s48, 1261568
  buffer_load_dwordx4 v22, s[32:35], s48 offen lds
  ds_read_b64_tr_b16 v[232:233], v26 offset:0
  ds_read_b64_tr_b16 v[234:235], v26 offset:512
  ds_read_b64_tr_b16 v[236:237], v26 offset:4096
  s_add_u32 m0, s53, 7424
  ds_read_b64_tr_b16 v[238:239], v26 offset:4608
  buffer_load_dwordx4 v18, s[20:23], s50 offen offset:768 lds
  ds_read_b128 v[170:173], v23 offset:40960
  ds_read_b128 v[228:231], v24 offset:40960
  s_add_u32 m0, s53, 15616
  ds_read_b128 v[166:169], v23 offset:38912
  buffer_load_dwordx4 v18, s[20:23], s51 offen offset:768 lds
  ds_read_b128 v[224:227], v24 offset:38912
  ds_read_b128 v[162:165], v23 offset:36864
  s_add_u32 m0, s52, 110592
  s_mov_b32 s48, 1376256
  buffer_load_dwordx4 v20, s[24:27], s48 offen lds
  ds_read_b128 v[220:223], v24 offset:36864
  ds_read_b128 v[158:161], v23 offset:34816
  ds_read_b128 v[216:219], v24 offset:34816
  global_load_dword v177, v211, s[0:1]
  ds_read_b64_tr_b16 v[240:241], v26 offset:8192
  ds_read_b64_tr_b16 v[242:243], v26 offset:8704
  ds_read_b64_tr_b16 v[244:245], v26 offset:12288
  ds_read_b64_tr_b16 v[246:247], v26 offset:12800
  s_waitcnt lgkmcnt(0) vmcnt(12)
  s_barrier
  v_mfma_f32_16x16x32_bf16 v[50:53], v[232:235], v[170:173], v[50:53]
  v_mfma_f32_16x16x32_bf16 v[50:53], v[236:239], v[228:231], v[50:53]
  v_mfma_f32_16x16x32_bf16 v[46:49], v[236:239], v[224:227], v[46:49]
  v_mfma_f32_16x16x32_bf16 v[46:49], v[232:235], v[166:169], v[46:49]
  v_mfma_f32_16x16x32_bf16 v[42:45], v[232:235], v[162:165], v[42:45]
  v_mfma_f32_16x16x32_bf16 v[42:45], v[236:239], v[220:223], v[42:45]
  v_mfma_f32_16x16x32_bf16 v[38:41], v[236:239], v[216:219], v[38:41]
  v_mfma_f32_16x16x32_bf16 v[38:41], v[232:235], v[158:161], v[38:41]
  v_mfma_f32_16x16x32_bf16 v[70:73], v[240:243], v[158:161], v[70:73]
  v_mfma_f32_16x16x32_bf16 v[70:73], v[244:247], v[216:219], v[70:73]
  v_mfma_f32_16x16x32_bf16 v[74:77], v[244:247], v[220:223], v[74:77]
  v_mfma_f32_16x16x32_bf16 v[74:77], v[240:243], v[162:165], v[74:77]
  v_mfma_f32_16x16x32_bf16 v[78:81], v[240:243], v[166:169], v[78:81]
  v_mfma_f32_16x16x32_bf16 v[78:81], v[244:247], v[224:227], v[78:81]
  v_mfma_f32_16x16x32_bf16 v[82:85], v[244:247], v[228:231], v[82:85]
  v_mfma_f32_16x16x32_bf16 v[82:85], v[240:243], v[170:173], v[82:85]
  s_add_u32 m0, s52, 114688
  s_mov_b32 s48, 1490944
  buffer_load_dwordx4 v20, s[24:27], s48 offen lds
  ds_read_b64_tr_b16 v[232:233], v26 offset:16384
  ds_read_b64_tr_b16 v[234:235], v26 offset:16896
  ds_read_b64_tr_b16 v[236:237], v26 offset:20480
  s_add_u32 m0, s52, 126976
  s_mov_b32 s48, 1376256
  buffer_load_dwordx4 v21, s[28:31], s48 offen lds
  ds_read_b64_tr_b16 v[238:239], v26 offset:20992
  ds_read_b64_tr_b16 v[240:241], v26 offset:24576
  ds_read_b64_tr_b16 v[242:243], v26 offset:25088
  s_add_u32 m0, s52, 131072
  s_mov_b32 s48, 1490944
  buffer_load_dwordx4 v21, s[28:31], s48 offen lds
  ds_read_b64_tr_b16 v[244:245], v26 offset:28672
  ds_read_b64_tr_b16 v[246:247], v26 offset:29184
  ds_read_b64_tr_b16 v[248:249], v28 offset:32768
  s_add_u32 m0, s52, 135168
  s_mov_b32 s48, 1376256
  buffer_load_dwordx4 v22, s[32:35], s48 offen lds
  ds_read_b64_tr_b16 v[250:251], v28 offset:33024
  ds_read_b64_tr_b16 v[252:253], v28 offset:36864
  ds_read_b64_tr_b16 v[254:255], v28 offset:37120
  s_waitcnt lgkmcnt(0) vmcnt(12)
  s_barrier
  v_mfma_f32_16x16x32_bf16 v[66:69], v[232:235], v[170:173], v[66:69]
  v_mfma_f32_16x16x32_bf16 v[66:69], v[236:239], v[228:231], v[66:69]
  v_mfma_f32_16x16x32_bf16 v[62:65], v[236:239], v[224:227], v[62:65]
  v_mfma_f32_16x16x32_bf16 v[62:65], v[232:235], v[166:169], v[62:65]
  v_mfma_f32_16x16x32_bf16 v[58:61], v[232:235], v[162:165], v[58:61]
  v_mfma_f32_16x16x32_bf16 v[58:61], v[236:239], v[220:223], v[58:61]
  v_mfma_f32_16x16x32_bf16 v[54:57], v[236:239], v[216:219], v[54:57]
  v_mfma_f32_16x16x32_bf16 v[54:57], v[232:235], v[158:161], v[54:57]
  v_mfma_f32_16x16x32_bf16 v[86:89], v[240:243], v[158:161], v[86:89]
  v_mfma_f32_16x16x32_bf16 v[86:89], v[244:247], v[216:219], v[86:89]
  v_mfma_f32_16x16x32_bf16 v[90:93], v[244:247], v[220:223], v[90:93]
  v_mfma_f32_16x16x32_bf16 v[90:93], v[240:243], v[162:165], v[90:93]
  v_mfma_f32_16x16x32_bf16 v[94:97], v[240:243], v[166:169], v[94:97]
  v_mfma_f32_16x16x32_bf16 v[94:97], v[244:247], v[224:227], v[94:97]
  v_mfma_f32_16x16x32_bf16 v[98:101], v[244:247], v[228:231], v[98:101]
  v_mfma_f32_16x16x32_bf16 v[98:101], v[240:243], v[170:173], v[98:101]
  v_mfma_f32_16x16x32_bf16 v[114:117], v[248:251], v[170:173], v[114:117]
  v_mfma_f32_16x16x32_bf16 v[114:117], v[252:255], v[228:231], v[114:117]
  v_mfma_f32_16x16x32_bf16 v[110:113], v[252:255], v[224:227], v[110:113]
  v_mfma_f32_16x16x32_bf16 v[110:113], v[248:251], v[166:169], v[110:113]
  v_mfma_f32_16x16x32_bf16 v[106:109], v[248:251], v[162:165], v[106:109]
  v_mfma_f32_16x16x32_bf16 v[106:109], v[252:255], v[220:223], v[106:109]
  v_mfma_f32_16x16x32_bf16 v[102:105], v[252:255], v[216:219], v[102:105]
  v_mfma_f32_16x16x32_bf16 v[102:105], v[248:251], v[158:161], v[102:105]
  buffer_load_dword v174, v2, s[36:39], s52 offen sc1
  ds_read_b64_tr_b16 v[232:233], v25 offset:0
  ds_read_b64_tr_b16 v[234:235], v25 offset:512
  ds_read_b64_tr_b16 v[236:237], v25 offset:4096
  s_add_u32 m0, s52, 139264
  s_mov_b32 s48, 1490944
  buffer_load_dwordx4 v22, s[32:35], s48 offen lds
  ds_read_b64_tr_b16 v[238:239], v25 offset:4608
  ds_read_b128 v[170:173], v23 offset:59392
  ds_read_b128 v[228:231], v24 offset:59392
  s_add_u32 m0, s53, 25728
  ds_read_b128 v[166:169], v23 offset:57344
  buffer_load_dwordx4 v18, s[20:23], s50 offen offset:896 lds
  ds_read_b128 v[224:227], v24 offset:57344
  ds_read_b128 v[162:165], v23 offset:55296
  s_add_u32 m0, s53, 33920
  ds_read_b128 v[220:223], v24 offset:55296
  buffer_load_dwordx4 v18, s[20:23], s51 offen offset:896 lds
  ds_read_b128 v[158:161], v23 offset:53248
  ds_read_b128 v[216:219], v24 offset:53248
  s_add_u32 m0, s52, 151552
  s_mov_b32 s48, 1605632
  buffer_load_dwordx4 v20, s[24:27], s48 offen lds
  ds_read_b64_tr_b16 v[240:241], v25 offset:8192
  ds_read_b64_tr_b16 v[242:243], v25 offset:8704
  ds_read_b64_tr_b16 v[244:245], v25 offset:12288
  ds_read_b64_tr_b16 v[246:247], v25 offset:12800
  s_waitcnt lgkmcnt(0) vmcnt(13)
  s_barrier
  v_mfma_f32_16x16x32_bf16 v[50:53], v[232:235], v[170:173], v[50:53]
  v_mfma_f32_16x16x32_bf16 v[50:53], v[236:239], v[228:231], v[50:53]
  v_mfma_f32_16x16x32_bf16 v[46:49], v[236:239], v[224:227], v[46:49]
  v_mfma_f32_16x16x32_bf16 v[46:49], v[232:235], v[166:169], v[46:49]
  v_mfma_f32_16x16x32_bf16 v[42:45], v[232:235], v[162:165], v[42:45]
  v_mfma_f32_16x16x32_bf16 v[42:45], v[236:239], v[220:223], v[42:45]
  v_mfma_f32_16x16x32_bf16 v[38:41], v[236:239], v[216:219], v[38:41]
  v_mfma_f32_16x16x32_bf16 v[38:41], v[232:235], v[158:161], v[38:41]
  v_mfma_f32_16x16x32_bf16 v[70:73], v[240:243], v[158:161], v[70:73]
  v_mfma_f32_16x16x32_bf16 v[70:73], v[244:247], v[216:219], v[70:73]
  v_mfma_f32_16x16x32_bf16 v[74:77], v[244:247], v[220:223], v[74:77]
  v_mfma_f32_16x16x32_bf16 v[74:77], v[240:243], v[162:165], v[74:77]
  v_mfma_f32_16x16x32_bf16 v[78:81], v[240:243], v[166:169], v[78:81]
  v_mfma_f32_16x16x32_bf16 v[78:81], v[244:247], v[224:227], v[78:81]
  v_mfma_f32_16x16x32_bf16 v[82:85], v[244:247], v[228:231], v[82:85]
  v_mfma_f32_16x16x32_bf16 v[82:85], v[240:243], v[170:173], v[82:85]
  s_add_u32 m0, s52, 155648
  s_mov_b32 s48, 1720320
  buffer_load_dwordx4 v20, s[24:27], s48 offen lds
  ds_read_b64_tr_b16 v[232:233], v25 offset:16384
  ds_read_b64_tr_b16 v[234:235], v25 offset:16896
  ds_read_b64_tr_b16 v[236:237], v25 offset:20480
  s_add_u32 m0, s52, 65536
  s_mov_b32 s48, 1605632
  buffer_load_dwordx4 v21, s[28:31], s48 offen lds
  ds_read_b64_tr_b16 v[238:239], v25 offset:20992
  ds_read_b64_tr_b16 v[240:241], v25 offset:24576
  ds_read_b64_tr_b16 v[242:243], v25 offset:25088
  s_add_u32 m0, s52, 69632
  s_mov_b32 s48, 1720320
  buffer_load_dwordx4 v21, s[28:31], s48 offen lds
  ds_read_b64_tr_b16 v[244:245], v25 offset:28672
  ds_read_b64_tr_b16 v[246:247], v25 offset:29184
  ds_read_b64_tr_b16 v[248:249], v27 offset:32768
  s_add_u32 m0, s52, 73728
  s_mov_b32 s48, 1605632
  buffer_load_dwordx4 v22, s[32:35], s48 offen lds
  ds_read_b64_tr_b16 v[250:251], v27 offset:33024
  ds_read_b64_tr_b16 v[252:253], v27 offset:36864
  ds_read_b64_tr_b16 v[254:255], v27 offset:37120
  s_cmp_eq_u32 s45, 0
  s_cselect_b32 s67, 0xffff, 0
  s_waitcnt vmcnt(8)
  v_cmp_gt_u32 vcc, 16, v174
  s_nop 0
  s_and_b32 s66, vcc_lo, s67
  s_cbranch_scc0 L_Bck
  s_mov_b32 s68, 262144
L_Bcl:
  s_sleep 8
  buffer_load_dword v174, v2, s[36:39], s52 offen sc1
  s_sub_u32 s68, s68, 1
  s_waitcnt vmcnt(0)
  s_cbranch_scc1 L_Bck
  v_cmp_gt_u32 vcc, 16, v174
  s_nop 0
  s_and_b32 s66, vcc_lo, s67
  s_cbranch_scc1 L_Bcl
L_Bck:
  s_waitcnt lgkmcnt(0)
  s_barrier
  v_mfma_f32_16x16x32_bf16 v[66:69], v[232:235], v[170:173], v[66:69]
  v_mfma_f32_16x16x32_bf16 v[66:69], v[236:239], v[228:231], v[66:69]
  v_mfma_f32_16x16x32_bf16 v[62:65], v[236:239], v[224:227], v[62:65]
  v_mfma_f32_16x16x32_bf16 v[62:65], v[232:235], v[166:169], v[62:65]
  v_mfma_f32_16x16x32_bf16 v[58:61], v[232:235], v[162:165], v[58:61]
  v_mfma_f32_16x16x32_bf16 v[58:61], v[236:239], v[220:223], v[58:61]
  v_mfma_f32_16x16x32_bf16 v[54:57], v[236:239], v[216:219], v[54:57]
  v_mfma_f32_16x16x32_bf16 v[54:57], v[232:235], v[158:161], v[54:57]
  v_mfma_f32_16x16x32_bf16 v[86:89], v[240:243], v[158:161], v[86:89]
  v_mfma_f32_16x16x32_bf16 v[86:89], v[244:247], v[216:219], v[86:89]
  v_mfma_f32_16x16x32_bf16 v[90:93], v[244:247], v[220:223], v[90:93]
  v_mfma_f32_16x16x32_bf16 v[90:93], v[240:243], v[162:165], v[90:93]
  v_mfma_f32_16x16x32_bf16 v[94:97], v[240:243], v[166:169], v[94:97]
  v_mfma_f32_16x16x32_bf16 v[94:97], v[244:247], v[224:227], v[94:97]
  v_mfma_f32_16x16x32_bf16 v[98:101], v[244:247], v[228:231], v[98:101]
  v_mfma_f32_16x16x32_bf16 v[98:101], v[240:243], v[170:173], v[98:101]
  v_mfma_f32_16x16x32_bf16 v[114:117], v[248:251], v[170:173], v[114:117]
  v_mfma_f32_16x16x32_bf16 v[114:117], v[252:255], v[228:231], v[114:117]
  v_mfma_f32_16x16x32_bf16 v[110:113], v[252:255], v[224:227], v[110:113]
  v_mfma_f32_16x16x32_bf16 v[110:113], v[248:251], v[166:169], v[110:113]
  v_mfma_f32_16x16x32_bf16 v[106:109], v[248:251], v[162:165], v[106:109]
  v_mfma_f32_16x16x32_bf16 v[106:109], v[252:255], v[220:223], v[106:109]
  v_mfma_f32_16x16x32_bf16 v[102:105], v[252:255], v[216:219], v[102:105]
  v_mfma_f32_16x16x32_bf16 v[102:105], v[248:251], v[158:161], v[102:105]
  s_add_u32 m0, s52, 77824
  s_mov_b32 s48, 1720320
  buffer_load_dwordx4 v22, s[32:35], s48 offen lds
  ds_read_b64_tr_b16 v[232:233], v25 offset:40960
  ds_read_b64_tr_b16 v[234:235], v25 offset:41472
  ds_read_b64_tr_b16 v[236:237], v25 offset:45056
  ds_read_b64_tr_b16 v[238:239], v25 offset:45568
  s_cmp_eq_u32 s64, 9
  s_cselect_b64 s[8:9], s[40:41], s[8:9]
  s_cselect_b32 s10, s42, s10
  s_add_u32 m0, s53, 43008
  s_lshl_b32 s60, 0, s64
  buffer_load_dwordx4 v7, s[8:11], s60 offen lds
  ds_read_b128 v[170:173], v23 offset:22528
  ds_read_b128 v[228:231], v24 offset:22528
  ds_read_b128 v[166:169], v23 offset:20480
  ds_read_b128 v[224:227], v24 offset:20480
  s_add_u32 m0, s53, 51200
  s_lshl_b32 s60, 4, s64
  buffer_load_dwordx4 v7, s[8:11], s60 offen lds
  ds_read_b128 v[162:165], v23 offset:18432
  ds_read_b128 v[220:223], v24 offset:18432
  ds_read_b128 v[158:161], v23 offset:16384
  ds_read_b128 v[216:219], v24 offset:16384
  s_add_u32 m0, s53, 81920
  s_lshl_b32 s60, 1, s64
  buffer_load_dwordx4 v7, s[8:11], s60 offen lds
  ds_read_b64_tr_b16 v[240:241], v25 offset:49152
  ds_read_b64_tr_b16 v[242:243], v25 offset:49664
  ds_read_b64_tr_b16 v[244:245], v25 offset:53248
  ds_read_b64_tr_b16 v[246:247], v25 offset:53760
  s_waitcnt lgkmcnt(0) vmcnt(11)
  s_barrier
  v_mfma_f32_16x16x32_bf16 v[50:53], v[232:235], v[170:173], v[50:53]
  v_mfma_f32_16x16x32_bf16 v[50:53], v[236:239], v[228:231], v[50:53]
  v_mfma_f32_16x16x32_bf16 v[46:49], v[236:239], v[224:227], v[46:49]
  v_mfma_f32_16x16x32_bf16 v[46:49], v[232:235], v[166:169], v[46:49]
  v_mfma_f32_16x16x32_bf16 v[42:45], v[232:235], v[162:165], v[42:45]
  v_mfma_f32_16x16x32_bf16 v[42:45], v[236:239], v[220:223], v[42:45]
  v_mfma_f32_16x16x32_bf16 v[38:41], v[236:239], v[216:219], v[38:41]
  v_mfma_f32_16x16x32_bf16 v[38:41], v[232:235], v[158:161], v[38:41]
  v_mfma_f32_16x16x32_bf16 v[70:73], v[240:243], v[158:161], v[70:73]
  v_mfma_f32_16x16x32_bf16 v[70:73], v[244:247], v[216:219], v[70:73]
  v_mfma_f32_16x16x32_bf16 v[74:77], v[244:247], v[220:223], v[74:77]
  v_mfma_f32_16x16x32_bf16 v[74:77], v[240:243], v[162:165], v[74:77]
  v_mfma_f32_16x16x32_bf16 v[78:81], v[240:243], v[166:169], v[78:81]
  v_mfma_f32_16x16x32_bf16 v[78:81], v[244:247], v[224:227], v[78:81]
  v_mfma_f32_16x16x32_bf16 v[82:85], v[244:247], v[228:231], v[82:85]
  v_mfma_f32_16x16x32_bf16 v[82:85], v[240:243], v[170:173], v[82:85]
  s_add_u32 m0, s61, 0
  s_lshr_b32 s61, s61, 2
  buffer_load_dwordx4 v29, s[40:43], 0 offen sc1 lds
  ds_read_b64_tr_b16 v[232:233], v25 offset:57344
  ds_read_b64_tr_b16 v[234:235], v25 offset:57856
  s_add_u32 m0, s53, 90112
  s_lshl_b32 s60, 5, s64
  buffer_load_dwordx4 v7, s[8:11], s60 offen lds
  ds_read_b64_tr_b16 v[236:237], v26 offset:0
  ds_read_b64_tr_b16 v[238:239], v26 offset:512
  s_add_u32 m0, s53, 98304
  s_lshl_b32 s60, 8, s64
  buffer_load_dwordx4 v7, s[8:11], s60 offen lds
  ds_read_b64_tr_b16 v[240:241], v26 offset:4096
  ds_read_b64_tr_b16 v[242:243], v26 offset:4608
  s_add_u32 m0, s53, 106496
  s_lshl_b32 s60, 12, s64
  buffer_load_dwordx4 v7, s[8:11], s60 offen lds
  ds_read_b64_tr_b16 v[244:245], v26 offset:8192
  ds_read_b64_tr_b16 v[246:247], v26 offset:8704
  s_add_u32 m0, s53, 6144
  s_lshl_b32 s60, 9, s64
  buffer_load_dwordx4 v7, s[8:11], s60 offen lds
  ds_read_b64_tr_b16 v[248:249], v28 offset:12288
  ds_read_b64_tr_b16 v[250:251], v28 offset:12544
  s_add_u32 m0, s53, 14336
  s_lshl_b32 s60, 13, s64
  buffer_load_dwordx4 v7, s[8:11], s60 offen lds
  ds_read_b64_tr_b16 v[252:253], v28 offset:16384
  ds_read_b64_tr_b16 v[254:255], v28 offset:16640
  s_waitcnt lgkmcnt(0) vmcnt(13)
  s_barrier
  v_mfma_f32_16x16x32_bf16 v[66:69], v[232:235], v[170:173], v[66:69]
  v_mfma_f32_16x16x32_bf16 v[66:69], v[236:239], v[228:231], v[66:69]
  v_mfma_f32_16x16x32_bf16 v[62:65], v[236:239], v[224:227], v[62:65]
  v_mfma_f32_16x16x32_bf16 v[62:65], v[232:235], v[166:169], v[62:65]
  v_mfma_f32_16x16x32_bf16 v[58:61], v[232:235], v[162:165], v[58:61]
  v_mfma_f32_16x16x32_bf16 v[58:61], v[236:239], v[220:223], v[58:61]
  v_mfma_f32_16x16x32_bf16 v[54:57], v[236:239], v[216:219], v[54:57]
  v_mfma_f32_16x16x32_bf16 v[54:57], v[232:235], v[158:161], v[54:57]
  v_mfma_f32_16x16x32_bf16 v[86:89], v[240:243], v[158:161], v[86:89]
  v_mfma_f32_16x16x32_bf16 v[86:89], v[244:247], v[216:219], v[86:89]
  v_mfma_f32_16x16x32_bf16 v[90:93], v[244:247], v[220:223], v[90:93]
  v_mfma_f32_16x16x32_bf16 v[90:93], v[240:243], v[162:165], v[90:93]
  v_mfma_f32_16x16x32_bf16 v[94:97], v[240:243], v[166:169], v[94:97]
  v_mfma_f32_16x16x32_bf16 v[94:97], v[244:247], v[224:227], v[94:97]
  v_mfma_f32_16x16x32_bf16 v[98:101], v[244:247], v[228:231], v[98:101]
  v_mfma_f32_16x16x32_bf16 v[98:101], v[240:243], v[170:173], v[98:101]
  v_mfma_f32_16x16x32_bf16 v[114:117], v[248:251], v[170:173], v[114:117]
  v_mfma_f32_16x16x32_bf16 v[114:117], v[252:255], v[228:231], v[114:117]
  v_mfma_f32_16x16x32_bf16 v[110:113], v[252:255], v[224:227], v[110:113]
  v_mfma_f32_16x16x32_bf16 v[110:113], v[248:251], v[166:169], v[110:113]
  v_mfma_f32_16x16x32_bf16 v[106:109], v[248:251], v[162:165], v[106:109]
  v_mfma_f32_16x16x32_bf16 v[106:109], v[252:255], v[220:223], v[106:109]
  v_mfma_f32_16x16x32_bf16 v[102:105], v[252:255], v[216:219], v[102:105]
  v_mfma_f32_16x16x32_bf16 v[102:105], v[248:251], v[158:161], v[102:105]
  s_add_u32 m0, s53, 114688
  s_lshl_b32 s60, 16, s64
  buffer_load_dwordx4 v7, s[8:11], s60 offen lds
  ds_read_b64_tr_b16 v[232:233], v26 offset:20480
  ds_read_b64_tr_b16 v[234:235], v26 offset:20992
  ds_read_b64_tr_b16 v[236:237], v26 offset:24576
  ds_read_b64_tr_b16 v[238:239], v26 offset:25088
  ds_read_b128 v[170:173], v23 offset:40960
  s_add_u32 m0, s53, 122880
  s_lshl_b32 s60, 20, s64
  buffer_load_dwordx4 v7, s[8:11], s60 offen lds
  ds_read_b128 v[228:231], v24 offset:40960
  ds_read_b128 v[166:169], v23 offset:38912
  ds_read_b128 v[224:227], v24 offset:38912
  ds_read_b128 v[162:165], v23 offset:36864
  ds_read_b128 v[220:223], v24 offset:36864
  s_add_u32 m0, s53, 131072
  s_lshl_b32 s60, 17, s64
  buffer_load_dwordx4 v7, s[8:11], s60 offen lds
  ds_read_b128 v[158:161], v23 offset:34816
  ds_read_b128 v[216:219], v24 offset:34816
  ds_read_b64_tr_b16 v[240:241], v26 offset:28672
  ds_read_b64_tr_b16 v[242:243], v26 offset:29184
  ds_read_b64_tr_b16 v[244:245], v26 offset:32768
  ds_read_b64_tr_b16 v[246:247], v26 offset:33280
  s_waitcnt lgkmcnt(0) vmcnt(12)
  s_barrier
  v_mfma_f32_16x16x32_bf16 v[50:53], v[232:235], v[170:173], v[50:53]
  v_mfma_f32_16x16x32_bf16 v[50:53], v[236:239], v[228:231], v[50:53]
  v_mfma_f32_16x16x32_bf16 v[46:49], v[236:239], v[224:227], v[46:49]
  v_mfma_f32_16x16x32_bf16 v[46:49], v[232:235], v[166:169], v[46:49]
  v_mfma_f32_16x16x32_bf16 v[42:45], v[232:235], v[162:165], v[42:45]
  v_mfma_f32_16x16x32_bf16 v[42:45], v[236:239], v[220:223], v[42:45]
  v_mfma_f32_16x16x32_bf16 v[38:41], v[236:239], v[216:219], v[38:41]
  v_mfma_f32_16x16x32_bf16 v[38:41], v[232:235], v[158:161], v[38:41]
  v_mfma_f32_16x16x32_bf16 v[70:73], v[240:243], v[158:161], v[70:73]
  v_mfma_f32_16x16x32_bf16 v[70:73], v[244:247], v[216:219], v[70:73]
  v_mfma_f32_16x16x32_bf16 v[74:77], v[244:247], v[220:223], v[74:77]
  v_mfma_f32_16x16x32_bf16 v[74:77], v[240:243], v[162:165], v[74:77]
  v_mfma_f32_16x16x32_bf16 v[78:81], v[240:243], v[166:169], v[78:81]
  v_mfma_f32_16x16x32_bf16 v[78:81], v[244:247], v[224:227], v[78:81]
  v_mfma_f32_16x16x32_bf16 v[82:85], v[244:247], v[228:231], v[82:85]
  v_mfma_f32_16x16x32_bf16 v[82:85], v[240:243], v[170:173], v[82:85]
  s_add_u32 m0, s53, 139264
  s_lshl_b32 s60, 21, s64
  buffer_load_dwordx4 v7, s[8:11], s60 offen lds
  ds_read_b64_tr_b16 v[232:233], v26 offset:36864
  ds_read_b64_tr_b16 v[234:235], v26 offset:37376
  ds_read_b64_tr_b16 v[236:237], v25 offset:0
  ds_read_b64_tr_b16 v[238:239], v25 offset:512
  s_add_u32 m0, s53, 22528
  s_lshl_b32 s60, 24, s64
  buffer_load_dwordx4 v7, s[8:11], s60 offen lds
  ds_read_b64_tr_b16 v[240:241], v25 offset:4096
  ds_read_b64_tr_b16 v[242:243], v25 offset:4608
  ds_read_b64_tr_b16 v[244:245], v25 offset:8192
  ds_read_b64_tr_b16 v[246:247], v25 offset:8704
  s_add_u32 m0, s53, 30720
  s_lshl_b32 s60, 28, s64
  buffer_load_dwordx4 v7, s[8:11], s60 offen lds
  ds_read_b64_tr_b16 v[248:249], v27 offset:12288
  ds_read_b64_tr_b16 v[250:251], v27 offset:12544
  ds_read_b64_tr_b16 v[252:253], v27 offset:16384
  ds_read_b64_tr_b16 v[254:255], v27 offset:16640
  s_waitcnt lgkmcnt(0) vmcnt(11)
  s_barrier
  v_mfma_f32_16x16x32_bf16 v[66:69], v[232:235], v[170:173], v[66:69]
  v_mfma_f32_16x16x32_bf16 v[66:69], v[236:239], v[228:231], v[66:69]
  v_mfma_f32_16x16x32_bf16 v[62:65], v[236:239], v[224:227], v[62:65]
  v_mfma_f32_16x16x32_bf16 v[62:65], v[232:235], v[166:169], v[62:65]
  v_mfma_f32_16x16x32_bf16 v[58:61], v[232:235], v[162:165], v[58:61]
  v_mfma_f32_16x16x32_bf16 v[58:61], v[236:239], v[220:223], v[58:61]
  v_mfma_f32_16x16x32_bf16 v[54:57], v[236:239], v[216:219], v[54:57]
  v_mfma_f32_16x16x32_bf16 v[54:57], v[232:235], v[158:161], v[54:57]
  v_mfma_f32_16x16x32_bf16 v[86:89], v[240:243], v[158:161], v[86:89]
  v_mfma_f32_16x16x32_bf16 v[86:89], v[244:247], v[216:219], v[86:89]
  v_mfma_f32_16x16x32_bf16 v[90:93], v[244:247], v[220:223], v[90:93]
  v_mfma_f32_16x16x32_bf16 v[90:93], v[240:243], v[162:165], v[90:93]
  v_mfma_f32_16x16x32_bf16 v[94:97], v[240:243], v[166:169], v[94:97]
  v_mfma_f32_16x16x32_bf16 v[94:97], v[244:247], v[224:227], v[94:97]
  v_mfma_f32_16x16x32_bf16 v[98:101], v[244:247], v[228:231], v[98:101]
  v_mfma_f32_16x16x32_bf16 v[98:101], v[240:243], v[170:173], v[98:101]
  v_mfma_f32_16x16x32_bf16 v[114:117], v[248:251], v[170:173], v[114:117]
  v_mfma_f32_16x16x32_bf16 v[114:117], v[252:255], v[228:231], v[114:117]
  v_mfma_f32_16x16x32_bf16 v[110:113], v[252:255], v[224:227], v[110:113]
  v_mfma_f32_16x16x32_bf16 v[110:113], v[248:251], v[166:169], v[110:113]
L_B1w1:
  s_cbranch_execz L_B1r
  s_nop 0
  v_mfma_f32_16x16x32_bf16 v[106:109], v[248:251], v[162:165], v[106:109]
  v_mfma_f32_16x16x32_bf16 v[106:109], v[252:255], v[220:223], v[106:109]
  v_mfma_f32_16x16x32_bf16 v[102:105], v[252:255], v[216:219], v[102:105]
  v_mfma_f32_16x16x32_bf16 v[102:105], v[248:251], v[158:161], v[102:105]
  s_barrier
  s_add_u32 m0, s53, 59392
  s_lshl_b32 s60, 25, s64
  buffer_load_dwordx4 v7, s[8:11], s60 offen lds
  ds_read_b128 v[142:145], v30 offset:1280
  ds_read_b128 v[18:21], v30 offset:1536
  ds_read_b128 v[22:25], v30 offset:1792
  ds_read_b128 v[180:183], v30 offset:2048
  ds_read_b64_tr_b16 v[184:185], v12 offset:43008
  ds_read_b64_tr_b16 v[188:189], v13 offset:43008
  ds_read_b64_tr_b16 v[192:193], v14 offset:43008
  ds_read_b64_tr_b16 v[196:197], v15 offset:43008
  s_waitcnt vmcnt(11)
  ds_read_b64_tr_b16 v[186:187], v212 offset:0
  ds_read_b64_tr_b16 v[190:191], v213 offset:0
  s_add_u32 m0, s53, 67584
  s_lshl_b32 s60, 29, s64
  buffer_load_dwordx4 v7, s[8:11], s60 offen lds
  ds_read_b64_tr_b16 v[194:195], v214 offset:0
  ds_read_b64_tr_b16 v[198:199], v215 offset:0
  s_waitcnt vmcnt(10)
  ds_read_b64_tr_b16 v[200:201], v212 offset:16384
  ds_read_b64_tr_b16 v[204:205], v213 offset:16384
  ds_read_b64_tr_b16 v[216:217], v214 offset:16384
  ds_read_b64_tr_b16 v[220:221], v215 offset:16384
  ds_read_b128 v[118:121], v3 offset:4608
  ds_read_b128 v[126:129], v3 offset:5120
  ds_read_b128 v[122:125], v3 offset:4864
  ds_read_b128 v[130:133], v3 offset:5376
  ds_read_b128 v[134:137], v3 offset:5632
  s_setprio 2
  s_waitcnt lgkmcnt(13) vmcnt(6)
  s_lshl_b32 s60, s5, s64
  v_add_u32 v7, s60, v7
  s_add_u32 m0, s53, 43008
  s_lshl_b32 s60, 0, s64
  buffer_load_dwordx4 v7, s[8:11], s60 offen lds
  s_waitcnt vmcnt(6)
  s_add_u32 m0, s53, 51200
  s_lshl_b32 s60, 4, s64
  buffer_load_dwordx4 v7, s[8:11], s60 offen lds
  ds_read_b64_tr_b16 v[202:203], v12 offset:6144
  ds_read_b64_tr_b16 v[206:207], v13 offset:6144
  ds_read_b64_tr_b16 v[218:219], v14 offset:6144
  ds_read_b64_tr_b16 v[222:223], v15 offset:6144
  s_waitcnt lgkmcnt(13) vmcnt(6)
  s_add_u32 m0, s53, 81920
  s_lshl_b32 s60, 1, s64
  buffer_load_dwordx4 v7, s[8:11], s60 offen lds
  s_waitcnt vmcnt(6)
  s_add_u32 m0, s53, 90112
  s_lshl_b32 s60, 5, s64
  buffer_load_dwordx4 v7, s[8:11], s60 offen lds
  ds_read_b64_tr_b16 v[224:225], v212 offset:32768
  ds_read_b64_tr_b16 v[228:229], v213 offset:32768
  ds_read_b64_tr_b16 v[232:233], v214 offset:32768
  ds_read_b64_tr_b16 v[236:237], v215 offset:32768
  s_waitcnt lgkmcnt(13) vmcnt(6)
  s_add_u32 m0, s53, 98304
  s_lshl_b32 s60, 8, s64
  buffer_load_dwordx4 v7, s[8:11], s60 offen lds
  s_waitcnt vmcnt(6)
  s_add_u32 m0, s53, 106496
  s_lshl_b32 s60, 12, s64
  buffer_load_dwordx4 v7, s[8:11], s60 offen lds
  ds_read_b64_tr_b16 v[226:227], v212 offset:49152
  ds_read_b64_tr_b16 v[230:231], v213 offset:49152
  ds_read_b64_tr_b16 v[234:235], v214 offset:49152
  ds_read_b64_tr_b16 v[238:239], v215 offset:49152
  s_waitcnt lgkmcnt(8) vmcnt(6)
  s_add_u32 m0, s53, 6144
  s_lshl_b32 s60, 9, s64
  buffer_load_dwordx4 v7, s[8:11], s60 offen lds
  s_waitcnt vmcnt(6)
  s_add_u32 m0, s53, 14336
  s_lshl_b32 s60, 13, s64
  buffer_load_dwordx4 v7, s[8:11], s60 offen lds
  ds_read_b64_tr_b16 v[240:241], v12 offset:22528
  ds_read_b64_tr_b16 v[244:245], v13 offset:22528
  ds_read_b64_tr_b16 v[248:249], v14 offset:22528
  ds_read_b64_tr_b16 v[252:253], v15 offset:22528
  s_waitcnt lgkmcnt(8) vmcnt(6)
  s_add_u32 m0, s53, 114688
  s_lshl_b32 s60, 16, s64
  buffer_load_dwordx4 v7, s[8:11], s60 offen lds
  s_waitcnt vmcnt(6)
  s_add_u32 m0, s53, 122880
  s_lshl_b32 s60, 20, s64
  buffer_load_dwordx4 v7, s[8:11], s60 offen lds
  ds_read_b64_tr_b16 v[242:243], v12 offset:59392
  ds_read_b64_tr_b16 v[246:247], v13 offset:59392
  ds_read_b64_tr_b16 v[250:251], v14 offset:59392
  ds_read_b64_tr_b16 v[254:255], v15 offset:59392
  s_waitcnt lgkmcnt(8) vmcnt(6)
  s_add_u32 m0, s53, 131072
  s_lshl_b32 s60, 17, s64
  buffer_load_dwordx4 v7, s[8:11], s60 offen lds
  s_waitcnt vmcnt(6)
  s_add_u32 m0, s53, 139264
  s_lshl_b32 s60, 21, s64
  buffer_load_dwordx4 v7, s[8:11], s60 offen lds
  s_waitcnt lgkmcnt(4) vmcnt(6)
  s_add_u32 m0, s53, 22528
  s_lshl_b32 s60, 24, s64
  buffer_load_dwordx4 v7, s[8:11], s60 offen lds
  s_waitcnt vmcnt(6)
  s_add_u32 m0, s53, 30720
  s_lshl_b32 s60, 28, s64
  buffer_load_dwordx4 v7, s[8:11], s60 offen lds
  s_waitcnt lgkmcnt(0) vmcnt(6)
  s_add_u32 m0, s53, 59392
  s_lshl_b32 s60, 25, s64
  buffer_load_dwordx4 v7, s[8:11], s60 offen lds
  s_waitcnt vmcnt(6)
  s_add_u32 m0, s53, 67584
  s_lshl_b32 s60, 29, s64
  buffer_load_dwordx4 v7, s[8:11], s60 offen lds
  ds_read_b128 v[172:175], v4 offset:1280
  ds_read_b128 v[176:179], v4 offset:1536
  v_pk_fma_f32 v[38:39], v[142:143], v[118:119], v[38:39] op_sel_hi:[0,1,1] neg_lo:[1,0,0] neg_hi:[1,0,0]
  v_pk_fma_f32 v[40:41], v[142:143], v[120:121], v[40:41] op_sel_hi:[0,1,1] neg_lo:[1,0,0] neg_hi:[1,0,0]
  v_pk_fma_f32 v[70:71], v[142:143], v[126:127], v[70:71] op_sel_hi:[0,1,1] neg_lo:[1,0,0] neg_hi:[1,0,0]
  v_pk_fma_f32 v[72:73], v[142:143], v[128:129], v[72:73] op_sel_hi:[0,1,1] neg_lo:[1,0,0] neg_hi:[1,0,0]
  v_pk_mul_f32 v[138:139], v[38:39], v[144:145] op_sel_hi:[1,0]
  v_pk_mul_f32 v[140:141], v[40:41], v[144:145] op_sel_hi:[1,0]
  v_exp_f32 v138, v138
  v_exp_f32 v139, v139
  v_exp_f32 v140, v140
  v_exp_f32_e64 v141, v141
  v_pk_mul_f32 v[38:39], v[38:39], v[70:71]
  v_pk_mul_f32 v[40:41], v[40:41], v[72:73]
  v_pk_fma_f32 v[138:139], v[144:145], v[138:139], v[144:145] op_sel:[1,0,1]
  v_pk_fma_f32 v[140:141], v[144:145], v[140:141], v[144:145] op_sel:[1,0,1]
  v_rcp_f32 v138, v138
  v_rcp_f32 v139, v139
  v_rcp_f32 v140, v140
  v_rcp_f32 v141, v141
  v_pk_mul_f32 v[38:39], v[38:39], v[138:139]
  v_pk_mul_f32 v[40:41], v[40:41], v[140:141]
  v_cvt_pk_bf16_f32 v70, v38, v39
  v_cvt_pk_bf16_f32 v71, v40, v41
  v_pk_fma_f32 v[42:43], v[18:19], v[118:119], v[42:43] op_sel_hi:[0,1,1] neg_lo:[1,0,0] neg_hi:[1,0,0]
  v_pk_fma_f32 v[44:45], v[18:19], v[120:121], v[44:45] op_sel_hi:[0,1,1] neg_lo:[1,0,0] neg_hi:[1,0,0]
  v_pk_fma_f32 v[74:75], v[18:19], v[126:127], v[74:75] op_sel_hi:[0,1,1] neg_lo:[1,0,0] neg_hi:[1,0,0]
  v_pk_fma_f32 v[76:77], v[18:19], v[128:129], v[76:77] op_sel_hi:[0,1,1] neg_lo:[1,0,0] neg_hi:[1,0,0]
  v_pk_mul_f32 v[138:139], v[42:43], v[20:21] op_sel_hi:[1,0]
  v_pk_mul_f32 v[140:141], v[44:45], v[20:21] op_sel_hi:[1,0]
  v_exp_f32 v138, v138
  v_exp_f32 v139, v139
  v_exp_f32 v140, v140
  v_exp_f32 v141, v141
  v_pk_mul_f32 v[42:43], v[42:43], v[74:75]
  v_pk_mul_f32 v[44:45], v[44:45], v[76:77]
  v_pk_fma_f32 v[138:139], v[20:21], v[138:139], v[20:21] op_sel:[1,0,1]
  v_pk_fma_f32 v[140:141], v[20:21], v[140:141], v[20:21] op_sel:[1,0,1]
  v_rcp_f32 v138, v138
  v_rcp_f32 v139, v139
  v_rcp_f32 v140, v140
  v_rcp_f32 v141, v141
  v_pk_mul_f32 v[42:43], v[42:43], v[138:139]
  v_pk_mul_f32 v[44:45], v[44:45], v[140:141]
  v_cvt_pk_bf16_f32 v72, v42, v43
  v_cvt_pk_bf16_f32 v73, v44, v45
  s_nop 0
  v_permlane16_swap_b32 v70, v72
  v_permlane16_swap_b32_e64 v71, v73
  buffer_store_dwordx4 v[70:73], v2, s[40:43], s55 offen sc1
  v_pk_fma_f32 v[46:47], v[22:23], v[118:119], v[46:47] op_sel_hi:[0,1,1] neg_lo:[1,0,0] neg_hi:[1,0,0]
  v_pk_fma_f32 v[48:49], v[22:23], v[120:121], v[48:49] op_sel_hi:[0,1,1] neg_lo:[1,0,0] neg_hi:[1,0,0]
  v_pk_fma_f32 v[78:79], v[22:23], v[126:127], v[78:79] op_sel_hi:[0,1,1] neg_lo:[1,0,0] neg_hi:[1,0,0]
  v_pk_fma_f32 v[80:81], v[22:23], v[128:129], v[80:81] op_sel_hi:[0,1,1] neg_lo:[1,0,0] neg_hi:[1,0,0]
  v_pk_mul_f32 v[138:139], v[46:47], v[24:25] op_sel_hi:[1,0]
  v_pk_mul_f32 v[140:141], v[48:49], v[24:25] op_sel_hi:[1,0]
  v_exp_f32 v138, v138
  v_exp_f32 v139, v139
  v_exp_f32 v140, v140
  v_exp_f32 v141, v141
  v_pk_mul_f32 v[46:47], v[46:47], v[78:79]
  v_pk_mul_f32 v[48:49], v[48:49], v[80:81]
  v_pk_fma_f32 v[138:139], v[24:25], v[138:139], v[24:25] op_sel:[1,0,1]
  v_pk_fma_f32 v[140:141], v[24:25], v[140:141], v[24:25] op_sel:[1,0,1]
  v_rcp_f32 v138, v138
  v_rcp_f32 v139, v139
  v_rcp_f32 v140, v140
  v_rcp_f32 v141, v141
  v_pk_mul_f32 v[46:47], v[46:47], v[138:139]
  v_pk_mul_f32 v[48:49], v[48:49], v[140:141]
  v_cvt_pk_bf16_f32 v78, v46, v47
  v_cvt_pk_bf16_f32 v79, v48, v49
  v_pk_fma_f32 v[50:51], v[180:181], v[118:119], v[50:51] op_sel_hi:[0,1,1] neg_lo:[1,0,0] neg_hi:[1,0,0]
  v_pk_fma_f32 v[52:53], v[180:181], v[120:121], v[52:53] op_sel_hi:[0,1,1] neg_lo:[1,0,0] neg_hi:[1,0,0]
  v_pk_fma_f32 v[82:83], v[180:181], v[126:127], v[82:83] op_sel_hi:[0,1,1] neg_lo:[1,0,0] neg_hi:[1,0,0]
  v_pk_fma_f32 v[84:85], v[180:181], v[128:129], v[84:85] op_sel_hi:[0,1,1] neg_lo:[1,0,0] neg_hi:[1,0,0]
  v_pk_mul_f32 v[138:139], v[50:51], v[182:183] op_sel_hi:[1,0]
  v_pk_mul_f32 v[140:141], v[52:53], v[182:183] op_sel_hi:[1,0]
  v_exp_f32 v138, v138
  v_exp_f32 v139, v139
  v_exp_f32 v140, v140
  v_exp_f32 v141, v141
  v_pk_mul_f32 v[50:51], v[50:51], v[82:83]
  v_pk_mul_f32 v[52:53], v[52:53], v[84:85]
  v_pk_fma_f32 v[138:139], v[182:183], v[138:139], v[182:183] op_sel:[1,0,1]
  v_pk_fma_f32 v[140:141], v[182:183], v[140:141], v[182:183] op_sel:[1,0,1]
  v_rcp_f32 v138, v138
  v_rcp_f32 v139, v139
  v_rcp_f32 v140, v140
  v_rcp_f32 v141, v141
  v_pk_mul_f32 v[50:51], v[50:51], v[138:139]
  v_pk_mul_f32 v[52:53], v[52:53], v[140:141]
  v_cvt_pk_bf16_f32 v80, v50, v51
  v_cvt_pk_bf16_f32 v81, v52, v53
  s_nop 0
  v_permlane16_swap_b32 v78, v80
  v_permlane16_swap_b32_e64 v79, v81
  buffer_store_dwordx4 v[78:81], v2, s[40:43], s56 offen sc1
  v_pk_fma_f32 v[54:55], v[142:143], v[122:123], v[54:55] op_sel_hi:[0,1,1] neg_lo:[1,0,0] neg_hi:[1,0,0]
  v_pk_fma_f32 v[56:57], v[142:143], v[124:125], v[56:57] op_sel_hi:[0,1,1] neg_lo:[1,0,0] neg_hi:[1,0,0]
  v_pk_fma_f32 v[86:87], v[142:143], v[130:131], v[86:87] op_sel_hi:[0,1,1] neg_lo:[1,0,0] neg_hi:[1,0,0]
  v_pk_fma_f32 v[88:89], v[142:143], v[132:133], v[88:89] op_sel_hi:[0,1,1] neg_lo:[1,0,0] neg_hi:[1,0,0]
  v_pk_mul_f32 v[138:139], v[54:55], v[144:145] op_sel_hi:[1,0]
  v_pk_mul_f32 v[140:141], v[56:57], v[144:145] op_sel_hi:[1,0]
  v_exp_f32 v138, v138
  v_exp_f32 v139, v139
  v_exp_f32 v140, v140
  v_exp_f32 v141, v141
  v_pk_mul_f32 v[54:55], v[54:55], v[86:87]
  v_pk_mul_f32 v[56:57], v[56:57], v[88:89]
  v_pk_fma_f32 v[138:139], v[144:145], v[138:139], v[144:145] op_sel:[1,0,1]
  v_pk_fma_f32 v[140:141], v[144:145], v[140:141], v[144:145] op_sel:[1,0,1]
  v_rcp_f32 v138, v138
  v_rcp_f32 v139, v139
  v_rcp_f32 v140, v140
  v_rcp_f32 v141, v141
  v_pk_mul_f32 v[54:55], v[54:55], v[138:139]
  v_pk_mul_f32 v[56:57], v[56:57], v[140:141]
  v_cvt_pk_bf16_f32 v86, v54, v55
  v_cvt_pk_bf16_f32 v87, v56, v57
  v_pk_fma_f32 v[58:59], v[18:19], v[122:123], v[58:59] op_sel_hi:[0,1,1] neg_lo:[1,0,0] neg_hi:[1,0,0]
  v_pk_fma_f32 v[60:61], v[18:19], v[124:125], v[60:61] op_sel_hi:[0,1,1] neg_lo:[1,0,0] neg_hi:[1,0,0]
  v_pk_fma_f32 v[90:91], v[18:19], v[130:131], v[90:91] op_sel_hi:[0,1,1] neg_lo:[1,0,0] neg_hi:[1,0,0]
  v_pk_fma_f32 v[92:93], v[18:19], v[132:133], v[92:93] op_sel_hi:[0,1,1] neg_lo:[1,0,0] neg_hi:[1,0,0]
  v_pk_mul_f32 v[138:139], v[58:59], v[20:21] op_sel_hi:[1,0]
  v_pk_mul_f32 v[140:141], v[60:61], v[20:21] op_sel_hi:[1,0]
  v_exp_f32 v138, v138
  v_exp_f32 v139, v139
  v_exp_f32 v140, v140
  v_exp_f32 v141, v141
  v_pk_mul_f32 v[58:59], v[58:59], v[90:91]
  v_pk_mul_f32 v[60:61], v[60:61], v[92:93]
  v_pk_fma_f32 v[138:139], v[20:21], v[138:139], v[20:21] op_sel:[1,0,1]
  v_pk_fma_f32 v[140:141], v[20:21], v[140:141], v[20:21] op_sel:[1,0,1]
  v_rcp_f32 v138, v138
  v_rcp_f32 v139, v139
  v_rcp_f32 v140, v140
  v_rcp_f32 v141, v141
  v_pk_mul_f32 v[58:59], v[58:59], v[138:139]
  v_pk_mul_f32 v[60:61], v[60:61], v[140:141]
  v_cvt_pk_bf16_f32 v88, v58, v59
  v_cvt_pk_bf16_f32 v89, v60, v61
  s_nop 0
  v_permlane16_swap_b32 v86, v88
  v_permlane16_swap_b32_e64 v87, v89
  buffer_store_dwordx4 v[86:89], v2, s[40:43], s57 offen sc1
  v_pk_fma_f32 v[62:63], v[22:23], v[122:123], v[62:63] op_sel_hi:[0,1,1] neg_lo:[1,0,0] neg_hi:[1,0,0]
  v_pk_fma_f32 v[64:65], v[22:23], v[124:125], v[64:65] op_sel_hi:[0,1,1] neg_lo:[1,0,0] neg_hi:[1,0,0]
  v_pk_fma_f32 v[94:95], v[22:23], v[130:131], v[94:95] op_sel_hi:[0,1,1] neg_lo:[1,0,0] neg_hi:[1,0,0]
  v_pk_fma_f32 v[96:97], v[22:23], v[132:133], v[96:97] op_sel_hi:[0,1,1] neg_lo:[1,0,0] neg_hi:[1,0,0]
  v_pk_mul_f32 v[138:139], v[62:63], v[24:25] op_sel_hi:[1,0]
  v_pk_mul_f32 v[140:141], v[64:65], v[24:25] op_sel_hi:[1,0]
  v_exp_f32 v138, v138
  v_exp_f32 v139, v139
  v_exp_f32 v140, v140
  v_exp_f32 v141, v141
  v_pk_mul_f32 v[62:63], v[62:63], v[94:95]
  v_pk_mul_f32 v[64:65], v[64:65], v[96:97]
  v_pk_fma_f32 v[138:139], v[24:25], v[138:139], v[24:25] op_sel:[1,0,1]
  v_pk_fma_f32 v[140:141], v[24:25], v[140:141], v[24:25] op_sel:[1,0,1]
  v_rcp_f32 v138, v138
  v_rcp_f32 v139, v139
  v_rcp_f32 v140, v140
  v_rcp_f32 v141, v141
  v_pk_mul_f32 v[62:63], v[62:63], v[138:139]
  v_pk_mul_f32 v[64:65], v[64:65], v[140:141]
  v_cvt_pk_bf16_f32 v94, v62, v63
  v_cvt_pk_bf16_f32 v95, v64, v65
  v_pk_fma_f32 v[66:67], v[180:181], v[122:123], v[66:67] op_sel_hi:[0,1,1] neg_lo:[1,0,0] neg_hi:[1,0,0]
  v_pk_fma_f32 v[68:69], v[180:181], v[124:125], v[68:69] op_sel_hi:[0,1,1] neg_lo:[1,0,0] neg_hi:[1,0,0]
  v_pk_fma_f32 v[98:99], v[180:181], v[130:131], v[98:99] op_sel_hi:[0,1,1] neg_lo:[1,0,0] neg_hi:[1,0,0]
  v_pk_fma_f32 v[100:101], v[180:181], v[132:133], v[100:101] op_sel_hi:[0,1,1] neg_lo:[1,0,0] neg_hi:[1,0,0]
  v_pk_mul_f32 v[138:139], v[66:67], v[182:183] op_sel_hi:[1,0]
  v_pk_mul_f32 v[140:141], v[68:69], v[182:183] op_sel_hi:[1,0]
  v_exp_f32 v138, v138
  v_exp_f32 v139, v139
  v_exp_f32 v140, v140
  v_exp_f32 v141, v141
  v_pk_mul_f32 v[66:67], v[66:67], v[98:99]
  v_pk_mul_f32 v[68:69], v[68:69], v[100:101]
  v_pk_fma_f32 v[138:139], v[182:183], v[138:139], v[182:183] op_sel:[1,0,1]
  v_pk_fma_f32 v[140:141], v[182:183], v[140:141], v[182:183] op_sel:[1,0,1]
  v_rcp_f32 v138, v138
  v_rcp_f32 v139, v139
  v_rcp_f32 v140, v140
  v_rcp_f32 v141, v141
  v_pk_mul_f32 v[66:67], v[66:67], v[138:139]
  v_pk_mul_f32 v[68:69], v[68:69], v[140:141]
  v_cvt_pk_bf16_f32 v96, v66, v67
  v_cvt_pk_bf16_f32 v97, v68, v69
  s_nop 0
  v_permlane16_swap_b32 v94, v96
  v_permlane16_swap_b32_e64 v95, v97
  buffer_store_dwordx4 v[94:97], v2, s[40:43], s58 offen sc1
  v_pk_fma_f32 v[102:103], v[142:143], v[134:135], v[102:103] op_sel_hi:[0,1,1] neg_lo:[1,0,0] neg_hi:[1,0,0]
  v_pk_fma_f32 v[104:105], v[142:143], v[136:137], v[104:105] op_sel_hi:[0,1,1] neg_lo:[1,0,0] neg_hi:[1,0,0]
  v_pk_fma_f32 v[106:107], v[18:19], v[134:135], v[106:107] op_sel_hi:[0,1,1] neg_lo:[1,0,0] neg_hi:[1,0,0]
  v_pk_fma_f32 v[108:109], v[18:19], v[136:137], v[108:109] op_sel_hi:[0,1,1] neg_lo:[1,0,0] neg_hi:[1,0,0]
  v_pk_fma_f32 v[110:111], v[22:23], v[134:135], v[110:111] op_sel_hi:[0,1,1] neg_lo:[1,0,0] neg_hi:[1,0,0]
  v_pk_fma_f32 v[112:113], v[22:23], v[136:137], v[112:113] op_sel_hi:[0,1,1] neg_lo:[1,0,0] neg_hi:[1,0,0]
  v_pk_fma_f32 v[114:115], v[180:181], v[134:135], v[114:115] op_sel_hi:[0,1,1] neg_lo:[1,0,0] neg_hi:[1,0,0]
  v_pk_fma_f32 v[116:117], v[180:181], v[136:137], v[116:117] op_sel_hi:[0,1,1] neg_lo:[1,0,0] neg_hi:[1,0,0]
  v_permlane32_swap_b32 v102, v110
  v_permlane32_swap_b32 v103, v111
  v_permlane32_swap_b32 v104, v112
  v_permlane32_swap_b32 v105, v113
  v_permlane32_swap_b32 v106, v114
  v_permlane32_swap_b32 v107, v115
  v_permlane32_swap_b32 v108, v116
  v_permlane32_swap_b32_e64 v109, v117
  s_waitcnt lgkmcnt(1)
  v_pk_mul_f32 v[138:139], v[102:103], v[174:175] op_sel_hi:[1,0]
  v_pk_mul_f32 v[140:141], v[104:105], v[174:175] op_sel_hi:[1,0]
  v_exp_f32 v138, v138
  v_exp_f32 v139, v139
  v_exp_f32 v140, v140
  v_exp_f32 v141, v141
  v_pk_mul_f32 v[102:103], v[102:103], v[110:111]
  v_pk_mul_f32 v[104:105], v[104:105], v[112:113]
  v_pk_fma_f32 v[138:139], v[174:175], v[138:139], v[174:175] op_sel:[1,0,1]
  v_pk_fma_f32 v[140:141], v[174:175], v[140:141], v[174:175] op_sel:[1,0,1]
  v_rcp_f32 v138, v138
  v_rcp_f32 v139, v139
  v_rcp_f32 v140, v140
  v_rcp_f32 v141, v141
  v_pk_mul_f32 v[102:103], v[102:103], v[138:139]
  v_pk_mul_f32 v[104:105], v[104:105], v[140:141]
  v_cvt_pk_bf16_f32 v164, v102, v103
  v_cvt_pk_bf16_f32 v165, v104, v105
  s_waitcnt lgkmcnt(0)
  v_pk_mul_f32 v[138:139], v[106:107], v[178:179] op_sel_hi:[1,0]
  v_pk_mul_f32 v[140:141], v[108:109], v[178:179] op_sel_hi:[1,0]
  v_exp_f32 v138, v138
  v_exp_f32 v139, v139
  v_exp_f32 v140, v140
  v_exp_f32_e64 v141, v141
  v_pk_mul_f32 v[106:107], v[106:107], v[114:115]
  v_pk_mul_f32 v[108:109], v[108:109], v[116:117]
  v_pk_fma_f32 v[138:139], v[178:179], v[138:139], v[178:179] op_sel:[1,0,1]
  v_pk_fma_f32 v[140:141], v[178:179], v[140:141], v[178:179] op_sel:[1,0,1]
  v_rcp_f32 v138, v138
  v_rcp_f32 v139, v139
  v_rcp_f32 v140, v140
  v_rcp_f32 v141, v141
  v_pk_mul_f32 v[106:107], v[106:107], v[138:139]
  v_pk_mul_f32 v[108:109], v[108:109], v[140:141]
  v_cvt_pk_bf16_f32 v166, v106, v107
  v_cvt_pk_bf16_f32 v167, v108, v109
  s_nop 0
  v_permlane16_swap_b32 v164, v166
  v_permlane16_swap_b32_e64 v165, v167
  buffer_store_dwordx4 v[164:167], v10, s[40:43], s59 offen sc1
  s_waitcnt vmcnt(5)
  ds_read_b64_tr_b16 v[104:105], v12 offset:43008
  ds_read_b64_tr_b16 v[108:109], v13 offset:43008
  ds_read_b64_tr_b16 v[112:113], v14 offset:43008
  ds_read_b64_tr_b16 v[116:117], v15 offset:43008
  ds_read_b64_tr_b16 v[106:107], v212 offset:0
  ds_read_b64_tr_b16 v[110:111], v213 offset:0
  ds_read_b64_tr_b16 v[114:115], v214 offset:0
  ds_read_b64_tr_b16 v[118:119], v215 offset:0
  ds_read_b64_tr_b16 v[120:121], v212 offset:16384
  ds_read_b64_tr_b16 v[124:125], v213 offset:16384
  ds_read_b64_tr_b16 v[128:129], v214 offset:16384
  ds_read_b64_tr_b16 v[132:133], v215 offset:16384
  ds_read_b64_tr_b16 v[122:123], v12 offset:6144
  ds_read_b64_tr_b16 v[126:127], v13 offset:6144
  ds_read_b64_tr_b16 v[130:131], v14 offset:6144
  ds_read_b64_tr_b16 v[134:135], v15 offset:6144
  ds_read_b64_tr_b16 v[136:137], v212 offset:32768
  ds_read_b64_tr_b16 v[140:141], v213 offset:32768
  ds_read_b64_tr_b16 v[144:145], v214 offset:32768
  ds_read_b64_tr_b16 v[148:149], v215 offset:32768
  ds_read_b64_tr_b16 v[138:139], v212 offset:49152
  ds_read_b64_tr_b16 v[142:143], v213 offset:49152
  ds_read_b64_tr_b16 v[146:147], v214 offset:49152
  ds_read_b64_tr_b16 v[150:151], v215 offset:49152
  ds_read_b64_tr_b16 v[152:153], v12 offset:22528
  ds_read_b64_tr_b16 v[156:157], v13 offset:22528
  ds_read_b64_tr_b16 v[160:161], v14 offset:22528
  ds_read_b64_tr_b16 v[164:165], v15 offset:22528
  ds_read_b64_tr_b16 v[154:155], v12 offset:59392
  ds_read_b64_tr_b16 v[158:159], v13 offset:59392
  ds_read_b64_tr_b16 v[162:163], v14 offset:59392
  ds_read_b64_tr_b16 v[166:167], v15 offset:59392
  buffer_load_dwordx2 v[20:21], v8, s[20:23], 0 offen
  buffer_load_dwordx2 v[22:23], v11, s[20:23], 0 offen
  s_buffer_load_dwordx4 s[28:31], s[40:43], s65 offset:0 glc
  s_waitcnt vmcnt(2)
  s_mov_b64 exec, 1
  ds_add_rtn_u32 v3, v1, v6 offset:5892
  s_waitcnt lgkmcnt(0)
  v_readfirstlane_b32 s66, v3
  s_mov_b64 exec, -1
  s_xor_b32 s66, s66, 3
  s_lshl_b32 s66, s66, 24
  v_add_u32_e64 v3, s66, v33
  buffer_store_dword v6, v3, s[40:43], 0 offen sc1
  s_setprio 1
  s_branch L_P1
.p2align 12
L_P0wA:
  s_branch L_A0w0
L_P0wB:
  s_branch L_B0w0
L_P0:
  s_lshl_b32 s66, s5, 8
  v_add_u32_e64 v7, s66, v9
  s_waitcnt lgkmcnt(0)
  s_and_b32 s28, s28, s29
  s_cbranch_scc1 L_P0g0
  s_mov_b32 s68, 262144
L_P0p0:
  s_sleep 3
  s_buffer_load_dwordx2 s[28:29], s[40:43], s65 offset:0 glc
  s_sub_u32 s68, s68, 1
  s_waitcnt lgkmcnt(0)
  s_cbranch_scc1 L_P0g0
  s_and_b32 s28, s28, s29
  s_cbranch_scc0 L_P0p0
L_P0g0:
  s_mov_b32 s48, 0
  buffer_load_dwordx4 v[56:59], v9, s[40:43], s48 offen sc1
  buffer_load_dwordx4 v[60:63], v9, s[40:43], s48 offen offset:2048 sc1
  buffer_load_dwordx4 v[64:67], v9, s[40:43], s48 offen offset:256 sc1
  buffer_load_dwordx4 v[68:71], v9, s[40:43], s48 offen offset:2304 sc1
  s_mov_b32 s48, 4096
  buffer_load_dwordx4 v[72:75], v9, s[40:43], s48 offen sc1
  buffer_load_dwordx4 v[76:79], v9, s[40:43], s48 offen offset:2048 sc1
  buffer_load_dwordx4 v[80:83], v9, s[40:43], s48 offen offset:256 sc1
  buffer_load_dwordx4 v[84:87], v9, s[40:43], s48 offen offset:2304 sc1
  s_add_u32 s69, s53, 81920
  v_lshrrev_b32 v3, 4, v1
  v_lshl_add_u32 v5, v3, 5, v2
  v_and_b32 v5, 0xf0, v5
  v_lshl_add_u32 v5, v3, 8, v5
  v_add_u32_e64 v17, s69, v5
  v_xor_b32 v4, 128, v17
  v_and_b32 v3, 7, v0
  v_lshrrev_b32 v5, 4, v0
  v_lshl_add_u32 v3, v3, 1, v5
  v_and_b32 v3, 15, v3
  v_lshlrev_b32 v18, 4, v3
  v_and_b32_e64 v3, 3, v0
  v_lshl_add_u32 v18, v3, 8, v18
  v_bfe_u32 v5, v0, 2, 2
  v_lshl_add_u32 v18, v5, 13, v18
  v_add_u32 v18, 81920, v18
  s_lshl_b32 s66, s45, 8
  v_lshl_add_u32 v10, v5, 13, s66
  v_lshl_add_u32 v10, v16, 6, v10
  v_lshl_add_u32 v10, v3, 4, v10
  v_mov_b32 v19, 0
  s_mov_b32 s56, 0xbfb8aa3b
  s_waitcnt vmcnt(7)
  v_mfma_f32_16x16x32_bf16 v[24:27], v[216:219], v[56:59], 0
  s_waitcnt vmcnt(6)
  v_mfma_f32_16x16x32_bf16 v[24:27], v[232:235], v[60:63], v[24:27]
  v_mfma_f32_16x16x32_bf16 v[28:31], v[236:239], v[60:63], 0
  v_mfma_f32_16x16x32_bf16 v[28:31], v[220:223], v[56:59], v[28:31]
  v_mfma_f32_16x16x32_bf16 v[32:35], v[224:227], v[56:59], 0
  v_mfma_f32_16x16x32_bf16 v[32:35], v[240:243], v[60:63], v[32:35]
  v_mfma_f32_16x16x32_bf16 v[36:39], v[244:247], v[60:63], 0
  v_mfma_f32_16x16x32_bf16 v[36:39], v[228:231], v[56:59], v[36:39]
  s_mov_b32 s48, 8192
  buffer_load_dwordx4 v[56:59], v9, s[40:43], s48 offen sc1
  s_mov_b32 s48, 0
  buffer_load_dwordx4 v[60:63], v7, s[40:43], s48 offen sc1
  ds_read_b64_tr_b16 v[164:165], v12 offset:43008
  ds_read_b64_tr_b16 v[160:161], v13 offset:43008
  ds_read_b64_tr_b16 v[156:157], v14 offset:43008
  ds_read_b64_tr_b16 v[152:153], v15 offset:43008
  ds_read_b64_tr_b16 v[166:167], v212 offset:0
  ds_read_b64_tr_b16 v[162:163], v213 offset:0
  ds_read_b64_tr_b16 v[158:159], v214 offset:0
  ds_read_b64_tr_b16 v[154:155], v215 offset:0
  ds_read_b64_tr_b16 v[148:149], v212 offset:16384
  ds_read_b64_tr_b16 v[144:145], v213 offset:16384
  ds_read_b64_tr_b16 v[140:141], v214 offset:16384
  ds_read_b64_tr_b16 v[136:137], v215 offset:16384
  s_waitcnt vmcnt(7)
  v_mfma_f32_16x16x32_bf16 v[40:43], v[216:219], v[64:67], 0
  s_waitcnt vmcnt(6)
  v_mfma_f32_16x16x32_bf16 v[40:43], v[232:235], v[68:71], v[40:43]
  v_mfma_f32_16x16x32_bf16 v[44:47], v[236:239], v[68:71], 0
  v_mfma_f32_16x16x32_bf16 v[44:47], v[220:223], v[64:67], v[44:47]
  v_mfma_f32_16x16x32_bf16 v[48:51], v[224:227], v[64:67], 0
  v_mfma_f32_16x16x32_bf16 v[48:51], v[240:243], v[68:71], v[48:51]
  v_mfma_f32_16x16x32_bf16 v[52:55], v[244:247], v[68:71], 0
  v_mfma_f32_16x16x32_bf16 v[52:55], v[228:231], v[64:67], v[52:55]
  s_mov_b32 s48, 8192
  buffer_load_dwordx4 v[64:67], v9, s[40:43], s48 offen offset:256 sc1
  s_mov_b32 s48, 0
  buffer_load_dwordx4 v[68:71], v7, s[40:43], s48 offen offset:256 sc1
  ds_read_b64_tr_b16 v[150:151], v12 offset:6144
  ds_read_b64_tr_b16 v[146:147], v13 offset:6144
  ds_read_b64_tr_b16 v[142:143], v14 offset:6144
  ds_read_b64_tr_b16 v[138:139], v15 offset:6144
  ds_read_b64_tr_b16 v[132:133], v212 offset:32768
  ds_read_b64_tr_b16 v[128:129], v213 offset:32768
  ds_read_b64_tr_b16 v[124:125], v214 offset:32768
  ds_read_b64_tr_b16 v[120:121], v215 offset:32768
  ds_read_b64_tr_b16 v[134:135], v212 offset:49152
  ds_read_b64_tr_b16 v[130:131], v213 offset:49152
  ds_read_b64_tr_b16 v[126:127], v214 offset:49152
  ds_read_b64_tr_b16 v[122:123], v215 offset:49152
  s_waitcnt vmcnt(7)
  v_mfma_f32_16x16x32_bf16 v[24:27], v[248:251], v[72:75], v[24:27]
  s_waitcnt vmcnt(6)
  v_mfma_f32_16x16x32_bf16 v[24:27], v[208:211], v[76:79], v[24:27]
  v_mfma_f32_16x16x32_bf16 v[28:31], v[192:195], v[76:79], v[28:31]
  v_mfma_f32_16x16x32_bf16 v[28:31], v[252:255], v[72:75], v[28:31]
  v_mfma_f32_16x16x32_bf16 v[32:35], v[200:203], v[72:75], v[32:35]
  v_mfma_f32_16x16x32_bf16 v[32:35], v[188:191], v[76:79], v[32:35]
  v_mfma_f32_16x16x32_bf16 v[36:39], v[184:187], v[76:79], v[36:39]
  v_mfma_f32_16x16x32_bf16 v[36:39], v[204:207], v[72:75], v[36:39]
  buffer_load_dwordx4 v[72:75], v7, s[40:43], s48 offen offset:2048 sc1
  s_mov_b32 s48, 4096
  buffer_load_dwordx4 v[76:79], v7, s[40:43], s48 offen sc1
  ds_read_b64_tr_b16 v[116:117], v12 offset:22528
  ds_read_b64_tr_b16 v[112:113], v13 offset:22528
  ds_read_b64_tr_b16 v[108:109], v14 offset:22528
  ds_read_b64_tr_b16 v[104:105], v15 offset:22528
  ds_read_b64_tr_b16 v[118:119], v196 offset:0
  ds_read_b64_tr_b16 v[114:115], v197 offset:0
  ds_read_b64_tr_b16 v[110:111], v198 offset:0
  ds_read_b64_tr_b16 v[106:107], v199 offset:0
  ds_read_b64_tr_b16 v[100:101], v196 offset:4096
  ds_read_b64_tr_b16 v[96:97], v197 offset:4096
  ds_read_b64_tr_b16 v[92:93], v198 offset:4096
  ds_read_b64_tr_b16 v[88:89], v199 offset:4096
  s_waitcnt vmcnt(7)
  v_mfma_f32_16x16x32_bf16 v[40:43], v[248:251], v[80:83], v[40:43]
  s_waitcnt vmcnt(6)
  v_mfma_f32_16x16x32_bf16 v[40:43], v[208:211], v[84:87], v[40:43]
  v_mfma_f32_16x16x32_bf16 v[44:47], v[192:195], v[84:87], v[44:47]
  v_mfma_f32_16x16x32_bf16 v[44:47], v[252:255], v[80:83], v[44:47]
  v_mfma_f32_16x16x32_bf16 v[48:51], v[200:203], v[80:83], v[48:51]
  v_mfma_f32_16x16x32_bf16 v[48:51], v[188:191], v[84:87], v[48:51]
  v_mfma_f32_16x16x32_bf16 v[52:55], v[184:187], v[84:87], v[52:55]
  v_mfma_f32_16x16x32_bf16 v[52:55], v[204:207], v[80:83], v[52:55]
  s_mov_b32 s48, 0
  buffer_load_dwordx4 v[80:83], v7, s[40:43], s48 offen offset:2304 sc1
  s_mov_b32 s48, 4096
  buffer_load_dwordx4 v[84:87], v7, s[40:43], s48 offen offset:256 sc1
  ds_read_b64_tr_b16 v[102:103], v12 offset:59392
  ds_read_b64_tr_b16 v[98:99], v13 offset:59392
  ds_read_b64_tr_b16 v[94:95], v14 offset:59392
  ds_read_b64_tr_b16 v[90:91], v15 offset:59392
  s_waitcnt vmcnt(7)
  v_mfma_f32_16x16x32_bf16 v[24:27], v[180:183], v[56:59], v[24:27]
  s_waitcnt vmcnt(6) lgkmcnt(14)
  v_mfma_f32_16x16x32_bf16 v[24:27], v[164:167], v[60:63], v[24:27]
  v_mfma_f32_16x16x32_bf16 v[28:31], v[160:163], v[60:63], v[28:31]
  v_mfma_f32_16x16x32_bf16 v[28:31], v[176:179], v[56:59], v[28:31]
  v_mfma_f32_16x16x32_bf16 v[32:35], v[172:175], v[56:59], v[32:35]
  v_mfma_f32_16x16x32_bf16 v[32:35], v[156:159], v[60:63], v[32:35]
  v_mfma_f32_16x16x32_bf16 v[36:39], v[152:155], v[60:63], v[36:39]
  v_mfma_f32_16x16x32_bf16 v[36:39], v[168:171], v[56:59], v[36:39]
  buffer_load_dwordx4 v[56:59], v7, s[40:43], s48 offen offset:2048 sc1
  s_mov_b32 s48, 8192
  buffer_load_dwordx4 v[60:63], v7, s[40:43], s48 offen sc1
  s_waitcnt vmcnt(7)
  v_mfma_f32_16x16x32_bf16 v[40:43], v[180:183], v[64:67], v[40:43]
  s_waitcnt vmcnt(6)
  v_mfma_f32_16x16x32_bf16 v[40:43], v[164:167], v[68:71], v[40:43]
  v_mfma_f32_16x16x32_bf16 v[44:47], v[160:163], v[68:71], v[44:47]
  v_mfma_f32_16x16x32_bf16 v[44:47], v[176:179], v[64:67], v[44:47]
  v_mfma_f32_16x16x32_bf16 v[48:51], v[172:175], v[64:67], v[48:51]
  v_mfma_f32_16x16x32_bf16 v[48:51], v[156:159], v[68:71], v[48:51]
  v_mfma_f32_16x16x32_bf16 v[52:55], v[152:155], v[68:71], v[52:55]
  v_mfma_f32_16x16x32_bf16 v[52:55], v[168:171], v[64:67], v[52:55]
  s_buffer_load_dwordx2 s[28:29], s[40:43], s65 offset:128 glc
  s_mov_b32 s48, 4096
  buffer_load_dwordx4 v[64:67], v7, s[40:43], s48 offen offset:2304 sc1
  s_mov_b32 s48, 8192
  buffer_load_dwordx4 v[68:71], v7, s[40:43], s48 offen offset:256 sc1
  s_waitcnt vmcnt(7)
  v_mfma_f32_16x16x32_bf16 v[24:27], v[148:151], v[72:75], v[24:27]
  s_waitcnt vmcnt(6)
  v_mfma_f32_16x16x32_bf16 v[24:27], v[132:135], v[76:79], v[24:27]
  v_mfma_f32_16x16x32_bf16 v[28:31], v[128:131], v[76:79], v[28:31]
  v_mfma_f32_16x16x32_bf16 v[28:31], v[144:147], v[72:75], v[28:31]
  v_mfma_f32_16x16x32_bf16 v[32:35], v[140:143], v[72:75], v[32:35]
  v_mfma_f32_16x16x32_bf16 v[32:35], v[124:127], v[76:79], v[32:35]
  v_mfma_f32_16x16x32_bf16 v[36:39], v[120:123], v[76:79], v[36:39]
  v_mfma_f32_16x16x32_bf16 v[36:39], v[136:139], v[72:75], v[36:39]
  s_waitcnt lgkmcnt(0)
  s_and_b32 s28, s28, s29
  s_cbranch_scc1 L_P0g1
  s_mov_b32 s68, 262144
L_P0p1:
  s_sleep 3
  s_buffer_load_dwordx2 s[28:29], s[40:43], s65 offset:128 glc
  s_sub_u32 s68, s68, 1
  s_waitcnt lgkmcnt(0)
  s_cbranch_scc1 L_P0g1
  s_and_b32 s28, s28, s29
  s_cbranch_scc0 L_P0p1
L_P0g1:
  s_mov_b32 s48, 294912
  buffer_load_dwordx4 v[72:75], v9, s[40:43], s48 offen sc1
  buffer_load_dwordx4 v[76:79], v9, s[40:43], s48 offen offset:2048 sc1
  s_waitcnt vmcnt(7)
  v_mfma_f32_16x16x32_bf16 v[40:43], v[148:151], v[80:83], v[40:43]
  s_waitcnt vmcnt(6)
  v_mfma_f32_16x16x32_bf16 v[40:43], v[132:135], v[84:87], v[40:43]
  v_mfma_f32_16x16x32_bf16 v[44:47], v[128:131], v[84:87], v[44:47]
  v_mfma_f32_16x16x32_bf16 v[44:47], v[144:147], v[80:83], v[44:47]
  v_mfma_f32_16x16x32_bf16 v[48:51], v[140:143], v[80:83], v[48:51]
  v_mfma_f32_16x16x32_bf16 v[48:51], v[124:127], v[84:87], v[48:51]
  v_mfma_f32_16x16x32_bf16 v[52:55], v[120:123], v[84:87], v[52:55]
  v_mfma_f32_16x16x32_bf16 v[52:55], v[136:139], v[80:83], v[52:55]
  buffer_load_dwordx4 v[80:83], v9, s[40:43], s48 offen offset:256 sc1
  buffer_load_dwordx4 v[84:87], v9, s[40:43], s48 offen offset:2304 sc1
  s_waitcnt vmcnt(7)
  v_mfma_f32_16x16x32_bf16 v[24:27], v[116:119], v[56:59], v[24:27]
  s_waitcnt vmcnt(6)
  v_mfma_f32_16x16x32_bf16 v[24:27], v[100:103], v[60:63], v[24:27]
  v_mfma_f32_16x16x32_bf16 v[28:31], v[96:99], v[60:63], v[28:31]
  v_mfma_f32_16x16x32_bf16 v[28:31], v[112:115], v[56:59], v[28:31]
  v_mfma_f32_16x16x32_bf16 v[32:35], v[108:111], v[56:59], v[32:35]
  v_mfma_f32_16x16x32_bf16 v[32:35], v[92:95], v[60:63], v[32:35]
  v_mfma_f32_16x16x32_bf16 v[36:39], v[88:91], v[60:63], v[36:39]
  v_mfma_f32_16x16x32_bf16 v[36:39], v[104:107], v[56:59], v[36:39]
  s_mov_b32 s48, 299008
  buffer_load_dwordx4 v[56:59], v9, s[40:43], s48 offen sc1
  buffer_load_dwordx4 v[60:63], v9, s[40:43], s48 offen offset:2048 sc1
  s_waitcnt vmcnt(7)
  v_mfma_f32_16x16x32_bf16 v[40:43], v[116:119], v[64:67], v[40:43]
  s_waitcnt vmcnt(6)
  v_mfma_f32_16x16x32_bf16 v[40:43], v[100:103], v[68:71], v[40:43]
  v_mfma_f32_16x16x32_bf16 v[44:47], v[96:99], v[68:71], v[44:47]
  v_mfma_f32_16x16x32_bf16 v[44:47], v[112:115], v[64:67], v[44:47]
  ds_write_b128 v17, v[24:27] offset:0
  v_mfma_f32_16x16x32_bf16 v[48:51], v[108:111], v[64:67], v[48:51]
  ds_write_b128 v4, v[28:31] offset:8192
  v_mfma_f32_16x16x32_bf16 v[48:51], v[92:95], v[68:71], v[48:51]
  ds_write_b128 v17, v[32:35] offset:16384
  v_mfma_f32_16x16x32_bf16 v[52:55], v[88:91], v[68:71], v[52:55]
  ds_write_b128 v4, v[36:39] offset:24576
  v_mfma_f32_16x16x32_bf16 v[52:55], v[104:107], v[64:67], v[52:55]
  buffer_load_dwordx4 v[64:67], v9, s[40:43], s48 offen offset:256 sc1
  buffer_load_dwordx4 v[68:71], v9, s[40:43], s48 offen offset:2304 sc1
  ds_write_b128 v17, v[40:43] offset:32768
  ds_write_b128 v4, v[44:47] offset:40960
  ds_write_b128 v17, v[48:51] offset:49152
  s_nop 2
  ds_write_b128 v4, v[52:55] offset:57344
  s_mov_b64 exec, 1
  ds_add_u32 v1, v6 offset:5896
  s_mov_b64 exec, -1
  s_waitcnt vmcnt(7)
  v_mfma_f32_16x16x32_bf16 v[24:27], v[72:75], v[216:219], 0
  s_waitcnt vmcnt(6)
  v_mfma_f32_16x16x32_bf16 v[24:27], v[76:79], v[232:235], v[24:27]
  v_mfma_f32_16x16x32_bf16 v[28:31], v[76:79], v[236:239], 0
  v_mfma_f32_16x16x32_bf16 v[28:31], v[72:75], v[220:223], v[28:31]
  v_mfma_f32_16x16x32_bf16 v[32:35], v[72:75], v[224:227], 0
  v_mfma_f32_16x16x32_bf16 v[32:35], v[76:79], v[240:243], v[32:35]
  v_mfma_f32_16x16x32_bf16 v[36:39], v[76:79], v[244:247], 0
  v_mfma_f32_16x16x32_bf16 v[36:39], v[72:75], v[228:231], v[36:39]
  s_mov_b32 s48, 303104
  buffer_load_dwordx4 v[72:75], v9, s[40:43], s48 offen sc1
  s_mov_b32 s48, 294912
  buffer_load_dwordx4 v[76:79], v7, s[40:43], s48 offen sc1
  s_waitcnt vmcnt(7)
  v_mfma_f32_16x16x32_bf16 v[40:43], v[80:83], v[216:219], 0
  s_waitcnt vmcnt(6)
  v_mfma_f32_16x16x32_bf16 v[40:43], v[84:87], v[232:235], v[40:43]
  v_mfma_f32_16x16x32_bf16 v[44:47], v[84:87], v[236:239], 0
  v_mfma_f32_16x16x32_bf16 v[44:47], v[80:83], v[220:223], v[44:47]
  v_mfma_f32_16x16x32_bf16 v[48:51], v[80:83], v[224:227], 0
  v_mfma_f32_16x16x32_bf16 v[48:51], v[84:87], v[240:243], v[48:51]
  v_mfma_f32_16x16x32_bf16 v[52:55], v[84:87], v[244:247], 0
  v_mfma_f32_16x16x32_bf16 v[52:55], v[80:83], v[228:231], v[52:55]
  s_mov_b32 s48, 303104
  buffer_load_dwordx4 v[80:83], v9, s[40:43], s48 offen offset:256 sc1
  s_mov_b32 s48, 294912
  buffer_load_dwordx4 v[84:87], v7, s[40:43], s48 offen offset:256 sc1
  s_waitcnt vmcnt(7)
  v_mfma_f32_16x16x32_bf16 v[24:27], v[56:59], v[248:251], v[24:27]
  s_waitcnt vmcnt(6)
  v_mfma_f32_16x16x32_bf16 v[24:27], v[60:63], v[208:211], v[24:27]
  v_mfma_f32_16x16x32_bf16 v[28:31], v[60:63], v[192:195], v[28:31]
  v_mfma_f32_16x16x32_bf16 v[28:31], v[56:59], v[252:255], v[28:31]
  v_mfma_f32_16x16x32_bf16 v[32:35], v[56:59], v[200:203], v[32:35]
  v_mfma_f32_16x16x32_bf16 v[32:35], v[60:63], v[188:191], v[32:35]
  v_mfma_f32_16x16x32_bf16 v[36:39], v[60:63], v[184:187], v[36:39]
  v_mfma_f32_16x16x32_bf16 v[36:39], v[56:59], v[204:207], v[36:39]
  buffer_load_dwordx4 v[56:59], v7, s[40:43], s48 offen offset:2048 sc1
  s_mov_b32 s48, 299008
  buffer_load_dwordx4 v[60:63], v7, s[40:43], s48 offen sc1
  s_waitcnt vmcnt(7)
  v_mfma_f32_16x16x32_bf16 v[40:43], v[64:67], v[248:251], v[40:43]
  s_waitcnt vmcnt(6)
  v_mfma_f32_16x16x32_bf16 v[40:43], v[68:71], v[208:211], v[40:43]
  v_mfma_f32_16x16x32_bf16 v[44:47], v[68:71], v[192:195], v[44:47]
  v_mfma_f32_16x16x32_bf16 v[44:47], v[64:67], v[252:255], v[44:47]
  v_mfma_f32_16x16x32_bf16 v[48:51], v[64:67], v[200:203], v[48:51]
  v_mfma_f32_16x16x32_bf16 v[48:51], v[68:71], v[188:191], v[48:51]
  v_mfma_f32_16x16x32_bf16 v[52:55], v[68:71], v[184:187], v[52:55]
  v_mfma_f32_16x16x32_bf16 v[52:55], v[64:67], v[204:207], v[52:55]
  s_mov_b32 s48, 294912
  buffer_load_dwordx4 v[64:67], v7, s[40:43], s48 offen offset:2304 sc1
  s_mov_b32 s48, 299008
  buffer_load_dwordx4 v[68:71], v7, s[40:43], s48 offen offset:256 sc1
  ds_read_b32 v3, v19 offset:5896
  s_waitcnt vmcnt(7)
  v_mfma_f32_16x16x32_bf16 v[24:27], v[72:75], v[180:183], v[24:27]
  s_waitcnt vmcnt(6)
  v_mfma_f32_16x16x32_bf16 v[24:27], v[76:79], v[164:167], v[24:27]
  v_mfma_f32_16x16x32_bf16 v[28:31], v[76:79], v[160:163], v[28:31]
  v_mfma_f32_16x16x32_bf16 v[28:31], v[72:75], v[176:179], v[28:31]
  v_mfma_f32_16x16x32_bf16 v[32:35], v[72:75], v[172:175], v[32:35]
  v_mfma_f32_16x16x32_bf16 v[32:35], v[76:79], v[156:159], v[32:35]
  v_mfma_f32_16x16x32_bf16 v[36:39], v[76:79], v[152:155], v[36:39]
  v_mfma_f32_16x16x32_bf16 v[36:39], v[72:75], v[168:171], v[36:39]
  buffer_load_dwordx4 v[72:75], v7, s[40:43], s48 offen offset:2048 sc1
  s_mov_b32 s48, 303104
  buffer_load_dwordx4 v[76:79], v7, s[40:43], s48 offen sc1
  s_waitcnt lgkmcnt(0)
  v_readfirstlane_b32 s66, v3
  s_nop 0
  s_cmp_ge_u32 s66, 8
  s_cbranch_scc1 L_P0v
L_P0u:
  s_sleep 1
  ds_read_b32 v3, v19 offset:5896
  s_waitcnt lgkmcnt(0)
  v_readfirstlane_b32 s66, v3
  s_nop 0
  s_cmp_ge_u32 s66, 8
  s_cbranch_scc0 L_P0u
L_P0v:
  ds_read_b128 v[216:219], v18 offset:0
  ds_read_b128 v[220:223], v18 offset:1024
  ds_read_b128 v[224:227], v18 offset:2048
  ds_read_b128 v[228:231], v18 offset:3072
  ds_read_b128 v[240:243], v18 offset:6144
  ds_read_b128 v[244:247], v18 offset:7168
  ds_read_b128 v[232:235], v18 offset:4096
  ds_read_b128 v[236:239], v18 offset:5120
  s_waitcnt vmcnt(7)
  v_mfma_f32_16x16x32_bf16 v[40:43], v[80:83], v[180:183], v[40:43]
  v_lshlrev_b32 v12, 16, v20
  v_and_b32 v13, 0xffff0000, v20
  s_waitcnt vmcnt(6)
  v_mfma_f32_16x16x32_bf16 v[40:43], v[84:87], v[164:167], v[40:43]
  v_lshlrev_b32 v14, 16, v21
  v_and_b32 v15, 0xffff0000, v21
  v_mfma_f32_16x16x32_bf16 v[44:47], v[84:87], v[160:163], v[44:47]
  s_waitcnt lgkmcnt(6)
  v_add_f32 v216, v220, v216
  v_add_f32_e64 v217, v221, v217
  v_mfma_f32_16x16x32_bf16 v[44:47], v[80:83], v[176:179], v[44:47]
  v_add_f32_e64 v218, v222, v218
  v_mfma_f32_16x16x32_bf16 v[48:51], v[80:83], v[172:175], v[48:51]
  v_add_f32 v219, v223, v219
  s_waitcnt lgkmcnt(4)
  v_add_f32_e64 v224, v228, v224
  v_mfma_f32_16x16x32_bf16 v[48:51], v[84:87], v[156:159], v[48:51]
  v_add_f32 v225, v229, v225
  v_add_f32 v226, v230, v226
  v_mfma_f32_16x16x32_bf16 v[52:55], v[84:87], v[152:155], v[52:55]
  v_add_f32 v227, v231, v227
  s_waitcnt lgkmcnt(2)
  v_add_f32_e64 v240, v244, v240
  v_mfma_f32_16x16x32_bf16 v[52:55], v[80:83], v[168:171], v[52:55]
  v_add_f32_e64 v241, v245, v241
  s_mov_b32 s48, 299008
  buffer_load_dwordx4 v[80:83], v7, s[40:43], s48 offen offset:2304 sc1
  s_mov_b32 s48, 303104
  buffer_load_dwordx4 v[84:87], v7, s[40:43], s48 offen offset:256 sc1
  s_waitcnt vmcnt(7)
  v_mfma_f32_16x16x32_bf16 v[24:27], v[56:59], v[148:151], v[24:27]
  v_add_f32 v242, v246, v242
  v_add_f32 v243, v247, v243
  s_waitcnt vmcnt(6)
  v_mfma_f32_16x16x32_bf16 v[24:27], v[60:63], v[132:135], v[24:27]
  v_add_f32 v216, v224, v216
  v_add_f32 v217, v225, v217
  v_mfma_f32_16x16x32_bf16 v[28:31], v[60:63], v[128:131], v[28:31]
  v_add_f32 v218, v226, v218
  v_add_f32 v219, v227, v219
  v_mfma_f32_16x16x32_bf16 v[28:31], v[56:59], v[144:147], v[28:31]
  v_add_f32_e64 v216, v240, v216
  v_mfma_f32_16x16x32_bf16 v[32:35], v[56:59], v[140:143], v[32:35]
  v_add_f32 v217, v241, v217
  v_add_f32 v218, v242, v218
  v_mfma_f32_16x16x32_bf16 v[32:35], v[60:63], v[124:127], v[32:35]
  v_add_f32 v219, v243, v219
  v_mul_f32 v220, s56, v216
  v_mfma_f32_16x16x32_bf16 v[36:39], v[60:63], v[120:123], v[36:39]
  v_mul_f32 v221, s56, v217
  v_mul_f32 v222, s56, v218
  v_mfma_f32_16x16x32_bf16 v[36:39], v[56:59], v[136:139], v[36:39]
  v_mul_f32 v223, s56, v219
  s_waitcnt vmcnt(5)
  v_mfma_f32_16x16x32_bf16 v[40:43], v[64:67], v[148:151], v[40:43]
  v_exp_f32 v220, v220
  v_exp_f32_e64 v221, v221
  s_waitcnt vmcnt(4)
  v_mfma_f32_16x16x32_bf16 v[40:43], v[68:71], v[132:135], v[40:43]
  v_exp_f32 v222, v222
  v_exp_f32 v223, v223
  v_mfma_f32_16x16x32_bf16 v[44:47], v[68:71], v[128:131], v[44:47]
  s_waitcnt lgkmcnt(0)
  v_add_f32 v232, v236, v232
  v_add_f32_e64 v233, v237, v233
  v_mfma_f32_16x16x32_bf16 v[44:47], v[64:67], v[144:147], v[44:47]
  v_add_f32_e64 v234, v238, v234
  v_mfma_f32_16x16x32_bf16 v[48:51], v[64:67], v[140:143], v[48:51]
  v_add_f32 v235, v239, v235
  v_add_f32 v220, 1.0, v220
  v_mfma_f32_16x16x32_bf16 v[48:51], v[68:71], v[124:127], v[48:51]
  v_add_f32 v221, 1.0, v221
  v_add_f32 v222, 1.0, v222
  v_mfma_f32_16x16x32_bf16 v[52:55], v[68:71], v[120:123], v[52:55]
  v_add_f32 v223, 1.0, v223
  v_rcp_f32 v220, v220
  v_mfma_f32_16x16x32_bf16 v[52:55], v[64:67], v[136:139], v[52:55]
  v_rcp_f32 v221, v221
  s_waitcnt vmcnt(3)
  v_mfma_f32_16x16x32_bf16 v[24:27], v[72:75], v[116:119], v[24:27]
  v_rcp_f32 v222, v222
  v_rcp_f32_e64 v223, v223
  s_waitcnt vmcnt(2)
  v_mfma_f32_16x16x32_bf16 v[24:27], v[76:79], v[100:103], v[24:27]
  v_mul_f32 v216, v232, v216
  v_mul_f32 v217, v233, v217
  v_mfma_f32_16x16x32_bf16 v[28:31], v[76:79], v[96:99], v[28:31]
  v_mul_f32_e64 v218, v234, v218
  v_mfma_f32_16x16x32_bf16 v[28:31], v[72:75], v[112:115], v[28:31]
  v_mul_f32_e64 v219, v235, v219
  v_fma_f32 v12, v216, v220, v12
  v_mfma_f32_16x16x32_bf16 v[32:35], v[72:75], v[108:111], v[32:35]
  v_fma_f32 v13, v217, v221, v13
  v_fma_f32 v14, v218, v222, v14
  v_mfma_f32_16x16x32_bf16 v[32:35], v[76:79], v[92:95], v[32:35]
  v_fma_f32 v15, v219, v223, v15
  v_mfma_f32_16x16x32_bf16 v[36:39], v[76:79], v[88:91], v[36:39]
  v_cvt_pk_bf16_f32 v20, v12, v13
  v_cvt_pk_bf16_f32 v21, v14, v15
  v_mfma_f32_16x16x32_bf16 v[36:39], v[72:75], v[104:107], v[36:39]
  buffer_store_dwordx2 v[20:21], v8, s[12:15], 0 offen
  s_add_u32 m0, s53, 6144
  s_waitcnt vmcnt(2)
  v_mfma_f32_16x16x32_bf16 v[40:43], v[80:83], v[116:119], v[40:43]
  s_waitcnt vmcnt(1)
  v_mfma_f32_16x16x32_bf16 v[40:43], v[84:87], v[100:103], v[40:43]
  v_mfma_f32_16x16x32_bf16 v[44:47], v[84:87], v[96:99], v[44:47]
  v_mfma_f32_16x16x32_bf16 v[44:47], v[80:83], v[112:115], v[44:47]
  ds_write_addtid_b32 v24 offset:0
  ds_write_addtid_b32 v25 offset:256
  ds_write_addtid_b32 v26 offset:512
  ds_write_addtid_b32 v27 offset:768
  v_mfma_f32_16x16x32_bf16 v[48:51], v[80:83], v[108:111], v[48:51]
  ds_write_addtid_b32 v28 offset:8192
  ds_write_addtid_b32 v29 offset:8448
  ds_write_addtid_b32 v30 offset:8704
  v_mfma_f32_16x16x32_bf16 v[48:51], v[84:87], v[92:95], v[48:51]
  ds_write_addtid_b32 v31 offset:8960
  ds_write_addtid_b32 v32 offset:16384
  ds_write_addtid_b32 v33 offset:16640
  v_mfma_f32_16x16x32_bf16 v[52:55], v[84:87], v[88:91], v[52:55]
  ds_write_addtid_b32 v34 offset:16896
  ds_write_addtid_b32 v35 offset:17152
  ds_write_addtid_b32 v36 offset:24576
  v_mfma_f32_16x16x32_bf16 v[52:55], v[80:83], v[104:107], v[52:55]
  ds_write_addtid_b32 v37 offset:24832
  ds_write_addtid_b32 v38 offset:25088
  ds_write_addtid_b32 v39 offset:25344
  ds_write_addtid_b32 v40 offset:36864
  ds_write_addtid_b32 v41 offset:37120
  ds_write_addtid_b32 v42 offset:37376
  ds_write_addtid_b32 v43 offset:37632
  ds_write_addtid_b32 v44 offset:45056
  ds_write_addtid_b32 v45 offset:45312
  ds_write_addtid_b32 v46 offset:45568
  ds_write_addtid_b32 v47 offset:45824
  ds_write_addtid_b32 v48 offset:53248
  ds_write_addtid_b32 v49 offset:53504
  ds_write_addtid_b32 v50 offset:53760
  ds_write_addtid_b32 v51 offset:54016
  ds_write_addtid_b32 v52 offset:61440
  ds_write_addtid_b32 v53 offset:61696
  ds_write_addtid_b32 v54 offset:61952
  ds_write_addtid_b32 v55 offset:62208
  v_lshlrev_b32_e64 v12, 16, v22
  v_and_b32 v13, 0xffff0000, v22
  v_lshlrev_b32_e64 v14, 16, v23
  v_and_b32 v15, 0xffff0000, v23
  s_waitcnt lgkmcnt(0)
  s_barrier
  ds_read_b128 v[216:219], v10 offset:6144
  ds_read_b128 v[220:223], v10 offset:7168
  ds_read_b128 v[224:227], v10 offset:8192
  ds_read_b128 v[228:231], v10 offset:9216
  ds_read_b128 v[240:243], v10 offset:12288
  ds_read_b128 v[244:247], v10 offset:13312
  ds_read_b128 v[232:235], v10 offset:10240
  ds_read_b128 v[236:239], v10 offset:11264
  s_waitcnt lgkmcnt(6)
  v_pk_add_f32 v[216:217], v[216:217], v[220:221]
  v_pk_add_f32 v[218:219], v[218:219], v[222:223]
  s_waitcnt lgkmcnt(4)
  v_pk_add_f32 v[224:225], v[224:225], v[228:229]
  v_pk_add_f32 v[226:227], v[226:227], v[230:231]
  s_waitcnt lgkmcnt(2)
  v_pk_add_f32 v[240:241], v[240:241], v[244:245]
  v_pk_add_f32 v[242:243], v[242:243], v[246:247]
  v_pk_add_f32 v[216:217], v[216:217], v[224:225]
  v_pk_add_f32 v[218:219], v[218:219], v[226:227]
  v_pk_add_f32 v[216:217], v[216:217], v[240:241]
  v_pk_add_f32 v[218:219], v[218:219], v[242:243]
  v_pk_mul_f32 v[220:221], v[216:217], s[56:57] op_sel_hi:[1,0]
  v_pk_mul_f32 v[222:223], v[218:219], s[56:57] op_sel_hi:[1,0]
  v_exp_f32 v220, v220
  v_exp_f32 v221, v221
  v_exp_f32 v222, v222
  v_exp_f32 v223, v223
  s_waitcnt lgkmcnt(0)
  v_pk_add_f32 v[232:233], v[232:233], v[236:237]
  v_pk_add_f32 v[234:235], v[234:235], v[238:239]
  v_pk_add_f32 v[220:221], v[220:221], 1.0 op_sel_hi:[1,0]
  v_pk_add_f32 v[222:223], v[222:223], 1.0 op_sel_hi:[1,0]
  v_rcp_f32 v220, v220
  v_rcp_f32 v221, v221
  v_rcp_f32 v222, v222
  v_rcp_f32 v223, v223
  v_pk_mul_f32 v[216:217], v[216:217], v[232:233]
  v_pk_mul_f32 v[218:219], v[218:219], v[234:235]
  v_pk_fma_f32 v[12:13], v[216:217], v[220:221], v[12:13]
  v_pk_fma_f32 v[14:15], v[218:219], v[222:223], v[14:15]
  v_cvt_pk_bf16_f32 v22, v12, v13
  v_cvt_pk_bf16_f32 v23, v14, v15
  buffer_store_dwordx2 v[22:23], v11, s[12:15], 0 offen
  s_endpgm
.p2align 12
L_P1wA:
  s_branch L_A1w0
L_P1wB:
  s_branch L_B1w0
L_P1:
  s_lshl_b32 s66, s5, 8
  v_add_u32_e64 v7, s66, v9
  s_waitcnt lgkmcnt(0)
  s_and_b32 s28, s28, s29
  s_and_b32 s28, s28, s30
  s_and_b32 s28, s28, s31
  s_cbranch_scc1 L_P1g0
  s_mov_b32 s68, 262144
L_P1p0:
  s_sleep 3
  s_buffer_load_dwordx4 s[28:31], s[40:43], s65 offset:0 glc
  s_sub_u32 s68, s68, 1
  s_waitcnt lgkmcnt(0)
  s_cbranch_scc1 L_P1g0
  s_and_b32 s28, s28, s29
  s_and_b32 s28, s28, s30
  s_and_b32 s28, s28, s31
  s_cbranch_scc0 L_P1p0
L_P1g0:
  s_mov_b32 s48, 0
  buffer_load_dwordx4 v[56:59], v9, s[40:43], s48 offen sc1
  buffer_load_dwordx4 v[60:63], v9, s[40:43], s48 offen offset:2048 sc1
  buffer_load_dwordx4 v[64:67], v9, s[40:43], s48 offen offset:256 sc1
  buffer_load_dwordx4 v[68:71], v9, s[40:43], s48 offen offset:2304 sc1
  s_mov_b32 s48, 4096
  buffer_load_dwordx4 v[72:75], v9, s[40:43], s48 offen sc1
  buffer_load_dwordx4 v[76:79], v9, s[40:43], s48 offen offset:2048 sc1
  s_add_u32 s69, s53, 81920
  v_lshrrev_b32 v3, 4, v1
  v_lshl_add_u32 v5, v3, 5, v2
  v_and_b32 v5, 0xf0, v5
  v_lshl_add_u32 v5, v3, 8, v5
  v_add_u32_e64 v17, s69, v5
  v_xor_b32 v4, 128, v17
  v_and_b32 v3, 7, v0
  v_lshrrev_b32 v5, 4, v0
  v_lshl_add_u32 v3, v3, 1, v5
  v_and_b32 v3, 15, v3
  v_lshlrev_b32 v18, 4, v3
  v_and_b32_e64 v3, 3, v0
  v_lshl_add_u32 v18, v3, 8, v18
  v_bfe_u32 v5, v0, 2, 2
  v_lshl_add_u32 v18, v5, 13, v18
  v_add_u32 v18, 114688, v18
  s_lshl_b32 s66, s45, 8
  v_lshl_add_u32 v10, v5, 13, s66
  v_lshl_add_u32 v10, v16, 6, v10
  v_lshl_add_u32 v10, v3, 4, v10
  v_mov_b32 v19, 0
  s_mov_b32 s56, 0xbfb8aa3b
  s_waitcnt vmcnt(5)
  v_mfma_f32_16x16x32_bf16 v[24:27], v[184:187], v[56:59], 0
  s_waitcnt vmcnt(4)
  v_mfma_f32_16x16x32_bf16 v[24:27], v[200:203], v[60:63], v[24:27]
  v_mfma_f32_16x16x32_bf16 v[28:31], v[204:207], v[60:63], 0
  v_mfma_f32_16x16x32_bf16 v[28:31], v[188:191], v[56:59], v[28:31]
  v_mfma_f32_16x16x32_bf16 v[32:35], v[192:195], v[56:59], 0
  v_mfma_f32_16x16x32_bf16 v[32:35], v[216:219], v[60:63], v[32:35]
  v_mfma_f32_16x16x32_bf16 v[36:39], v[220:223], v[60:63], 0
  v_mfma_f32_16x16x32_bf16 v[36:39], v[196:199], v[56:59], v[36:39]
  buffer_load_dwordx4 v[56:59], v9, s[40:43], s48 offen offset:256 sc1
  buffer_load_dwordx4 v[60:63], v9, s[40:43], s48 offen offset:2304 sc1
  s_waitcnt vmcnt(5)
  v_mfma_f32_16x16x32_bf16 v[40:43], v[184:187], v[64:67], 0
  s_waitcnt vmcnt(4)
  v_mfma_f32_16x16x32_bf16 v[40:43], v[200:203], v[68:71], v[40:43]
  v_mfma_f32_16x16x32_bf16 v[44:47], v[204:207], v[68:71], 0
  v_mfma_f32_16x16x32_bf16 v[44:47], v[188:191], v[64:67], v[44:47]
  v_mfma_f32_16x16x32_bf16 v[48:51], v[192:195], v[64:67], 0
  v_mfma_f32_16x16x32_bf16 v[48:51], v[216:219], v[68:71], v[48:51]
  v_mfma_f32_16x16x32_bf16 v[52:55], v[220:223], v[68:71], 0
  v_mfma_f32_16x16x32_bf16 v[52:55], v[196:199], v[64:67], v[52:55]
  s_mov_b32 s48, 0
  buffer_load_dwordx4 v[64:67], v7, s[40:43], s48 offen sc1
  buffer_load_dwordx4 v[68:71], v7, s[40:43], s48 offen offset:2048 sc1
  s_waitcnt vmcnt(5)
  v_mfma_f32_16x16x32_bf16 v[24:27], v[224:227], v[72:75], v[24:27]
  s_waitcnt vmcnt(4)
  v_mfma_f32_16x16x32_bf16 v[24:27], v[240:243], v[76:79], v[24:27]
  v_mfma_f32_16x16x32_bf16 v[28:31], v[244:247], v[76:79], v[28:31]
  v_mfma_f32_16x16x32_bf16 v[28:31], v[228:231], v[72:75], v[28:31]
  v_mfma_f32_16x16x32_bf16 v[32:35], v[232:235], v[72:75], v[32:35]
  v_mfma_f32_16x16x32_bf16 v[32:35], v[248:251], v[76:79], v[32:35]
  v_mfma_f32_16x16x32_bf16 v[36:39], v[252:255], v[76:79], v[36:39]
  v_mfma_f32_16x16x32_bf16 v[36:39], v[236:239], v[72:75], v[36:39]
  buffer_load_dwordx4 v[72:75], v7, s[40:43], s48 offen offset:256 sc1
  buffer_load_dwordx4 v[76:79], v7, s[40:43], s48 offen offset:2304 sc1
  s_waitcnt vmcnt(5)
  v_mfma_f32_16x16x32_bf16 v[40:43], v[224:227], v[56:59], v[40:43]
  s_waitcnt vmcnt(4)
  v_mfma_f32_16x16x32_bf16 v[40:43], v[240:243], v[60:63], v[40:43]
  v_mfma_f32_16x16x32_bf16 v[44:47], v[244:247], v[60:63], v[44:47]
  v_mfma_f32_16x16x32_bf16 v[44:47], v[228:231], v[56:59], v[44:47]
  v_mfma_f32_16x16x32_bf16 v[48:51], v[232:235], v[56:59], v[48:51]
  v_mfma_f32_16x16x32_bf16 v[48:51], v[248:251], v[60:63], v[48:51]
  v_mfma_f32_16x16x32_bf16 v[52:55], v[252:255], v[60:63], v[52:55]
  v_mfma_f32_16x16x32_bf16 v[52:55], v[236:239], v[56:59], v[52:55]
  s_buffer_load_dwordx4 s[28:31], s[40:43], s65 offset:128 glc
  s_mov_b32 s48, 4096
  buffer_load_dwordx4 v[56:59], v7, s[40:43], s48 offen sc1
  buffer_load_dwordx4 v[60:63], v7, s[40:43], s48 offen offset:2048 sc1
  s_waitcnt vmcnt(5)
  v_mfma_f32_16x16x32_bf16 v[24:27], v[104:107], v[64:67], v[24:27]
  s_waitcnt vmcnt(4)
  v_mfma_f32_16x16x32_bf16 v[24:27], v[120:123], v[68:71], v[24:27]
  v_mfma_f32_16x16x32_bf16 v[28:31], v[124:127], v[68:71], v[28:31]
  v_mfma_f32_16x16x32_bf16 v[28:31], v[108:111], v[64:67], v[28:31]
  v_mfma_f32_16x16x32_bf16 v[32:35], v[112:115], v[64:67], v[32:35]
  v_mfma_f32_16x16x32_bf16 v[32:35], v[128:131], v[68:71], v[32:35]
  v_mfma_f32_16x16x32_bf16 v[36:39], v[132:135], v[68:71], v[36:39]
  v_mfma_f32_16x16x32_bf16 v[36:39], v[116:119], v[64:67], v[36:39]
  buffer_load_dwordx4 v[64:67], v7, s[40:43], s48 offen offset:256 sc1
  buffer_load_dwordx4 v[68:71], v7, s[40:43], s48 offen offset:2304 sc1
  s_waitcnt vmcnt(5)
  v_mfma_f32_16x16x32_bf16 v[40:43], v[104:107], v[72:75], v[40:43]
  s_waitcnt vmcnt(4)
  v_mfma_f32_16x16x32_bf16 v[40:43], v[120:123], v[76:79], v[40:43]
  v_mfma_f32_16x16x32_bf16 v[44:47], v[124:127], v[76:79], v[44:47]
  v_mfma_f32_16x16x32_bf16 v[44:47], v[108:111], v[72:75], v[44:47]
  v_mfma_f32_16x16x32_bf16 v[48:51], v[112:115], v[72:75], v[48:51]
  v_mfma_f32_16x16x32_bf16 v[48:51], v[128:131], v[76:79], v[48:51]
  v_mfma_f32_16x16x32_bf16 v[52:55], v[132:135], v[76:79], v[52:55]
  v_mfma_f32_16x16x32_bf16 v[52:55], v[116:119], v[72:75], v[52:55]
  s_waitcnt lgkmcnt(0)
  s_and_b32 s28, s28, s29
  s_and_b32 s28, s28, s30
  s_and_b32 s28, s28, s31
  s_cbranch_scc1 L_P1g1
  s_mov_b32 s68, 262144
L_P1p1:
  s_sleep 3
  s_buffer_load_dwordx4 s[28:31], s[40:43], s65 offset:128 glc
  s_sub_u32 s68, s68, 1
  s_waitcnt lgkmcnt(0)
  s_cbranch_scc1 L_P1g1
  s_and_b32 s28, s28, s29
  s_and_b32 s28, s28, s30
  s_and_b32 s28, s28, s31
  s_cbranch_scc0 L_P1p1
L_P1g1:
  s_mov_b32 s48, 294912
  buffer_load_dwordx4 v[72:75], v9, s[40:43], s48 offen sc1
  buffer_load_dwordx4 v[76:79], v9, s[40:43], s48 offen offset:2048 sc1
  s_setprio 0
  s_waitcnt vmcnt(5)
  v_mfma_f32_16x16x32_bf16 v[24:27], v[136:139], v[56:59], v[24:27]
  s_waitcnt vmcnt(4)
  v_mfma_f32_16x16x32_bf16 v[24:27], v[152:155], v[60:63], v[24:27]
  v_mfma_f32_16x16x32_bf16 v[28:31], v[156:159], v[60:63], v[28:31]
  v_mfma_f32_16x16x32_bf16 v[28:31], v[140:143], v[56:59], v[28:31]
  v_mfma_f32_16x16x32_bf16 v[32:35], v[144:147], v[56:59], v[32:35]
  v_mfma_f32_16x16x32_bf16 v[32:35], v[160:163], v[60:63], v[32:35]
  v_mfma_f32_16x16x32_bf16 v[36:39], v[164:167], v[60:63], v[36:39]
  v_mfma_f32_16x16x32_bf16 v[36:39], v[148:151], v[56:59], v[36:39]
  buffer_load_dwordx4 v[56:59], v9, s[40:43], s48 offen offset:256 sc1
  buffer_load_dwordx4 v[60:63], v9, s[40:43], s48 offen offset:2304 sc1
  s_waitcnt vmcnt(5)
  v_mfma_f32_16x16x32_bf16 v[40:43], v[136:139], v[64:67], v[40:43]
  s_waitcnt vmcnt(4)
  v_mfma_f32_16x16x32_bf16 v[40:43], v[152:155], v[68:71], v[40:43]
  v_mfma_f32_16x16x32_bf16 v[44:47], v[156:159], v[68:71], v[44:47]
  v_mfma_f32_16x16x32_bf16 v[44:47], v[140:143], v[64:67], v[44:47]
  ds_write_b128 v17, v[24:27] offset:0
  v_mfma_f32_16x16x32_bf16 v[48:51], v[144:147], v[64:67], v[48:51]
  ds_write_b128 v4, v[28:31] offset:8192
  v_mfma_f32_16x16x32_bf16 v[48:51], v[160:163], v[68:71], v[48:51]
  ds_write_b128 v17, v[32:35] offset:16384
  v_mfma_f32_16x16x32_bf16 v[52:55], v[164:167], v[68:71], v[52:55]
  ds_write_b128 v4, v[36:39] offset:24576
  v_mfma_f32_16x16x32_bf16 v[52:55], v[148:151], v[64:67], v[52:55]
  s_mov_b32 s48, 299008
  buffer_load_dwordx4 v[64:67], v9, s[40:43], s48 offen sc1
  buffer_load_dwordx4 v[68:71], v9, s[40:43], s48 offen offset:2048 sc1
  ds_write_b128 v17, v[40:43] offset:32768
  ds_write_b128 v4, v[44:47] offset:40960
  ds_write_b128 v17, v[48:51] offset:49152
  s_nop 1
  ds_write_b128 v4, v[52:55] offset:57344
  s_mov_b64 exec, 1
  ds_add_u32 v1, v6 offset:5896
  s_mov_b64 exec, -1
  s_waitcnt vmcnt(5)
  v_mfma_f32_16x16x32_bf16 v[24:27], v[72:75], v[184:187], 0
  s_waitcnt vmcnt(4)
  v_mfma_f32_16x16x32_bf16 v[24:27], v[76:79], v[200:203], v[24:27]
  v_mfma_f32_16x16x32_bf16 v[28:31], v[76:79], v[204:207], 0
  v_mfma_f32_16x16x32_bf16 v[28:31], v[72:75], v[188:191], v[28:31]
  v_mfma_f32_16x16x32_bf16 v[32:35], v[72:75], v[192:195], 0
  v_mfma_f32_16x16x32_bf16 v[32:35], v[76:79], v[216:219], v[32:35]
  v_mfma_f32_16x16x32_bf16 v[36:39], v[76:79], v[220:223], 0
  v_mfma_f32_16x16x32_bf16 v[36:39], v[72:75], v[196:199], v[36:39]
  buffer_load_dwordx4 v[72:75], v9, s[40:43], s48 offen offset:256 sc1
  buffer_load_dwordx4 v[76:79], v9, s[40:43], s48 offen offset:2304 sc1
  s_waitcnt vmcnt(5)
  v_mfma_f32_16x16x32_bf16 v[40:43], v[56:59], v[184:187], 0
  s_waitcnt vmcnt(4)
  v_mfma_f32_16x16x32_bf16 v[40:43], v[60:63], v[200:203], v[40:43]
  v_mfma_f32_16x16x32_bf16 v[44:47], v[60:63], v[204:207], 0
  v_mfma_f32_16x16x32_bf16 v[44:47], v[56:59], v[188:191], v[44:47]
  v_mfma_f32_16x16x32_bf16 v[48:51], v[56:59], v[192:195], 0
  v_mfma_f32_16x16x32_bf16 v[48:51], v[60:63], v[216:219], v[48:51]
  v_mfma_f32_16x16x32_bf16 v[52:55], v[60:63], v[220:223], 0
  v_mfma_f32_16x16x32_bf16 v[52:55], v[56:59], v[196:199], v[52:55]
  s_mov_b32 s48, 294912
  buffer_load_dwordx4 v[56:59], v7, s[40:43], s48 offen sc1
  buffer_load_dwordx4 v[60:63], v7, s[40:43], s48 offen offset:2048 sc1
  ds_read_b32 v3, v19 offset:5896
  s_waitcnt vmcnt(5)
  v_mfma_f32_16x16x32_bf16 v[24:27], v[64:67], v[224:227], v[24:27]
  s_waitcnt vmcnt(4)
  v_mfma_f32_16x16x32_bf16 v[24:27], v[68:71], v[240:243], v[24:27]
  v_mfma_f32_16x16x32_bf16 v[28:31], v[68:71], v[244:247], v[28:31]
  v_mfma_f32_16x16x32_bf16 v[28:31], v[64:67], v[228:231], v[28:31]
  v_mfma_f32_16x16x32_bf16 v[32:35], v[64:67], v[232:235], v[32:35]
  v_mfma_f32_16x16x32_bf16 v[32:35], v[68:71], v[248:251], v[32:35]
  v_mfma_f32_16x16x32_bf16 v[36:39], v[68:71], v[252:255], v[36:39]
  v_mfma_f32_16x16x32_bf16 v[36:39], v[64:67], v[236:239], v[36:39]
  buffer_load_dwordx4 v[64:67], v7, s[40:43], s48 offen offset:256 sc1
  buffer_load_dwordx4 v[68:71], v7, s[40:43], s48 offen offset:2304 sc1
  s_waitcnt lgkmcnt(0)
  v_readfirstlane_b32 s66, v3
  s_nop 0
  s_cmp_ge_u32 s66, 8
  s_cbranch_scc1 L_P1v
L_P1u:
  s_sleep 1
  ds_read_b32 v3, v19 offset:5896
  s_waitcnt lgkmcnt(0)
  v_readfirstlane_b32 s66, v3
  s_nop 0
  s_cmp_ge_u32 s66, 8
  s_cbranch_scc0 L_P1u
L_P1v:
  ds_read_b128 v[184:187], v18 offset:0
  ds_read_b128 v[188:191], v18 offset:1024
  ds_read_b128 v[192:195], v18 offset:2048
  ds_read_b128 v[196:199], v18 offset:3072
  ds_read_b128 v[216:219], v18 offset:6144
  ds_read_b128 v[220:223], v18 offset:7168
  ds_read_b128 v[200:203], v18 offset:4096
  ds_read_b128 v[204:207], v18 offset:5120
  s_waitcnt vmcnt(5)
  v_mfma_f32_16x16x32_bf16 v[40:43], v[72:75], v[224:227], v[40:43]
  v_lshlrev_b32_e64 v12, 16, v20
  v_and_b32 v13, 0xffff0000, v20
  s_waitcnt vmcnt(4)
  v_mfma_f32_16x16x32_bf16 v[40:43], v[76:79], v[240:243], v[40:43]
  v_lshlrev_b32 v14, 16, v21
  v_and_b32 v15, 0xffff0000, v21
  v_mfma_f32_16x16x32_bf16 v[44:47], v[76:79], v[244:247], v[44:47]
  s_waitcnt lgkmcnt(6)
  v_add_f32 v184, v188, v184
  v_add_f32_e64 v185, v189, v185
  v_mfma_f32_16x16x32_bf16 v[44:47], v[72:75], v[228:231], v[44:47]
  v_add_f32_e64 v186, v190, v186
  v_mfma_f32_16x16x32_bf16 v[48:51], v[72:75], v[232:235], v[48:51]
  v_add_f32 v187, v191, v187
  s_waitcnt lgkmcnt(4)
  v_add_f32_e64 v192, v196, v192
  v_mfma_f32_16x16x32_bf16 v[48:51], v[76:79], v[248:251], v[48:51]
  v_add_f32 v193, v197, v193
  v_add_f32 v194, v198, v194
  v_mfma_f32_16x16x32_bf16 v[52:55], v[76:79], v[252:255], v[52:55]
  v_add_f32 v195, v199, v195
  s_waitcnt lgkmcnt(2)
  v_add_f32_e64 v216, v220, v216
  v_mfma_f32_16x16x32_bf16 v[52:55], v[72:75], v[236:239], v[52:55]
  v_add_f32_e64 v217, v221, v217
  s_mov_b32 s48, 299008
  buffer_load_dwordx4 v[72:75], v7, s[40:43], s48 offen sc1
  buffer_load_dwordx4 v[76:79], v7, s[40:43], s48 offen offset:2048 sc1
  s_waitcnt vmcnt(5)
  v_mfma_f32_16x16x32_bf16 v[24:27], v[56:59], v[104:107], v[24:27]
  v_add_f32 v218, v222, v218
  v_add_f32 v219, v223, v219
  s_waitcnt vmcnt(4)
  v_mfma_f32_16x16x32_bf16 v[24:27], v[60:63], v[120:123], v[24:27]
  v_add_f32 v184, v192, v184
  v_add_f32 v185, v193, v185
  v_mfma_f32_16x16x32_bf16 v[28:31], v[60:63], v[124:127], v[28:31]
  v_add_f32 v186, v194, v186
  v_add_f32 v187, v195, v187
  v_mfma_f32_16x16x32_bf16 v[28:31], v[56:59], v[108:111], v[28:31]
  v_add_f32_e64 v184, v216, v184
  v_mfma_f32_16x16x32_bf16 v[32:35], v[56:59], v[112:115], v[32:35]
  v_add_f32 v185, v217, v185
  v_add_f32 v186, v218, v186
  v_mfma_f32_16x16x32_bf16 v[32:35], v[60:63], v[128:131], v[32:35]
  v_add_f32 v187, v219, v187
  v_mul_f32 v188, s56, v184
  v_mfma_f32_16x16x32_bf16 v[36:39], v[60:63], v[132:135], v[36:39]
  v_mul_f32 v189, s56, v185
  v_mul_f32 v190, s56, v186
  v_mfma_f32_16x16x32_bf16 v[36:39], v[56:59], v[116:119], v[36:39]
  v_mul_f32_e64 v191, s56, v187
  buffer_load_dwordx4 v[56:59], v7, s[40:43], s48 offen offset:256 sc1
  buffer_load_dwordx4 v[60:63], v7, s[40:43], s48 offen offset:2304 sc1
  s_waitcnt vmcnt(5)
  v_mfma_f32_16x16x32_bf16 v[40:43], v[64:67], v[104:107], v[40:43]
  v_exp_f32 v188, v188
  v_exp_f32 v189, v189
  s_waitcnt vmcnt(4)
  v_mfma_f32_16x16x32_bf16 v[40:43], v[68:71], v[120:123], v[40:43]
  v_exp_f32 v190, v190
  v_exp_f32 v191, v191
  v_mfma_f32_16x16x32_bf16 v[44:47], v[68:71], v[124:127], v[44:47]
  s_waitcnt lgkmcnt(0)
  v_add_f32 v200, v204, v200
  v_add_f32_e64 v201, v205, v201
  v_mfma_f32_16x16x32_bf16 v[44:47], v[64:67], v[108:111], v[44:47]
  v_add_f32_e64 v202, v206, v202
  v_mfma_f32_16x16x32_bf16 v[48:51], v[64:67], v[112:115], v[48:51]
  v_add_f32 v203, v207, v203
  v_add_f32 v188, 1.0, v188
  v_mfma_f32_16x16x32_bf16 v[48:51], v[68:71], v[128:131], v[48:51]
  v_add_f32 v189, 1.0, v189
  v_add_f32 v190, 1.0, v190
  v_mfma_f32_16x16x32_bf16 v[52:55], v[68:71], v[132:135], v[52:55]
  v_add_f32 v191, 1.0, v191
  v_rcp_f32 v188, v188
  v_mfma_f32_16x16x32_bf16 v[52:55], v[64:67], v[116:119], v[52:55]
  v_rcp_f32 v189, v189
  s_waitcnt vmcnt(3)
  v_mfma_f32_16x16x32_bf16 v[24:27], v[72:75], v[136:139], v[24:27]
  v_rcp_f32 v190, v190
  v_rcp_f32_e64 v191, v191
  s_waitcnt vmcnt(2)
  v_mfma_f32_16x16x32_bf16 v[24:27], v[76:79], v[152:155], v[24:27]
  v_mul_f32 v184, v200, v184
  v_mul_f32 v185, v201, v185
  v_mfma_f32_16x16x32_bf16 v[28:31], v[76:79], v[156:159], v[28:31]
  v_mul_f32_e64 v186, v202, v186
  v_mfma_f32_16x16x32_bf16 v[28:31], v[72:75], v[140:143], v[28:31]
  v_mul_f32_e64 v187, v203, v187
  v_fma_f32 v12, v184, v188, v12
  v_mfma_f32_16x16x32_bf16 v[32:35], v[72:75], v[144:147], v[32:35]
  v_fma_f32 v13, v185, v189, v13
  v_fma_f32 v14, v186, v190, v14
  v_mfma_f32_16x16x32_bf16 v[32:35], v[76:79], v[160:163], v[32:35]
  v_fma_f32 v15, v187, v191, v15
  v_mfma_f32_16x16x32_bf16 v[36:39], v[76:79], v[164:167], v[36:39]
  v_cvt_pk_bf16_f32 v20, v12, v13
  v_cvt_pk_bf16_f32 v21, v14, v15
  v_mfma_f32_16x16x32_bf16 v[36:39], v[72:75], v[148:151], v[36:39]
  buffer_store_dwordx2 v[20:21], v8, s[12:15], 0 offen
  s_add_u32 m0, s53, 6144
  s_waitcnt vmcnt(2)
  v_mfma_f32_16x16x32_bf16 v[40:43], v[56:59], v[136:139], v[40:43]
  s_waitcnt vmcnt(1)
  v_mfma_f32_16x16x32_bf16 v[40:43], v[60:63], v[152:155], v[40:43]
  v_mfma_f32_16x16x32_bf16 v[44:47], v[60:63], v[156:159], v[44:47]
  v_mfma_f32_16x16x32_bf16 v[44:47], v[56:59], v[140:143], v[44:47]
  ds_write_addtid_b32 v24 offset:0
  ds_write_addtid_b32 v25 offset:256
  ds_write_addtid_b32 v26 offset:512
  ds_write_addtid_b32 v27 offset:768
  v_mfma_f32_16x16x32_bf16 v[48:51], v[56:59], v[144:147], v[48:51]
  ds_write_addtid_b32 v28 offset:8192
  ds_write_addtid_b32 v29 offset:8448
  ds_write_addtid_b32 v30 offset:8704
  v_mfma_f32_16x16x32_bf16 v[48:51], v[60:63], v[160:163], v[48:51]
  ds_write_addtid_b32 v31 offset:8960
  ds_write_addtid_b32 v32 offset:16384
  ds_write_addtid_b32 v33 offset:16640
  v_mfma_f32_16x16x32_bf16 v[52:55], v[60:63], v[164:167], v[52:55]
  ds_write_addtid_b32 v34 offset:16896
  ds_write_addtid_b32 v35 offset:17152
  ds_write_addtid_b32 v36 offset:24576
  v_mfma_f32_16x16x32_bf16 v[52:55], v[56:59], v[148:151], v[52:55]
  ds_write_addtid_b32 v37 offset:24832
  ds_write_addtid_b32 v38 offset:25088
  ds_write_addtid_b32 v39 offset:25344
  ds_write_addtid_b32 v40 offset:36864
  ds_write_addtid_b32 v41 offset:37120
  ds_write_addtid_b32 v42 offset:37376
  ds_write_addtid_b32 v43 offset:37632
  ds_write_addtid_b32 v44 offset:45056
  ds_write_addtid_b32 v45 offset:45312
  ds_write_addtid_b32 v46 offset:45568
  ds_write_addtid_b32 v47 offset:45824
  ds_write_addtid_b32 v48 offset:53248
  ds_write_addtid_b32 v49 offset:53504
  ds_write_addtid_b32 v50 offset:53760
  ds_write_addtid_b32 v51 offset:54016
  ds_write_addtid_b32 v52 offset:61440
  ds_write_addtid_b32 v53 offset:61696
  ds_write_addtid_b32 v54 offset:61952
  ds_write_addtid_b32 v55 offset:62208
  v_lshlrev_b32_e64 v12, 16, v22
  v_and_b32 v13, 0xffff0000, v22
  v_lshlrev_b32_e64 v14, 16, v23
  v_and_b32 v15, 0xffff0000, v23
  s_waitcnt lgkmcnt(0)
  s_barrier
  ds_read_b128 v[184:187], v10 offset:43008
  ds_read_b128 v[188:191], v10 offset:44032
  ds_read_b128 v[192:195], v10 offset:45056
  ds_read_b128 v[196:199], v10 offset:46080
  ds_read_b128 v[216:219], v10 offset:49152
  ds_read_b128 v[220:223], v10 offset:50176
  ds_read_b128 v[200:203], v10 offset:47104
  ds_read_b128 v[204:207], v10 offset:48128
  s_waitcnt lgkmcnt(6)
  v_pk_add_f32 v[184:185], v[184:185], v[188:189]
  v_pk_add_f32 v[186:187], v[186:187], v[190:191]
  s_waitcnt lgkmcnt(4)
  v_pk_add_f32 v[192:193], v[192:193], v[196:197]
  v_pk_add_f32 v[194:195], v[194:195], v[198:199]
  s_waitcnt lgkmcnt(2)
  v_pk_add_f32 v[216:217], v[216:217], v[220:221]
  v_pk_add_f32 v[218:219], v[218:219], v[222:223]
  v_pk_add_f32 v[184:185], v[184:185], v[192:193]
  v_pk_add_f32 v[186:187], v[186:187], v[194:195]
  v_pk_add_f32 v[184:185], v[184:185], v[216:217]
  v_pk_add_f32 v[186:187], v[186:187], v[218:219]
  v_pk_mul_f32 v[188:189], v[184:185], s[56:57] op_sel_hi:[1,0]
  v_pk_mul_f32 v[190:191], v[186:187], s[56:57] op_sel_hi:[1,0]
  v_exp_f32 v188, v188
  v_exp_f32 v189, v189
  v_exp_f32 v190, v190
  v_exp_f32 v191, v191
  s_waitcnt lgkmcnt(0)
  v_pk_add_f32 v[200:201], v[200:201], v[204:205]
  v_pk_add_f32 v[202:203], v[202:203], v[206:207]
  v_pk_add_f32 v[188:189], v[188:189], 1.0 op_sel_hi:[1,0]
  v_pk_add_f32 v[190:191], v[190:191], 1.0 op_sel_hi:[1,0]
  v_rcp_f32 v188, v188
  v_rcp_f32 v189, v189
  v_rcp_f32 v190, v190
  v_rcp_f32 v191, v191
  v_pk_mul_f32 v[184:185], v[184:185], v[200:201]
  v_pk_mul_f32 v[186:187], v[186:187], v[202:203]
  v_pk_fma_f32 v[12:13], v[184:185], v[188:189], v[12:13]
  v_pk_fma_f32 v[14:15], v[186:187], v[190:191], v[14:15]
  v_cvt_pk_bf16_f32 v22, v12, v13
  v_cvt_pk_bf16_f32 v23, v14, v15
  buffer_store_dwordx2 v[22:23], v11, s[12:15], 0 offen
  s_endpgm
L_end:
.fill (66048 - (L_end - recurrent_scan__sliding_local_dilated__swiglu_ffn__prompt_kernel)) / 4, 4, 0xbf800000
.section .rodata,"a"
.p2align 6
.amdhsa_kernel recurrent_scan__sliding_local_dilated__swiglu_ffn__prompt_kernel
  .amdhsa_next_free_vgpr 256
  .amdhsa_next_free_sgpr 102
  .amdhsa_accum_offset 256
  .amdhsa_group_segment_fixed_size 0
  .amdhsa_kernarg_size 80
  .amdhsa_user_sgpr_count 2
  .amdhsa_user_sgpr_kernarg_segment_ptr 1
  .amdhsa_system_sgpr_workgroup_id_x 1
  .amdhsa_float_denorm_mode_32 3
.end_amdhsa_kernel
```
